```python
import torch

def _softmax(x, axis=-1):
    return torch.softmax(x, dim=axis)

def _gelu(x):
    return torch.nn.functional.gelu(x, approximate='tanh')

def _silu(x):
    return torch.nn.functional.silu(x)

def _sigmoid(x):
    return torch.sigmoid(x)

def _layernorm(x, axis=-1, eps=1e-05):
    m = x.mean(dim=axis, keepdim=True)
    v = x.var(dim=axis, keepdim=True, unbiased=False)
    return (x - m) / torch.sqrt(v + eps)

def _scatter_add(tgt, idx, src, axis=0):
    return tgt.clone().index_add_(axis, idx, src)

def _segment_sum(src, seg, n):
    out = torch.zeros((n,) + src.shape[1:], dtype=src.dtype)
    return out.index_add_(0, seg, src)

def _pad(x, pw):
    flat = tuple((v for pair in reversed(pw) for v in pair))
    return torch.nn.functional.pad(x, flat)
kernel_name = 'gated_mix__grouped_kv_mqa__memory_aug_recurrent_mem_tr__prompt'

def setup_inputs():

    _w = lambda a: (lambda t: t.to(torch.bfloat16) if t.is_floating_point() else t)(torch.as_tensor(a))

    def _A_setup():
        B, S, D, H = (1, 2048, 1024, 32)
        Dh = D // H
        return {'x': _w((lambda *s: torch.randn(*s, dtype=torch.bfloat16) * 0.1)(B, S, D)), 'wq': _w((lambda *s: torch.randn(*s, dtype=torch.bfloat16) * 0.8)(D, H * Dh)), 'wk': _w((lambda *s: torch.randn(*s, dtype=torch.bfloat16) * 0.2)(D, Dh)), 'wv': _w((lambda *s: torch.randn(*s, dtype=torch.bfloat16) * 0.2)(D, Dh)), 'wo': _w((lambda *s: torch.randn(*s, dtype=torch.bfloat16) * 0.2)(H * Dh, D))}
    _A_in = _A_setup()

    def _B_setup():
        B, S, Dm = (1, 2048, 1024)
        H, Dh = (32, 128)
        M, seg = (8, 32)
        seg = min(seg, S)
        S = S // seg * seg
        return {'x': _w((lambda *s: torch.randn(*s, dtype=torch.bfloat16) * 0.1)(B, S, Dm)), 'mem0': _w((lambda *s: torch.randn(*s, dtype=torch.bfloat16) * 1.6)(B, M, Dm)), 'Wq': _w((lambda *s: torch.randn(*s, dtype=torch.bfloat16) * 0.8)(Dm, H, Dh) * Dm ** (-0.5)), 'Wk': _w((lambda *s: torch.randn(*s, dtype=torch.bfloat16) * 0.8)(Dm, H, Dh) * Dm ** (-0.5)), 'Wv': _w((lambda *s: torch.randn(*s, dtype=torch.bfloat16) * 1.6)(Dm, H, Dh) * Dm ** (-0.5)), 'Wo': _w((lambda *s: torch.randn(*s, dtype=torch.bfloat16) * 1.6)(H, Dh, Dm) * (H * Dh) ** (-0.5)), 'seg_len': seg}
    _B_in = _B_setup()
    return {'A_x': _A_in['x'], 'A_wq': _A_in['wq'], 'A_wk': _A_in['wk'], 'A_wv': _A_in['wv'], 'A_wo': _A_in['wo'], 'B_x': _B_in['x'], 'B_mem0': _B_in['mem0'], 'B_Wq': _B_in['Wq'], 'B_Wk': _B_in['Wk'], 'B_Wv': _B_in['Wv'], 'B_Wo': _B_in['Wo'], 'B_seg_len': _B_in['seg_len'], 'gate_w': _w((lambda *s: torch.randn(*s, dtype=torch.bfloat16) * 1.6)(1024) * 16.0)}

def reference(A_x, A_wq, A_wk, A_wv, A_wo, B_x, B_mem0, B_Wq, B_Wk, B_Wv, B_Wo, B_seg_len, gate_w):

    def _A_ref(x, wq, wk, wv, wo):
        B, S, D = x.shape
        H = 32
        Dh = D // H
        q = (lambda x, *d: x.permute(*d))((x @ wq).reshape(B, S, H, Dh), 0, 2, 1, 3)
        k = x @ wk
        v = x @ wv
        scores = torch.einsum('bhqd,bkd->bhqk', q, k) * Dh ** (-0.5)
        p = _softmax(scores, axis=-1)
        o = torch.einsum('bhqk,bkd->bhqd', p, v)
        return (lambda x, *d: x.permute(*d))(o, 0, 2, 1, 3).reshape(B, S, H * Dh) @ wo

    def _B_ref(x, mem0, Wq, Wk, Wv, Wo, seg_len):
        B, S, Dm = x.shape
        H, Dh = (Wq.shape[1], Wq.shape[2])
        M = mem0.shape[1]
        scale = Dh ** (-0.5)
        n_seg = S // seg_len
        L = M + seg_len
        idx = torch.arange(L)
        mask = (idx[:, None] < M) | (idx[:, None] >= idx[None, :])
        mem = mem0
        outs = []
        for s in range(n_seg):
            xs = x[:, s * seg_len:(s + 1) * seg_len, :].clone()
            h = torch.concatenate([mem, xs], axis=1)
            q = torch.einsum('btd,dhe->bhte', h, Wq)
            k = torch.einsum('btd,dhe->bhte', h, Wk)
            v = torch.einsum('btd,dhe->bhte', h, Wv)
            scores = torch.einsum('bhqe,bhke->bhqk', q, k) * scale
            scores = torch.where(mask[None, None], scores, -1000000000.0)
            p = _softmax(scores, axis=-1)
            o = torch.einsum('bhqk,bhke->bhqe', p, v)
            o = torch.einsum('bhte,hed->btd', o, Wo)
            mem = o[:, :M, :].clone()
            outs.append(o[:, M:, :])
        return torch.concatenate(outs, axis=1)
    x = A_x
    g = _sigmoid((x * gate_w).sum(-1, keepdims=True))
    a = _A_ref(x, A_wq, A_wk, A_wv, A_wo)
    b = _B_ref(x, B_mem0, B_Wq, B_Wk, B_Wv, B_Wo, B_seg_len)
    return g * a + (1 - g) * b
```

```asm
; @launch grid=(256,1,1) block=(512,1,1) lds=163840
.amdgcn_target "amdgcn-amd-amdhsa--gfx950"
.text
.globl gated_mix__grouped_kv_mqa__memory_aug_recurrent_mem_tr__prompt_kernel
.p2align 8
.type gated_mix__grouped_kv_mqa__memory_aug_recurrent_mem_tr__prompt_kernel,@function
gated_mix__grouped_kv_mqa__memory_aug_recurrent_mem_tr__prompt_kernel:
 s_load_dwordx2 s[4:5], s[0:1], 120
 s_load_dwordx2 s[16:17], s[0:1], 112
 s_bfe_u32 s10, s2, 0x20006
 s_lshl_b32 s10, s10, 3
 s_add_u32 s10, s10, 56
 s_load_dwordx2 s[18:19], s[0:1], s10
 s_load_dwordx2 s[20:21], s[0:1], 0
 s_load_dwordx2 s[22:23], s[0:1], 8
 s_getreg_b32 s12, hwreg(HW_REG_XCC_ID, 0, 4)
 s_mov_b32 s6, 0x10000000
 s_mov_b32 s7, 0x20000
 v_lshrrev_b32 v3, 6, v0
 s_nop 0
 v_readfirstlane_b32 s14, v3
 v_and_b32 v0, 63, v0
 s_and_b32 s12, s12, 7
 s_xor_b32 s12, s12, 0
 s_mov_b32 s63, 0
 s_mov_b32 s61, 0
 s_mov_b32 s62, 0
 v_mov_b32 v11, 163776
 v_mov_b32 v9, 1
 s_mov_b32 s30, 2047
 s_getreg_b32 s31, hwreg(HW_REG_HW_ID, 8, 1)
 s_waitcnt lgkmcnt(0)
 s_and_b32 s8, s2, 255
 s_lshl_b32 s8, s8, 3
 s_add_u32 s8, s8, s14
 s_and_b32 s9, s8, 511
 s_lshl_b32 s9, s9, 14
 v_lshl_add_u32 v4, v0, 10, s9
 s_lshl_b32 s9, s8, 11
 v_lshl_add_u32 v5, v0, 10, s9
 v_lshrrev_b32 v6, 1, v5
 s_mov_b64 exec, 0xffff
 global_load_dword v125, v4, s[18:19] offset:384
 s_mov_b64 exec, 3
 global_load_dword v125, v5, s[20:21] offset:384
 s_mov_b64 exec, 1
 global_load_dword v125, v6, s[22:23] offset:384
 s_mov_b64 exec, 1
 s_cmp_lg_u32 s14, 0
 s_cbranch_scc1 L_r0
 s_lshl_b32 s10, s12, 5
 s_add_u32 s10, s10, 28
 v_mov_b32 v8, s10
 global_atomic_add v10, v8, v9, s[16:17] sc0 sc1
 s_waitcnt vmcnt(0)
 ds_write_b32 v11, v10
 s_waitcnt lgkmcnt(0)
 s_branch L_r2
L_r0:
 s_lshr_b32 s11, s12, 2
 s_lshl_b32 s11, s11, 3
 s_add_u32 s10, s14, s11
 s_cmp_lg_u32 s10, 4
 s_cbranch_scc1 L_r1
 s_and_b32 s10, s2, 511
 s_lshl_b32 s10, s10, 7
 s_and_b32 s11, s10, 0xe000
 s_add_u32 s10, s10, s11
 s_lshl_b32 s11, s31, 13
 s_add_u32 s10, s10, s11
 s_add_u32 s10, s10, 84934656
 s_mov_b32 s11, 3
L_rp:
 s_memtime s[26:27]
 s_waitcnt lgkmcnt(0)
 buffer_store_dword v9, off, s[4:7], s10 sc1
 s_waitcnt vmcnt(0)
 s_memtime s[28:29]
 s_waitcnt lgkmcnt(0)
 s_sub_u32 s26, s28, s26
 s_min_u32 s30, s30, s26
 s_sub_u32 s11, s11, 1
 s_cmp_lg_u32 s11, 0
 s_cbranch_scc1 L_rp
L_r1:
L_r2:
 s_mov_b64 exec, -1
 s_waitcnt vmcnt(0)
 s_barrier
 ds_read_b32 v10, v11
 s_waitcnt lgkmcnt(0)
 v_readfirstlane_b32 s13, v10
 s_cmp_ge_u32 s13, 32
 s_cbranch_scc1 L_end
 s_lshr_b32 s10, s12, 2
 s_and_b32 s12, s12, 3
 s_lshl_b32 s12, s12, 1
 s_lshr_b32 s11, s13, 4
 s_add_u32 s12, s12, s11
 s_and_b32 s13, s13, 15
 s_lshl_b32 s10, s10, 4
 s_add_u32 s13, s13, s10
 s_lshl_b32 s95, s12, 5
 s_add_u32 s95, s95, s13
 s_lshl_b32 s95, s95, 10
 s_add_u32 s95, s95, 5242880
 s_sub_u32 s40, s13, 16
 s_cbranch_scc0 L_disp
L_chain:
 s_mov_b32 s88, 0
 s_mov_b32 s89, 0
 s_mov_b32 s90, 0
 s_mov_b32 s60, 0
 s_mov_b32 s15, 0
 s_lshl_b32 s20, s12, 14
 v_and_b32_e64 v56, 15, v0
 v_lshrrev_b32_e64 v57, 4, v0
 v_mov_b32 v3, 0x4444
 v_mov_b32 v58, 0xeeee
 v_cmp_lt_u32_e64 vcc, 7, v56
 s_nop 1
 v_cndmask_b32_e64 v3, v3, v58, vcc
 s_and_b32 s21, s14, 3
 s_mov_b32 s40, 0x3f80
 s_mov_b32 s41, 0x3f800000
 s_mov_b32 s42, 0x05040100
 s_mov_b32 s43, 0x07060302
 s_mov_b32 s44, -2
 v_mov_b32_e64 v59, 0
 v_mov_b32_e64 v63, 0
 s_mov_b32 s51, 0
 s_mov_b32 s86, 0
 s_mov_b32 s81, 3
 s_mul_i32 s91, s14, 4352
 s_add_u32 s91, s91, 69632
 s_mov_b32 s83, 4
 s_mov_b32 s87, 0
 s_lshr_b32 s22, s13, 2
 s_lshl_b32 s22, s22, 14
 s_and_b32 s36, s13, 3
 s_lshl_b32 s36, s36, 11
 s_add_u32 s22, s22, s36
 s_add_u32 s22, s22, 83886080
 s_bfe_u32 s36, s13, 65536
 s_lshl_b32 s36, s36, 7
 s_cmp_ge_u32 s14, 4
 s_cbranch_scc1 L_T
 s_load_dwordx2 s[8:9], s[0:1], 56
 s_load_dwordx2 s[24:25], s[0:1], 64
 s_load_dwordx2 s[28:29], s[0:1], 72
 s_load_dwordx2 s[32:33], s[0:1], 48
 s_mov_b32 s10, 0x800000
 s_mov_b32 s11, 0x20000
 s_mov_b32 s26, 0x800000
 s_mov_b32 s27, 0x20000
 s_mov_b32 s30, 0x800000
 s_mov_b32 s31, 0x20000
 s_mov_b32 s34, 0x4000
 s_mov_b32 s35, 0x20000
 s_lshl_b32 s23, s12, 4
 s_add_u32 s23, s23, s13
 s_lshl_b32 s23, s23, 6
 v_mov_b32_e64 v8, v56
 v_mov_b32_e64 v9, v57
 v_lshlrev_b32_e64 v7, 4, v0
 v_mov_b32_e64 v48, 0
 v_mov_b32_e64 v49, 0
 v_mov_b32_e64 v50, 0
 v_mov_b32_e64 v51, 0
 v_lshrrev_b32 v12, 1, v9
 v_and_b32 v13, 1, v9
 v_lshl_add_u32 v13, v12, 3, v13
 v_lshlrev_b32 v28, 16, v13
 v_lshl_add_u32 v28, v8, 2, v28
 v_add_u32 v28, s23, v28
 s_lshl_b32 s36, s14, 14
 s_add_u32 s36, s36, 83886080
 v_lshl_add_u32 v2, v9, 11, s36
 s_lshl_b32 s36, s14, 2
 v_add_u32 v13, s36, v9
 v_bfe_u32 v13, v13, 0, 1
 v_lshrrev_b32 v13, 3, v8
 v_and_b32 v14, 7, v8
 v_lshl_add_u32 v1, v13, 8, v2
 v_lshl_add_u32 v1, v14, 4, v1
 v_lshl_add_u32 v2, v8, 2, v2
 v_lshlrev_b32 v29, 11, v14
 v_lshl_add_u32 v29, v9, 7, v29
 v_lshl_add_u32 v29, v13, 2, v29
 v_and_b32 v13, 1, v9
 v_mul_u32_u24 v4, 1664, v13
 v_lshl_add_u32 v4, v8, 3, v4
 s_mul_i32 s36, s14, 3584
 v_add_u32 v4, s36, v4
 v_lshl_add_u32 v5, v12, 2, v4
 v_add_u32 v5, 288, v5
 v_mul_u32_u24 v12, 144, v12
 v_add_u32 v4, v4, v12
 v_mov_b32 v20, -1
 v_mov_b32 v21, -1
 v_mov_b32 v22, -1
 v_mov_b32 v23, -1
 s_mov_b32 s52, 0x00ff00ff
 s_mov_b32 s53, 0x00ff00ff
 s_mov_b32 s54, 0
 s_mov_b32 s55, 0x00ff00ff
 s_mov_b32 s84, 0x88888888
 s_mov_b32 s85, 0x88888888
 s_mov_b32 s49, 0x07060100
 s_mov_b32 s50, 0x41000000
 s_lshl_b32 s58, s23, 6
 s_lshl_b32 s36, s14, 10
 s_add_u32 s58, s58, s36
 s_add_u32 s58, s58, 133693440
 s_add_u32 s36, s58, 33030144
 buffer_store_dwordx4 v[20:23], v7, s[4:7], s36 offen sc1
 s_add_u32 s36, s58, 33554432
 buffer_store_dwordx4 v[20:23], v7, s[4:7], s36 offen sc1
 v_lshrrev_b32 v12, 3, v0
 v_mul_u32_u24 v6, 272, v12
 s_mul_i32 s36, s14, 2176
 s_add_u32 s36, s36, 98304
 v_add_u32 v6, s36, v6
 v_bfe_u32 v12, v0, 1, 2
 v_lshl_add_u32 v57, v12, 6, v6
 v_and_b32 v12, 1, v0
 v_lshl_add_u32 v57, v12, 3, v57
 s_lshl_b32 s57, s13, 10
 s_and_b32 s36, s57, 0x2000
 s_add_u32 s57, s57, s36
 s_lshl_b32 s36, s14, 8
 s_add_u32 s57, s57, s36
 s_add_u32 s57, s57, 84410368
 s_cmp_ge_u32 s12, 2
 s_cbranch_scc1 L_Gi
 s_lshl_b32 s36, s12, 13
 s_add_u32 s36, s36, s57
 s_mov_b64 exec, 1
 buffer_store_dword v48, off, s[4:7], s36 sc1
 s_mov_b64 exec, -1
L_Gi:
 s_cmp_eq_u32 s14, 0
 s_cbranch_scc1 L_G0i
 s_cmp_eq_u32 s14, 1
 s_cbranch_scc1 L_G1i
 s_cmp_eq_u32 s14, 3
 s_cbranch_scc1 L_G3i
 s_lshl_b32 s36, s12, 10
 s_add_u32 s38, s36, 2293760
 v_lshrrev_b32 v12, 2, v0
 v_lshl_add_u32 v56, v12, 7, s38
 v_and_b32 v12, 3, v0
 v_lshl_add_u32 v56, v12, 2, v56
 v_mov_b32 v52, -1
 v_mov_b32 v54, 1
 s_lshl_b32 s36, s12, 11
 s_lshl_b32 s37, s13, 2
 s_add_u32 s36, s36, s37
 s_add_u32 s36, s36, 2162688
 v_lshlrev_b32 v59, 7, v0
 v_add_u32 v59, s36, v59
 v_bfe_u32 v12, v0, 2, 1
 v_lshl_add_u32 v12, v12, 2, 3
 v_lshlrev_b32 v50, 4, v12
 v_add_u32 v50, 24704, v50
 v_mul_u32_u24 v49, 320, v12
 v_and_b32 v12, 3, v0
 v_lshl_add_u32 v49, v12, 6, v49
 v_bfe_u32 v12, v0, 3, 1
 v_lshl_add_u32 v49, v12, 3, v49
 v_add_u32 v49, 14388, v49
 v_lshl_add_u32 v51, v8, 2, s22
 s_mov_b32 s52, 0xaaaaaaaa
 s_mov_b32 s53, 0xaaaaaaaa
 s_lshl_b32 s51, s23, 1
 s_add_u32 s51, s51, 2260992
 s_lshl_b32 s36, s23, 5
 s_add_u32 s36, s36, 16777216
 v_lshl_add_u32 v58, v8, 7, s36
 v_lshl_add_u32 v58, v9, 24, v58
 s_and_b32 s37, s13, 3
 s_mul_i32 s37, s37, 5
 v_add_u32 v12, s37, v8
 v_min_u32 v12, 17, v12
 s_and_b32 s36, s36, 0xffffe000
 s_add_u32 s36, s36, 50331648
 v_lshl_add_u32 v12, v12, 7, s36
 v_cmp_lt_u32 vcc, 47, v0
 s_nop 1
 v_cndmask_b32 v58, v58, v12, vcc
 s_branch L_Gw
L_G3i:
 v_and_b32 v12, 3, v8
 v_lshrrev_b32 v13, 3, v8
 v_lshl_add_u32 v12, v13, 2, v12
 v_mul_u32_u24 v63, 416, v12
 v_lshl_add_u32 v63, v9, 5, v63
 v_add_u32 v63, 144, v63
 v_lshlrev_b32 v58, 9, v9
 v_lshl_add_u32 v58, v8, 4, v58
 s_lshl_b32 s36, s23, 5
 s_add_u32 s36, s36, 50331648
 v_add_u32 v58, s36, v58
 s_lshl_b32 s36, s13, 9
 s_add_u32 s36, s36, s20
 s_add_u32 s36, s36, 1581056
 v_lshlrev_b32 v56, 5, v8
 v_lshl_add_u32 v56, v9, 3, v56
 v_add_u32 v56, s36, v56
 s_mov_b32 s52, 0xffff0000
 s_mov_b32 s53, 0xffff0000
 s_branch L_G1r
L_G1i:
 v_bfe_u32 v12, v0, 1, 2
 v_bfe_u32 v13, v0, 4, 1
 v_lshl_add_u32 v12, v13, 2, v12
 v_mul_u32_u24 v63, 416, v12
 v_lshrrev_b32 v12, 5, v0
 v_lshl_add_u32 v63, v12, 6, v63
 v_and_b32 v12, 1, v0
 v_lshl_add_u32 v63, v12, 5, v63
 v_bfe_u32 v12, v0, 3, 1
 v_lshl_add_u32 v63, v12, 3, v63
 v_add_u32 v63, 288, v63
 v_add_u32 v58, 16, v63
 v_lshlrev_b32 v12, 3, v0
 s_lshl_b32 s36, s13, 9
 s_add_u32 s36, s36, s20
 s_add_u32 s36, s36, 1572864
 v_add_u32 v56, s36, v12
 v_lshrrev_b32 v12, 3, v0
 v_lshl_add_u32 v59, v12, 8, s22
 v_and_b32 v12, 7, v0
 v_lshl_add_u32 v59, v12, 4, v59
 s_and_b32 s36, s12, 3
 s_lshl_b32 s36, s36, 16
 s_lshr_b32 s37, s12, 2
 s_lshl_b32 s37, s37, 13
 s_add_u32 s36, s36, s37
 buffer_store_dwordx4 v[48:51], v59, s[4:7], s36 offen sc1
 s_mov_b64 exec, 15
 buffer_store_dwordx4 v[48:51], v59, s[4:7], s36 offen offset:384 sc1
 s_mov_b64 exec, -1
L_G1r:
 s_mov_b32 s36, 0
 buffer_store_dwordx2 v[20:21], v56, s[4:7], s36 offen
 buffer_load_dwordx2 v[24:25], v56, s[4:7], s36 offen sc1
 s_mov_b32 s36, 131072
 buffer_store_dwordx2 v[20:21], v56, s[4:7], s36 offen
 buffer_load_dwordx2 v[24:25], v56, s[4:7], s36 offen sc1
 s_mov_b32 s36, 262144
 buffer_store_dwordx2 v[20:21], v56, s[4:7], s36 offen
 buffer_load_dwordx2 v[24:25], v56, s[4:7], s36 offen sc1
 s_mov_b32 s36, 393216
 buffer_store_dwordx2 v[20:21], v56, s[4:7], s36 offen
 buffer_load_dwordx2 v[24:25], v56, s[4:7], s36 offen sc1
 s_branch L_Gw
L_G0i:
 v_and_b32 v12, 7, v8
 v_bfe_u32 v13, v8, 1, 1
 v_bfe_u32 v14, v8, 2, 1
 v_and_b32 v15, 1, v8
 v_lshl_add_u32 v15, v13, 2, v15
 v_lshl_add_u32 v16, v14, 1, v15
 v_cmp_lt_u32 vcc, 7, v8
 s_nop 1
 v_cndmask_b32 v16, v12, v16, vcc
 v_mul_u32_u24 v63, 416, v16
 v_lshrrev_b32 v13, 3, v8
 v_mul_u32_u24 v17, 144, v13
 v_add_u32 v63, v63, v17
 v_lshl_add_u32 v63, v9, 5, v63
 v_lshl_add_u32 v15, v14, 4, v15
 v_lshl_add_u32 v15, v13, 1, v15
 v_lshlrev_b32 v17, 9, v9
 v_lshl_add_u32 v58, v15, 4, v17
 s_lshl_b32 s36, s23, 5
 s_add_u32 s36, s36, 16777216
 v_add_u32 v58, s36, v58
 s_lshl_b32 s36, s13, 10
 s_add_u32 s36, s36, s20
 s_add_u32 s36, s36, 1048576
 v_and_b32 v13, 1, v9
 v_lshrrev_b32 v14, 1, v9
 v_lshlrev_b32 v56, 8, v13
 v_lshl_add_u32 v56, v14, 7, v56
 v_lshl_add_u32 v56, v12, 4, v56
 v_add_u32 v56, s36, v56
 v_lshlrev_b32 v59, 6, v13
 v_lshl_add_u32 v59, v12, 3, v59
 v_add_u32 v59, s36, v59
 s_add_u32 s37, s36, 0
 buffer_store_dwordx4 v[20:23], v7, s[4:7], s37 offen
 buffer_load_dwordx4 v[24:27], v7, s[4:7], s37 offen sc1
 s_add_u32 s37, s36, 131072
 buffer_store_dwordx4 v[20:23], v7, s[4:7], s37 offen
 buffer_load_dwordx4 v[24:27], v7, s[4:7], s37 offen sc1
 s_add_u32 s37, s36, 262144
 buffer_store_dwordx4 v[20:23], v7, s[4:7], s37 offen
 buffer_load_dwordx4 v[24:27], v7, s[4:7], s37 offen sc1
 s_add_u32 s37, s36, 393216
 buffer_store_dwordx4 v[20:23], v7, s[4:7], s37 offen
 buffer_load_dwordx4 v[24:27], v7, s[4:7], s37 offen sc1
L_Gw:
 s_lshl_b32 s36, s13, 2
 s_add_u32 s36, s36, s14
 s_lshl_b32 s36, s36, 17
 s_lshl_b32 s37, s12, 10
 s_add_u32 s36, s36, s37
 v_lshlrev_b32 v30, 13, v8
 v_lshl_add_u32 v30, v9, 9, v30
 s_lshl_b32 s38, s14, 9
 s_waitcnt lgkmcnt(0)
 s_mov_b64 exec, 0xffff
 s_cmp_ge_u32 s12, 7
 s_cselect_b32 exec_lo, -1, 0xffff
 buffer_load_dword v31, v30, s[28:31], s36 offen offset:384
 buffer_load_dword v31, v30, s[24:27], s36 offen offset:384
 buffer_load_dword v31, v30, s[8:11], s36 offen offset:384
 s_mov_b64 exec, -1
 s_lshl_b32 s36, s14, 21
 s_add_u32 s37, s36, 0
 buffer_load_dword a0, v28, s[8:11], s37 offen nt
 s_add_u32 s37, s36, 8192
 buffer_load_dword a16, v28, s[8:11], s37 offen nt
 s_add_u32 s37, s36, 16384
 buffer_load_dword a1, v28, s[8:11], s37 offen nt
 s_add_u32 s37, s36, 24576
 buffer_load_dword a17, v28, s[8:11], s37 offen nt
 s_add_u32 s37, s36, 32768
 buffer_load_dword a2, v28, s[8:11], s37 offen nt
 s_add_u32 s37, s36, 40960
 buffer_load_dword a18, v28, s[8:11], s37 offen nt
 s_add_u32 s37, s36, 49152
 buffer_load_dword a3, v28, s[8:11], s37 offen nt
 s_add_u32 s37, s36, 57344
 buffer_load_dword a19, v28, s[8:11], s37 offen nt
 s_add_u32 s37, s36, 1048576
 buffer_load_dword a4, v28, s[8:11], s37 offen nt
 s_add_u32 s37, s36, 1056768
 buffer_load_dword a20, v28, s[8:11], s37 offen nt
 s_add_u32 s37, s36, 1064960
 buffer_load_dword a5, v28, s[8:11], s37 offen nt
 s_add_u32 s37, s36, 1073152
 buffer_load_dword a21, v28, s[8:11], s37 offen nt
 s_add_u32 s37, s36, 1081344
 buffer_load_dword a6, v28, s[8:11], s37 offen nt
 s_add_u32 s37, s36, 1089536
 buffer_load_dword a22, v28, s[8:11], s37 offen nt
 s_add_u32 s37, s36, 1097728
 buffer_load_dword a7, v28, s[8:11], s37 offen nt
 s_add_u32 s37, s36, 1105920
 buffer_load_dword a23, v28, s[8:11], s37 offen nt
 s_add_u32 s37, s36, 0
 buffer_load_dword a8, v28, s[24:27], s37 offen nt
 s_add_u32 s37, s36, 8192
 buffer_load_dword a24, v28, s[24:27], s37 offen nt
 s_add_u32 s37, s36, 16384
 buffer_load_dword a9, v28, s[24:27], s37 offen nt
 s_add_u32 s37, s36, 24576
 buffer_load_dword a25, v28, s[24:27], s37 offen nt
 s_add_u32 s37, s36, 32768
 buffer_load_dword a10, v28, s[24:27], s37 offen nt
 s_add_u32 s37, s36, 40960
 buffer_load_dword a26, v28, s[24:27], s37 offen nt
 s_add_u32 s37, s36, 49152
 buffer_load_dword a11, v28, s[24:27], s37 offen nt
 s_add_u32 s37, s36, 57344
 buffer_load_dword a27, v28, s[24:27], s37 offen nt
 s_add_u32 s37, s36, 1048576
 buffer_load_dword a12, v28, s[24:27], s37 offen nt
 s_add_u32 s37, s36, 1056768
 buffer_load_dword a28, v28, s[24:27], s37 offen nt
 s_add_u32 s37, s36, 1064960
 buffer_load_dword a13, v28, s[24:27], s37 offen nt
 s_add_u32 s37, s36, 1073152
 buffer_load_dword a29, v28, s[24:27], s37 offen nt
 s_add_u32 s37, s36, 1081344
 buffer_load_dword a14, v28, s[24:27], s37 offen nt
 s_add_u32 s37, s36, 1089536
 buffer_load_dword a30, v28, s[24:27], s37 offen nt
 s_add_u32 s37, s36, 1097728
 buffer_load_dword a15, v28, s[24:27], s37 offen nt
 s_add_u32 s37, s36, 1105920
 buffer_load_dword a31, v28, s[24:27], s37 offen nt
 s_add_u32 s37, s36, 0
 buffer_load_dword a32, v28, s[28:31], s37 offen nt
 s_add_u32 s37, s36, 8192
 buffer_load_dword a40, v28, s[28:31], s37 offen nt
 s_add_u32 s37, s36, 16384
 buffer_load_dword a33, v28, s[28:31], s37 offen nt
 s_add_u32 s37, s36, 24576
 buffer_load_dword a41, v28, s[28:31], s37 offen nt
 s_add_u32 s37, s36, 32768
 buffer_load_dword a34, v28, s[28:31], s37 offen nt
 s_add_u32 s37, s36, 40960
 buffer_load_dword a42, v28, s[28:31], s37 offen nt
 s_add_u32 s37, s36, 49152
 buffer_load_dword a35, v28, s[28:31], s37 offen nt
 s_add_u32 s37, s36, 57344
 buffer_load_dword a43, v28, s[28:31], s37 offen nt
 s_add_u32 s37, s36, 1048576
 buffer_load_dword a36, v28, s[28:31], s37 offen nt
 s_add_u32 s37, s36, 1056768
 buffer_load_dword a44, v28, s[28:31], s37 offen nt
 s_add_u32 s37, s36, 1064960
 buffer_load_dword a37, v28, s[28:31], s37 offen nt
 s_add_u32 s37, s36, 1073152
 buffer_load_dword a45, v28, s[28:31], s37 offen nt
 s_add_u32 s37, s36, 1081344
 buffer_load_dword a38, v28, s[28:31], s37 offen nt
 s_add_u32 s37, s36, 1089536
 buffer_load_dword a46, v28, s[28:31], s37 offen nt
 s_add_u32 s37, s36, 1097728
 buffer_load_dword a39, v28, s[28:31], s37 offen nt
 s_add_u32 s37, s36, 1105920
 buffer_load_dword a47, v28, s[28:31], s37 offen nt
 s_waitcnt vmcnt(51)
 s_barrier
 s_waitcnt vmcnt(32)
 s_add_u32 s37, s36, 131072
 buffer_load_dword a48, v28, s[8:11], s37 offen nt
 s_add_u32 s37, s36, 139264
 buffer_load_dword a64, v28, s[8:11], s37 offen nt
 s_add_u32 s37, s36, 147456
 buffer_load_dword a49, v28, s[8:11], s37 offen nt
 s_add_u32 s37, s36, 155648
 buffer_load_dword a65, v28, s[8:11], s37 offen nt
 s_add_u32 s37, s36, 163840
 buffer_load_dword a50, v28, s[8:11], s37 offen nt
 s_add_u32 s37, s36, 172032
 buffer_load_dword a66, v28, s[8:11], s37 offen nt
 s_add_u32 s37, s36, 180224
 buffer_load_dword a51, v28, s[8:11], s37 offen nt
 s_add_u32 s37, s36, 188416
 buffer_load_dword a67, v28, s[8:11], s37 offen nt
 s_add_u32 s37, s36, 1179648
 buffer_load_dword a52, v28, s[8:11], s37 offen nt
 s_add_u32 s37, s36, 1187840
 buffer_load_dword a68, v28, s[8:11], s37 offen nt
 s_add_u32 s37, s36, 1196032
 buffer_load_dword a53, v28, s[8:11], s37 offen nt
 s_add_u32 s37, s36, 1204224
 buffer_load_dword a69, v28, s[8:11], s37 offen nt
 s_add_u32 s37, s36, 1212416
 buffer_load_dword a54, v28, s[8:11], s37 offen nt
 s_add_u32 s37, s36, 1220608
 buffer_load_dword a70, v28, s[8:11], s37 offen nt
 s_add_u32 s37, s36, 1228800
 buffer_load_dword a55, v28, s[8:11], s37 offen nt
 s_add_u32 s37, s36, 1236992
 buffer_load_dword a71, v28, s[8:11], s37 offen nt
 v_accvgpr_read_b32 v24, a0
 v_accvgpr_read_b32 v25, a16
 v_perm_b32 v26, v25, v24, s42
 v_perm_b32 v27, v25, v24, s43
 v_accvgpr_write_b32 a0, v26
 v_accvgpr_write_b32 a16, v27
 v_accvgpr_read_b32 v24, a1
 v_accvgpr_read_b32 v25, a17
 v_perm_b32 v26, v25, v24, s42
 v_perm_b32 v27, v25, v24, s43
 v_accvgpr_write_b32 a1, v26
 v_accvgpr_write_b32 a17, v27
 v_accvgpr_read_b32 v24, a2
 v_accvgpr_read_b32 v25, a18
 v_perm_b32 v26, v25, v24, s42
 v_perm_b32 v27, v25, v24, s43
 v_accvgpr_write_b32 a2, v26
 v_accvgpr_write_b32 a18, v27
 v_accvgpr_read_b32 v24, a3
 v_accvgpr_read_b32 v25, a19
 v_perm_b32 v26, v25, v24, s42
 v_perm_b32 v27, v25, v24, s43
 v_accvgpr_write_b32 a3, v26
 v_accvgpr_write_b32 a19, v27
 v_accvgpr_read_b32 v24, a4
 v_accvgpr_read_b32 v25, a20
 v_perm_b32 v26, v25, v24, s42
 v_perm_b32 v27, v25, v24, s43
 v_accvgpr_write_b32 a4, v26
 v_accvgpr_write_b32 a20, v27
 v_accvgpr_read_b32 v24, a5
 v_accvgpr_read_b32 v25, a21
 v_perm_b32 v26, v25, v24, s42
 v_perm_b32 v27, v25, v24, s43
 v_accvgpr_write_b32 a5, v26
 v_accvgpr_write_b32 a21, v27
 v_accvgpr_read_b32 v24, a6
 v_accvgpr_read_b32 v25, a22
 v_perm_b32 v26, v25, v24, s42
 v_perm_b32 v27, v25, v24, s43
 v_accvgpr_write_b32 a6, v26
 v_accvgpr_write_b32 a22, v27
 v_accvgpr_read_b32 v24, a7
 v_accvgpr_read_b32 v25, a23
 v_perm_b32 v26, v25, v24, s42
 v_perm_b32 v27, v25, v24, s43
 v_accvgpr_write_b32 a7, v26
 v_accvgpr_write_b32 a23, v27
 s_waitcnt vmcnt(32)
 s_add_u32 s37, s36, 131072
 buffer_load_dword a56, v28, s[24:27], s37 offen nt
 s_add_u32 s37, s36, 139264
 buffer_load_dword a72, v28, s[24:27], s37 offen nt
 s_add_u32 s37, s36, 147456
 buffer_load_dword a57, v28, s[24:27], s37 offen nt
 s_add_u32 s37, s36, 155648
 buffer_load_dword a73, v28, s[24:27], s37 offen nt
 s_add_u32 s37, s36, 163840
 buffer_load_dword a58, v28, s[24:27], s37 offen nt
 s_add_u32 s37, s36, 172032
 buffer_load_dword a74, v28, s[24:27], s37 offen nt
 s_add_u32 s37, s36, 180224
 buffer_load_dword a59, v28, s[24:27], s37 offen nt
 s_add_u32 s37, s36, 188416
 buffer_load_dword a75, v28, s[24:27], s37 offen nt
 s_add_u32 s37, s36, 1179648
 buffer_load_dword a60, v28, s[24:27], s37 offen nt
 s_add_u32 s37, s36, 1187840
 buffer_load_dword a76, v28, s[24:27], s37 offen nt
 s_add_u32 s37, s36, 1196032
 buffer_load_dword a61, v28, s[24:27], s37 offen nt
 s_add_u32 s37, s36, 1204224
 buffer_load_dword a77, v28, s[24:27], s37 offen nt
 s_add_u32 s37, s36, 1212416
 buffer_load_dword a62, v28, s[24:27], s37 offen nt
 s_add_u32 s37, s36, 1220608
 buffer_load_dword a78, v28, s[24:27], s37 offen nt
 s_add_u32 s37, s36, 1228800
 buffer_load_dword a63, v28, s[24:27], s37 offen nt
 s_add_u32 s37, s36, 1236992
 buffer_load_dword a79, v28, s[24:27], s37 offen nt
 v_accvgpr_read_b32 v24, a8
 v_accvgpr_read_b32 v25, a24
 v_perm_b32 v26, v25, v24, s42
 v_perm_b32 v27, v25, v24, s43
 v_accvgpr_write_b32 a8, v26
 v_accvgpr_write_b32 a24, v27
 v_accvgpr_read_b32 v24, a9
 v_accvgpr_read_b32 v25, a25
 v_perm_b32 v26, v25, v24, s42
 v_perm_b32 v27, v25, v24, s43
 v_accvgpr_write_b32 a9, v26
 v_accvgpr_write_b32 a25, v27
 v_accvgpr_read_b32 v24, a10
 v_accvgpr_read_b32 v25, a26
 v_perm_b32 v26, v25, v24, s42
 v_perm_b32 v27, v25, v24, s43
 v_accvgpr_write_b32 a10, v26
 v_accvgpr_write_b32 a26, v27
 v_accvgpr_read_b32 v24, a11
 v_accvgpr_read_b32 v25, a27
 v_perm_b32 v26, v25, v24, s42
 v_perm_b32 v27, v25, v24, s43
 v_accvgpr_write_b32 a11, v26
 v_accvgpr_write_b32 a27, v27
 v_accvgpr_read_b32 v24, a12
 v_accvgpr_read_b32 v25, a28
 v_perm_b32 v26, v25, v24, s42
 v_perm_b32 v27, v25, v24, s43
 v_accvgpr_write_b32 a12, v26
 v_accvgpr_write_b32 a28, v27
 v_accvgpr_read_b32 v24, a13
 v_accvgpr_read_b32 v25, a29
 v_perm_b32 v26, v25, v24, s42
 v_perm_b32 v27, v25, v24, s43
 v_accvgpr_write_b32 a13, v26
 v_accvgpr_write_b32 a29, v27
 v_accvgpr_read_b32 v24, a14
 v_accvgpr_read_b32 v25, a30
 v_perm_b32 v26, v25, v24, s42
 v_perm_b32 v27, v25, v24, s43
 v_accvgpr_write_b32 a14, v26
 v_accvgpr_write_b32 a30, v27
 v_accvgpr_read_b32 v24, a15
 v_accvgpr_read_b32 v25, a31
 v_perm_b32 v26, v25, v24, s42
 v_perm_b32 v27, v25, v24, s43
 v_accvgpr_write_b32 a15, v26
 v_accvgpr_write_b32 a31, v27
 s_waitcnt vmcnt(32)
 s_add_u32 s37, s36, 131072
 buffer_load_dword a80, v28, s[28:31], s37 offen nt
 s_add_u32 s37, s36, 139264
 buffer_load_dword a88, v28, s[28:31], s37 offen nt
 s_add_u32 s37, s36, 147456
 buffer_load_dword a81, v28, s[28:31], s37 offen nt
 s_add_u32 s37, s36, 155648
 buffer_load_dword a89, v28, s[28:31], s37 offen nt
 s_add_u32 s37, s36, 163840
 buffer_load_dword a82, v28, s[28:31], s37 offen nt
 s_add_u32 s37, s36, 172032
 buffer_load_dword a90, v28, s[28:31], s37 offen nt
 s_add_u32 s37, s36, 180224
 buffer_load_dword a83, v28, s[28:31], s37 offen nt
 s_add_u32 s37, s36, 188416
 buffer_load_dword a91, v28, s[28:31], s37 offen nt
 s_add_u32 s37, s36, 1179648
 buffer_load_dword a84, v28, s[28:31], s37 offen nt
 s_add_u32 s37, s36, 1187840
 buffer_load_dword a92, v28, s[28:31], s37 offen nt
 s_add_u32 s37, s36, 1196032
 buffer_load_dword a85, v28, s[28:31], s37 offen nt
 s_add_u32 s37, s36, 1204224
 buffer_load_dword a93, v28, s[28:31], s37 offen nt
 s_add_u32 s37, s36, 1212416
 buffer_load_dword a86, v28, s[28:31], s37 offen nt
 s_add_u32 s37, s36, 1220608
 buffer_load_dword a94, v28, s[28:31], s37 offen nt
 s_add_u32 s37, s36, 1228800
 buffer_load_dword a87, v28, s[28:31], s37 offen nt
 s_add_u32 s37, s36, 1236992
 buffer_load_dword a95, v28, s[28:31], s37 offen nt
 v_accvgpr_read_b32 v24, a32
 v_accvgpr_read_b32 v25, a40
 v_perm_b32 v26, v25, v24, s42
 v_perm_b32 v27, v25, v24, s43
 v_accvgpr_write_b32 a32, v26
 v_accvgpr_write_b32 a40, v27
 v_accvgpr_read_b32 v24, a33
 v_accvgpr_read_b32 v25, a41
 v_perm_b32 v26, v25, v24, s42
 v_perm_b32 v27, v25, v24, s43
 v_accvgpr_write_b32 a33, v26
 v_accvgpr_write_b32 a41, v27
 v_accvgpr_read_b32 v24, a34
 v_accvgpr_read_b32 v25, a42
 v_perm_b32 v26, v25, v24, s42
 v_perm_b32 v27, v25, v24, s43
 v_accvgpr_write_b32 a34, v26
 v_accvgpr_write_b32 a42, v27
 v_accvgpr_read_b32 v24, a35
 v_accvgpr_read_b32 v25, a43
 v_perm_b32 v26, v25, v24, s42
 v_perm_b32 v27, v25, v24, s43
 v_accvgpr_write_b32 a35, v26
 v_accvgpr_write_b32 a43, v27
 v_accvgpr_read_b32 v24, a36
 v_accvgpr_read_b32 v25, a44
 v_perm_b32 v26, v25, v24, s42
 v_perm_b32 v27, v25, v24, s43
 v_accvgpr_write_b32 a36, v26
 v_accvgpr_write_b32 a44, v27
 v_accvgpr_read_b32 v24, a37
 v_accvgpr_read_b32 v25, a45
 v_perm_b32 v26, v25, v24, s42
 v_perm_b32 v27, v25, v24, s43
 v_accvgpr_write_b32 a37, v26
 v_accvgpr_write_b32 a45, v27
 v_accvgpr_read_b32 v24, a38
 v_accvgpr_read_b32 v25, a46
 v_perm_b32 v26, v25, v24, s42
 v_perm_b32 v27, v25, v24, s43
 v_accvgpr_write_b32 a38, v26
 v_accvgpr_write_b32 a46, v27
 v_accvgpr_read_b32 v24, a39
 v_accvgpr_read_b32 v25, a47
 v_perm_b32 v26, v25, v24, s42
 v_perm_b32 v27, v25, v24, s43
 v_accvgpr_write_b32 a39, v26
 v_accvgpr_write_b32 a47, v27
 s_waitcnt vmcnt(32)
 s_add_u32 s37, s36, 262144
 buffer_load_dword a96, v28, s[8:11], s37 offen nt
 s_add_u32 s37, s36, 270336
 buffer_load_dword a112, v28, s[8:11], s37 offen nt
 s_add_u32 s37, s36, 278528
 buffer_load_dword a97, v28, s[8:11], s37 offen nt
 s_add_u32 s37, s36, 286720
 buffer_load_dword a113, v28, s[8:11], s37 offen nt
 s_add_u32 s37, s36, 294912
 buffer_load_dword a98, v28, s[8:11], s37 offen nt
 s_add_u32 s37, s36, 303104
 buffer_load_dword a114, v28, s[8:11], s37 offen nt
 s_add_u32 s37, s36, 311296
 buffer_load_dword a99, v28, s[8:11], s37 offen nt
 s_add_u32 s37, s36, 319488
 buffer_load_dword a115, v28, s[8:11], s37 offen nt
 s_add_u32 s37, s36, 1310720
 buffer_load_dword a100, v28, s[8:11], s37 offen nt
 s_add_u32 s37, s36, 1318912
 buffer_load_dword a116, v28, s[8:11], s37 offen nt
 s_add_u32 s37, s36, 1327104
 buffer_load_dword a101, v28, s[8:11], s37 offen nt
 s_add_u32 s37, s36, 1335296
 buffer_load_dword a117, v28, s[8:11], s37 offen nt
 s_add_u32 s37, s36, 1343488
 buffer_load_dword a102, v28, s[8:11], s37 offen nt
 s_add_u32 s37, s36, 1351680
 buffer_load_dword a118, v28, s[8:11], s37 offen nt
 s_add_u32 s37, s36, 1359872
 buffer_load_dword a103, v28, s[8:11], s37 offen nt
 s_add_u32 s37, s36, 1368064
 buffer_load_dword a119, v28, s[8:11], s37 offen nt
 v_accvgpr_read_b32 v24, a48
 v_accvgpr_read_b32 v25, a64
 v_perm_b32 v26, v25, v24, s42
 v_perm_b32 v27, v25, v24, s43
 v_accvgpr_write_b32 a48, v26
 v_accvgpr_write_b32 a64, v27
 v_accvgpr_read_b32 v24, a49
 v_accvgpr_read_b32 v25, a65
 v_perm_b32 v26, v25, v24, s42
 v_perm_b32 v27, v25, v24, s43
 v_accvgpr_write_b32 a49, v26
 v_accvgpr_write_b32 a65, v27
 v_accvgpr_read_b32 v24, a50
 v_accvgpr_read_b32 v25, a66
 v_perm_b32 v26, v25, v24, s42
 v_perm_b32 v27, v25, v24, s43
 v_accvgpr_write_b32 a50, v26
 v_accvgpr_write_b32 a66, v27
 v_accvgpr_read_b32 v24, a51
 v_accvgpr_read_b32 v25, a67
 v_perm_b32 v26, v25, v24, s42
 v_perm_b32 v27, v25, v24, s43
 v_accvgpr_write_b32 a51, v26
 v_accvgpr_write_b32 a67, v27
 v_accvgpr_read_b32 v24, a52
 v_accvgpr_read_b32 v25, a68
 v_perm_b32 v26, v25, v24, s42
 v_perm_b32 v27, v25, v24, s43
 v_accvgpr_write_b32 a52, v26
 v_accvgpr_write_b32 a68, v27
 v_accvgpr_read_b32 v24, a53
 v_accvgpr_read_b32 v25, a69
 v_perm_b32 v26, v25, v24, s42
 v_perm_b32 v27, v25, v24, s43
 v_accvgpr_write_b32 a53, v26
 v_accvgpr_write_b32 a69, v27
 v_accvgpr_read_b32 v24, a54
 v_accvgpr_read_b32 v25, a70
 v_perm_b32 v26, v25, v24, s42
 v_perm_b32 v27, v25, v24, s43
 v_accvgpr_write_b32 a54, v26
 v_accvgpr_write_b32 a70, v27
 v_accvgpr_read_b32 v24, a55
 v_accvgpr_read_b32 v25, a71
 v_perm_b32 v26, v25, v24, s42
 v_perm_b32 v27, v25, v24, s43
 v_accvgpr_write_b32 a55, v26
 v_accvgpr_write_b32 a71, v27
 s_waitcnt vmcnt(32)
 s_add_u32 s37, s36, 262144
 buffer_load_dword a104, v28, s[24:27], s37 offen nt
 s_add_u32 s37, s36, 270336
 buffer_load_dword a120, v28, s[24:27], s37 offen nt
 s_add_u32 s37, s36, 278528
 buffer_load_dword a105, v28, s[24:27], s37 offen nt
 s_add_u32 s37, s36, 286720
 buffer_load_dword a121, v28, s[24:27], s37 offen nt
 s_add_u32 s37, s36, 294912
 buffer_load_dword a106, v28, s[24:27], s37 offen nt
 s_add_u32 s37, s36, 303104
 buffer_load_dword a122, v28, s[24:27], s37 offen nt
 s_add_u32 s37, s36, 311296
 buffer_load_dword a107, v28, s[24:27], s37 offen nt
 s_add_u32 s37, s36, 319488
 buffer_load_dword a123, v28, s[24:27], s37 offen nt
 s_add_u32 s37, s36, 1310720
 buffer_load_dword a108, v28, s[24:27], s37 offen nt
 s_add_u32 s37, s36, 1318912
 buffer_load_dword a124, v28, s[24:27], s37 offen nt
 s_add_u32 s37, s36, 1327104
 buffer_load_dword a109, v28, s[24:27], s37 offen nt
 s_add_u32 s37, s36, 1335296
 buffer_load_dword a125, v28, s[24:27], s37 offen nt
 s_add_u32 s37, s36, 1343488
 buffer_load_dword a110, v28, s[24:27], s37 offen nt
 s_add_u32 s37, s36, 1351680
 buffer_load_dword a126, v28, s[24:27], s37 offen nt
 s_add_u32 s37, s36, 1359872
 buffer_load_dword a111, v28, s[24:27], s37 offen nt
 s_add_u32 s37, s36, 1368064
 buffer_load_dword a127, v28, s[24:27], s37 offen nt
 v_accvgpr_read_b32 v24, a56
 v_accvgpr_read_b32 v25, a72
 v_perm_b32 v26, v25, v24, s42
 v_perm_b32 v27, v25, v24, s43
 v_accvgpr_write_b32 a56, v26
 v_accvgpr_write_b32 a72, v27
 v_accvgpr_read_b32 v24, a57
 v_accvgpr_read_b32 v25, a73
 v_perm_b32 v26, v25, v24, s42
 v_perm_b32 v27, v25, v24, s43
 v_accvgpr_write_b32 a57, v26
 v_accvgpr_write_b32 a73, v27
 v_accvgpr_read_b32 v24, a58
 v_accvgpr_read_b32 v25, a74
 v_perm_b32 v26, v25, v24, s42
 v_perm_b32 v27, v25, v24, s43
 v_accvgpr_write_b32 a58, v26
 v_accvgpr_write_b32 a74, v27
 v_accvgpr_read_b32 v24, a59
 v_accvgpr_read_b32 v25, a75
 v_perm_b32 v26, v25, v24, s42
 v_perm_b32 v27, v25, v24, s43
 v_accvgpr_write_b32 a59, v26
 v_accvgpr_write_b32 a75, v27
 v_accvgpr_read_b32 v24, a60
 v_accvgpr_read_b32 v25, a76
 v_perm_b32 v26, v25, v24, s42
 v_perm_b32 v27, v25, v24, s43
 v_accvgpr_write_b32 a60, v26
 v_accvgpr_write_b32 a76, v27
 v_accvgpr_read_b32 v24, a61
 v_accvgpr_read_b32 v25, a77
 v_perm_b32 v26, v25, v24, s42
 v_perm_b32 v27, v25, v24, s43
 v_accvgpr_write_b32 a61, v26
 v_accvgpr_write_b32 a77, v27
 v_accvgpr_read_b32 v24, a62
 v_accvgpr_read_b32 v25, a78
 v_perm_b32 v26, v25, v24, s42
 v_perm_b32 v27, v25, v24, s43
 v_accvgpr_write_b32 a62, v26
 v_accvgpr_write_b32 a78, v27
 v_accvgpr_read_b32 v24, a63
 v_accvgpr_read_b32 v25, a79
 v_perm_b32 v26, v25, v24, s42
 v_perm_b32 v27, v25, v24, s43
 v_accvgpr_write_b32 a63, v26
 v_accvgpr_write_b32 a79, v27
 s_waitcnt vmcnt(32)
 s_add_u32 s37, s36, 262144
 buffer_load_dword v64, v28, s[28:31], s37 offen nt
 s_add_u32 s37, s36, 270336
 buffer_load_dword v72, v28, s[28:31], s37 offen nt
 s_add_u32 s37, s36, 278528
 buffer_load_dword v65, v28, s[28:31], s37 offen nt
 s_add_u32 s37, s36, 286720
 buffer_load_dword v73, v28, s[28:31], s37 offen nt
 s_add_u32 s37, s36, 294912
 buffer_load_dword v66, v28, s[28:31], s37 offen nt
 s_add_u32 s37, s36, 303104
 buffer_load_dword v74, v28, s[28:31], s37 offen nt
 s_add_u32 s37, s36, 311296
 buffer_load_dword v67, v28, s[28:31], s37 offen nt
 s_add_u32 s37, s36, 319488
 buffer_load_dword v75, v28, s[28:31], s37 offen nt
 s_add_u32 s37, s36, 1310720
 buffer_load_dword v68, v28, s[28:31], s37 offen nt
 s_add_u32 s37, s36, 1318912
 buffer_load_dword v76, v28, s[28:31], s37 offen nt
 s_add_u32 s37, s36, 1327104
 buffer_load_dword v69, v28, s[28:31], s37 offen nt
 s_add_u32 s37, s36, 1335296
 buffer_load_dword v77, v28, s[28:31], s37 offen nt
 s_add_u32 s37, s36, 1343488
 buffer_load_dword v70, v28, s[28:31], s37 offen nt
 s_add_u32 s37, s36, 1351680
 buffer_load_dword v78, v28, s[28:31], s37 offen nt
 s_add_u32 s37, s36, 1359872
 buffer_load_dword v71, v28, s[28:31], s37 offen nt
 s_add_u32 s37, s36, 1368064
 buffer_load_dword v79, v28, s[28:31], s37 offen nt
 v_accvgpr_read_b32 v24, a80
 v_accvgpr_read_b32 v25, a88
 v_perm_b32 v26, v25, v24, s42
 v_perm_b32 v27, v25, v24, s43
 v_accvgpr_write_b32 a80, v26
 v_accvgpr_write_b32 a88, v27
 v_accvgpr_read_b32 v24, a81
 v_accvgpr_read_b32 v25, a89
 v_perm_b32 v26, v25, v24, s42
 v_perm_b32 v27, v25, v24, s43
 v_accvgpr_write_b32 a81, v26
 v_accvgpr_write_b32 a89, v27
 v_accvgpr_read_b32 v24, a82
 v_accvgpr_read_b32 v25, a90
 v_perm_b32 v26, v25, v24, s42
 v_perm_b32 v27, v25, v24, s43
 v_accvgpr_write_b32 a82, v26
 v_accvgpr_write_b32 a90, v27
 v_accvgpr_read_b32 v24, a83
 v_accvgpr_read_b32 v25, a91
 v_perm_b32 v26, v25, v24, s42
 v_perm_b32 v27, v25, v24, s43
 v_accvgpr_write_b32 a83, v26
 v_accvgpr_write_b32 a91, v27
 v_accvgpr_read_b32 v24, a84
 v_accvgpr_read_b32 v25, a92
 v_perm_b32 v26, v25, v24, s42
 v_perm_b32 v27, v25, v24, s43
 v_accvgpr_write_b32 a84, v26
 v_accvgpr_write_b32 a92, v27
 v_accvgpr_read_b32 v24, a85
 v_accvgpr_read_b32 v25, a93
 v_perm_b32 v26, v25, v24, s42
 v_perm_b32 v27, v25, v24, s43
 v_accvgpr_write_b32 a85, v26
 v_accvgpr_write_b32 a93, v27
 v_accvgpr_read_b32 v24, a86
 v_accvgpr_read_b32 v25, a94
 v_perm_b32 v26, v25, v24, s42
 v_perm_b32 v27, v25, v24, s43
 v_accvgpr_write_b32 a86, v26
 v_accvgpr_write_b32 a94, v27
 v_accvgpr_read_b32 v24, a87
 v_accvgpr_read_b32 v25, a95
 v_perm_b32 v26, v25, v24, s42
 v_perm_b32 v27, v25, v24, s43
 v_accvgpr_write_b32 a87, v26
 v_accvgpr_write_b32 a95, v27
 s_waitcnt vmcnt(32)
 s_add_u32 s37, s36, 393216
 buffer_load_dword v80, v28, s[8:11], s37 offen nt
 s_add_u32 s37, s36, 401408
 buffer_load_dword v96, v28, s[8:11], s37 offen nt
 s_add_u32 s37, s36, 409600
 buffer_load_dword v81, v28, s[8:11], s37 offen nt
 s_add_u32 s37, s36, 417792
 buffer_load_dword v97, v28, s[8:11], s37 offen nt
 s_add_u32 s37, s36, 425984
 buffer_load_dword v82, v28, s[8:11], s37 offen nt
 s_add_u32 s37, s36, 434176
 buffer_load_dword v98, v28, s[8:11], s37 offen nt
 s_add_u32 s37, s36, 442368
 buffer_load_dword v83, v28, s[8:11], s37 offen nt
 s_add_u32 s37, s36, 450560
 buffer_load_dword v99, v28, s[8:11], s37 offen nt
 s_add_u32 s37, s36, 1441792
 buffer_load_dword v84, v28, s[8:11], s37 offen nt
 s_add_u32 s37, s36, 1449984
 buffer_load_dword v100, v28, s[8:11], s37 offen nt
 s_add_u32 s37, s36, 1458176
 buffer_load_dword v85, v28, s[8:11], s37 offen nt
 s_add_u32 s37, s36, 1466368
 buffer_load_dword v101, v28, s[8:11], s37 offen nt
 s_add_u32 s37, s36, 1474560
 buffer_load_dword v86, v28, s[8:11], s37 offen nt
 s_add_u32 s37, s36, 1482752
 buffer_load_dword v102, v28, s[8:11], s37 offen nt
 s_add_u32 s37, s36, 1490944
 buffer_load_dword v87, v28, s[8:11], s37 offen nt
 s_add_u32 s37, s36, 1499136
 buffer_load_dword v103, v28, s[8:11], s37 offen nt
 v_accvgpr_read_b32 v24, a96
 v_accvgpr_read_b32 v25, a112
 v_perm_b32 v26, v25, v24, s42
 v_perm_b32 v27, v25, v24, s43
 v_accvgpr_write_b32 a96, v26
 v_accvgpr_write_b32 a112, v27
 v_accvgpr_read_b32 v24, a97
 v_accvgpr_read_b32 v25, a113
 v_perm_b32 v26, v25, v24, s42
 v_perm_b32 v27, v25, v24, s43
 v_accvgpr_write_b32 a97, v26
 v_accvgpr_write_b32 a113, v27
 v_accvgpr_read_b32 v24, a98
 v_accvgpr_read_b32 v25, a114
 v_perm_b32 v26, v25, v24, s42
 v_perm_b32 v27, v25, v24, s43
 v_accvgpr_write_b32 a98, v26
 v_accvgpr_write_b32 a114, v27
 v_accvgpr_read_b32 v24, a99
 v_accvgpr_read_b32 v25, a115
 v_perm_b32 v26, v25, v24, s42
 v_perm_b32 v27, v25, v24, s43
 v_accvgpr_write_b32 a99, v26
 v_accvgpr_write_b32 a115, v27
 v_accvgpr_read_b32 v24, a100
 v_accvgpr_read_b32 v25, a116
 v_perm_b32 v26, v25, v24, s42
 v_perm_b32 v27, v25, v24, s43
 v_accvgpr_write_b32 a100, v26
 v_accvgpr_write_b32 a116, v27
 v_accvgpr_read_b32 v24, a101
 v_accvgpr_read_b32 v25, a117
 v_perm_b32 v26, v25, v24, s42
 v_perm_b32 v27, v25, v24, s43
 v_accvgpr_write_b32 a101, v26
 v_accvgpr_write_b32 a117, v27
 v_accvgpr_read_b32 v24, a102
 v_accvgpr_read_b32 v25, a118
 v_perm_b32 v26, v25, v24, s42
 v_perm_b32 v27, v25, v24, s43
 v_accvgpr_write_b32 a102, v26
 v_accvgpr_write_b32 a118, v27
 v_accvgpr_read_b32 v24, a103
 v_accvgpr_read_b32 v25, a119
 v_perm_b32 v26, v25, v24, s42
 v_perm_b32 v27, v25, v24, s43
 v_accvgpr_write_b32 a103, v26
 v_accvgpr_write_b32 a119, v27
 s_waitcnt vmcnt(32)
 s_add_u32 s37, s36, 393216
 buffer_load_dword v88, v28, s[24:27], s37 offen nt
 s_add_u32 s37, s36, 401408
 buffer_load_dword v104, v28, s[24:27], s37 offen nt
 s_add_u32 s37, s36, 409600
 buffer_load_dword v89, v28, s[24:27], s37 offen nt
 s_add_u32 s37, s36, 417792
 buffer_load_dword v105, v28, s[24:27], s37 offen nt
 s_add_u32 s37, s36, 425984
 buffer_load_dword v90, v28, s[24:27], s37 offen nt
 s_add_u32 s37, s36, 434176
 buffer_load_dword v106, v28, s[24:27], s37 offen nt
 s_add_u32 s37, s36, 442368
 buffer_load_dword v91, v28, s[24:27], s37 offen nt
 s_add_u32 s37, s36, 450560
 buffer_load_dword v107, v28, s[24:27], s37 offen nt
 s_add_u32 s37, s36, 1441792
 buffer_load_dword v92, v28, s[24:27], s37 offen nt
 s_add_u32 s37, s36, 1449984
 buffer_load_dword v108, v28, s[24:27], s37 offen nt
 s_add_u32 s37, s36, 1458176
 buffer_load_dword v93, v28, s[24:27], s37 offen nt
 s_add_u32 s37, s36, 1466368
 buffer_load_dword v109, v28, s[24:27], s37 offen nt
 s_add_u32 s37, s36, 1474560
 buffer_load_dword v94, v28, s[24:27], s37 offen nt
 s_add_u32 s37, s36, 1482752
 buffer_load_dword v110, v28, s[24:27], s37 offen nt
 s_add_u32 s37, s36, 1490944
 buffer_load_dword v95, v28, s[24:27], s37 offen nt
 s_add_u32 s37, s36, 1499136
 buffer_load_dword v111, v28, s[24:27], s37 offen nt
 v_accvgpr_read_b32 v24, a104
 v_accvgpr_read_b32 v25, a120
 v_perm_b32 v26, v25, v24, s42
 v_perm_b32 v27, v25, v24, s43
 v_accvgpr_write_b32 a104, v26
 v_accvgpr_write_b32 a120, v27
 v_accvgpr_read_b32 v24, a105
 v_accvgpr_read_b32 v25, a121
 v_perm_b32 v26, v25, v24, s42
 v_perm_b32 v27, v25, v24, s43
 v_accvgpr_write_b32 a105, v26
 v_accvgpr_write_b32 a121, v27
 v_accvgpr_read_b32 v24, a106
 v_accvgpr_read_b32 v25, a122
 v_perm_b32 v26, v25, v24, s42
 v_perm_b32 v27, v25, v24, s43
 v_accvgpr_write_b32 a106, v26
 v_accvgpr_write_b32 a122, v27
 v_accvgpr_read_b32 v24, a107
 v_accvgpr_read_b32 v25, a123
 v_perm_b32 v26, v25, v24, s42
 v_perm_b32 v27, v25, v24, s43
 v_accvgpr_write_b32 a107, v26
 v_accvgpr_write_b32 a123, v27
 v_accvgpr_read_b32 v24, a108
 v_accvgpr_read_b32 v25, a124
 v_perm_b32 v26, v25, v24, s42
 v_perm_b32 v27, v25, v24, s43
 v_accvgpr_write_b32 a108, v26
 v_accvgpr_write_b32 a124, v27
 v_accvgpr_read_b32 v24, a109
 v_accvgpr_read_b32 v25, a125
 v_perm_b32 v26, v25, v24, s42
 v_perm_b32 v27, v25, v24, s43
 v_accvgpr_write_b32 a109, v26
 v_accvgpr_write_b32 a125, v27
 v_accvgpr_read_b32 v24, a110
 v_accvgpr_read_b32 v25, a126
 v_perm_b32 v26, v25, v24, s42
 v_perm_b32 v27, v25, v24, s43
 v_accvgpr_write_b32 a110, v26
 v_accvgpr_write_b32 a126, v27
 v_accvgpr_read_b32 v24, a111
 v_accvgpr_read_b32 v25, a127
 v_perm_b32 v26, v25, v24, s42
 v_perm_b32 v27, v25, v24, s43
 v_accvgpr_write_b32 a111, v26
 v_accvgpr_write_b32 a127, v27
 s_waitcnt vmcnt(32)
 s_add_u32 s37, s36, 393216
 buffer_load_dword v112, v28, s[28:31], s37 offen nt
 s_add_u32 s37, s36, 401408
 buffer_load_dword v120, v28, s[28:31], s37 offen nt
 s_add_u32 s37, s36, 409600
 buffer_load_dword v113, v28, s[28:31], s37 offen nt
 s_add_u32 s37, s36, 417792
 buffer_load_dword v121, v28, s[28:31], s37 offen nt
 s_add_u32 s37, s36, 425984
 buffer_load_dword v114, v28, s[28:31], s37 offen nt
 s_add_u32 s37, s36, 434176
 buffer_load_dword v122, v28, s[28:31], s37 offen nt
 s_add_u32 s37, s36, 442368
 buffer_load_dword v115, v28, s[28:31], s37 offen nt
 s_add_u32 s37, s36, 450560
 buffer_load_dword v123, v28, s[28:31], s37 offen nt
 s_add_u32 s37, s36, 1441792
 buffer_load_dword v116, v28, s[28:31], s37 offen nt
 s_add_u32 s37, s36, 1449984
 buffer_load_dword v124, v28, s[28:31], s37 offen nt
 s_add_u32 s37, s36, 1458176
 buffer_load_dword v117, v28, s[28:31], s37 offen nt
 s_add_u32 s37, s36, 1466368
 buffer_load_dword v125, v28, s[28:31], s37 offen nt
 s_add_u32 s37, s36, 1474560
 buffer_load_dword v118, v28, s[28:31], s37 offen nt
 s_add_u32 s37, s36, 1482752
 buffer_load_dword v126, v28, s[28:31], s37 offen nt
 s_add_u32 s37, s36, 1490944
 buffer_load_dword v119, v28, s[28:31], s37 offen nt
 s_add_u32 s37, s36, 1499136
 buffer_load_dword v127, v28, s[28:31], s37 offen nt
 v_perm_b32 v26, v72, v64, s42
 v_perm_b32 v27, v72, v64, s43
 v_mov_b32 v64, v26
 v_mov_b32 v72, v27
 v_perm_b32 v26, v73, v65, s42
 v_perm_b32 v27, v73, v65, s43
 v_mov_b32 v65, v26
 v_mov_b32 v73, v27
 v_perm_b32 v26, v74, v66, s42
 v_perm_b32 v27, v74, v66, s43
 v_mov_b32 v66, v26
 v_mov_b32 v74, v27
 v_perm_b32 v26, v75, v67, s42
 v_perm_b32 v27, v75, v67, s43
 v_mov_b32 v67, v26
 v_mov_b32 v75, v27
 v_perm_b32 v26, v76, v68, s42
 v_perm_b32 v27, v76, v68, s43
 v_mov_b32 v68, v26
 v_mov_b32 v76, v27
 v_perm_b32 v26, v77, v69, s42
 v_perm_b32 v27, v77, v69, s43
 v_mov_b32 v69, v26
 v_mov_b32 v77, v27
 v_perm_b32 v26, v78, v70, s42
 v_perm_b32 v27, v78, v70, s43
 v_mov_b32 v70, v26
 v_mov_b32 v78, v27
 v_perm_b32 v26, v79, v71, s42
 v_perm_b32 v27, v79, v71, s43
 v_mov_b32 v71, v26
 v_mov_b32 v79, v27
 s_waitcnt vmcnt(32)
 buffer_load_dword v8, v29, s[32:35], s38 offen offset:0
 buffer_load_dword v9, v29, s[32:35], s38 offen offset:8
 buffer_load_dword v10, v29, s[32:35], s38 offen offset:16
 buffer_load_dword v11, v29, s[32:35], s38 offen offset:24
 buffer_load_dword v12, v29, s[32:35], s38 offen offset:32
 buffer_load_dword v13, v29, s[32:35], s38 offen offset:40
 buffer_load_dword v14, v29, s[32:35], s38 offen offset:48
 buffer_load_dword v15, v29, s[32:35], s38 offen offset:56
 buffer_load_dword v16, v29, s[32:35], s38 offen offset:64
 buffer_load_dword v17, v29, s[32:35], s38 offen offset:72
 buffer_load_dword v18, v29, s[32:35], s38 offen offset:80
 buffer_load_dword v19, v29, s[32:35], s38 offen offset:88
 buffer_load_dword v20, v29, s[32:35], s38 offen offset:96
 buffer_load_dword v21, v29, s[32:35], s38 offen offset:104
 buffer_load_dword v22, v29, s[32:35], s38 offen offset:112
 buffer_load_dword v23, v29, s[32:35], s38 offen offset:120
 v_perm_b32 v26, v96, v80, s42
 v_perm_b32 v27, v96, v80, s43
 v_mov_b32 v80, v26
 v_mov_b32 v96, v27
 v_perm_b32 v26, v97, v81, s42
 v_perm_b32 v27, v97, v81, s43
 v_mov_b32 v81, v26
 v_mov_b32 v97, v27
 v_perm_b32 v26, v98, v82, s42
 v_perm_b32 v27, v98, v82, s43
 v_mov_b32 v82, v26
 v_mov_b32 v98, v27
 v_perm_b32 v26, v99, v83, s42
 v_perm_b32 v27, v99, v83, s43
 v_mov_b32 v83, v26
 v_mov_b32 v99, v27
 v_perm_b32 v26, v100, v84, s42
 v_perm_b32 v27, v100, v84, s43
 v_mov_b32 v84, v26
 v_mov_b32 v100, v27
 v_perm_b32 v26, v101, v85, s42
 v_perm_b32 v27, v101, v85, s43
 v_mov_b32 v85, v26
 v_mov_b32 v101, v27
 v_perm_b32 v26, v102, v86, s42
 v_perm_b32 v27, v102, v86, s43
 v_mov_b32 v86, v26
 v_mov_b32 v102, v27
 v_perm_b32 v26, v103, v87, s42
 v_perm_b32 v27, v103, v87, s43
 v_mov_b32 v87, v26
 v_mov_b32 v103, v27
 s_waitcnt vmcnt(32)
 v_perm_b32 v26, v104, v88, s42
 v_perm_b32 v27, v104, v88, s43
 v_mov_b32 v88, v26
 v_mov_b32 v104, v27
 v_perm_b32 v26, v105, v89, s42
 v_perm_b32 v27, v105, v89, s43
 v_mov_b32 v89, v26
 v_mov_b32 v105, v27
 v_perm_b32 v26, v106, v90, s42
 v_perm_b32 v27, v106, v90, s43
 v_mov_b32 v90, v26
 v_mov_b32 v106, v27
 v_perm_b32 v26, v107, v91, s42
 v_perm_b32 v27, v107, v91, s43
 v_mov_b32 v91, v26
 v_mov_b32 v107, v27
 v_perm_b32 v26, v108, v92, s42
 v_perm_b32 v27, v108, v92, s43
 v_mov_b32 v92, v26
 v_mov_b32 v108, v27
 v_perm_b32 v26, v109, v93, s42
 v_perm_b32 v27, v109, v93, s43
 v_mov_b32 v93, v26
 v_mov_b32 v109, v27
 v_perm_b32 v26, v110, v94, s42
 v_perm_b32 v27, v110, v94, s43
 v_mov_b32 v94, v26
 v_mov_b32 v110, v27
 v_perm_b32 v26, v111, v95, s42
 v_perm_b32 v27, v111, v95, s43
 v_mov_b32 v95, v26
 v_mov_b32 v111, v27
 s_waitcnt vmcnt(16)
 v_perm_b32 v26, v120, v112, s42
 v_perm_b32 v27, v120, v112, s43
 v_mov_b32 v112, v26
 v_mov_b32 v120, v27
 v_perm_b32 v26, v121, v113, s42
 v_perm_b32 v27, v121, v113, s43
 v_mov_b32 v113, v26
 v_mov_b32 v121, v27
 v_perm_b32 v26, v122, v114, s42
 v_perm_b32 v27, v122, v114, s43
 v_mov_b32 v114, v26
 v_mov_b32 v122, v27
 v_perm_b32 v26, v123, v115, s42
 v_perm_b32 v27, v123, v115, s43
 v_mov_b32 v115, v26
 v_mov_b32 v123, v27
 v_perm_b32 v26, v124, v116, s42
 v_perm_b32 v27, v124, v116, s43
 v_mov_b32 v116, v26
 v_mov_b32 v124, v27
 v_perm_b32 v26, v125, v117, s42
 v_perm_b32 v27, v125, v117, s43
 v_mov_b32 v117, v26
 v_mov_b32 v125, v27
 v_perm_b32 v26, v126, v118, s42
 v_perm_b32 v27, v126, v118, s43
 v_mov_b32 v118, v26
 v_mov_b32 v126, v27
 v_perm_b32 v26, v127, v119, s42
 v_perm_b32 v27, v127, v119, s43
 v_mov_b32 v119, v26
 v_mov_b32 v127, v27
 v_mov_b32 v25, 24576
L_lwg:
 s_sleep 1
 ds_read_b32 v24, v25 offset:32
 s_add_u32 s60, s60, 2
 s_cmp_gt_u32 s60, 134217728
 s_cbranch_scc1 L_end
 s_waitcnt lgkmcnt(0)
 v_readfirstlane_b32 s59, v24
 s_cmp_eq_u32 s59, -1
 s_cbranch_scc1 L_lwg
 s_mov_b32 s45, 0
 s_add_u32 s57, s57, s59
 s_setprio 2
 s_cmp_lg_u32 s14, 0
 s_cbranch_scc1 L_Gq0
 buffer_load_dwordx4 v[48:51], v58, s[4:7], 0 offen sc1
 buffer_load_dwordx4 v[52:55], v58, s[4:7], 0 offen offset:128 sc1
L_Gq0:
 s_cmp_lg_u32 s14, 3
 s_cbranch_scc1 L_Gq1
 buffer_load_dwordx4 v[48:51], v58, s[4:7], 0 offen sc1
 buffer_load_dwordx4 v[52:55], v58, s[4:7], 0 offen offset:256 sc1
L_Gq1:
 v_mov_b64 v[24:25], 0
 v_mov_b64 v[26:27], 0
 v_mov_b64 v[28:29], 0
 v_mov_b64 v[30:31], 0
 v_mov_b64 v[32:33], 0
 v_mov_b64 v[34:35], 0
 v_mov_b64 v[36:37], 0
 v_mov_b64 v[38:39], 0
 v_mov_b64 v[40:41], 0
 v_mov_b64 v[42:43], 0
 v_mov_b64 v[44:45], 0
 v_mov_b64 v[46:47], 0
 s_waitcnt vmcnt(0)
 v_smfmac_f32_16x16x64_bf16 v[24:27], v[8:11], a[0:7], v3
 v_smfmac_f32_16x16x64_bf16 v[28:31], v[8:11], a[8:15], v3
 v_smfmac_f32_16x16x64_bf16 v[32:35], v[8:11], a[16:23], v3
 v_smfmac_f32_16x16x64_bf16 v[36:39], v[8:11], a[24:31], v3
 v_smfmac_f32_16x16x64_bf16 v[40:43], v[8:11], a[32:39], v3
 v_smfmac_f32_16x16x64_bf16 v[44:47], v[8:11], a[40:47], v3
 v_smfmac_f32_16x16x64_bf16 v[24:27], v[12:15], a[48:55], v3
 v_smfmac_f32_16x16x64_bf16 v[28:31], v[12:15], a[56:63], v3
 v_smfmac_f32_16x16x64_bf16 v[32:35], v[12:15], a[64:71], v3
 v_smfmac_f32_16x16x64_bf16 v[36:39], v[12:15], a[72:79], v3
 v_smfmac_f32_16x16x64_bf16 v[40:43], v[12:15], a[80:87], v3
 v_smfmac_f32_16x16x64_bf16 v[44:47], v[12:15], a[88:95], v3
 v_smfmac_f32_16x16x64_bf16 v[24:27], v[16:19], a[96:103], v3
 v_smfmac_f32_16x16x64_bf16 v[28:31], v[16:19], a[104:111], v3
 v_smfmac_f32_16x16x64_bf16 v[32:35], v[16:19], a[112:119], v3
 v_smfmac_f32_16x16x64_bf16 v[36:39], v[16:19], a[120:127], v3
 v_smfmac_f32_16x16x64_bf16 v[40:43], v[16:19], v[64:71], v3
 v_smfmac_f32_16x16x64_bf16 v[44:47], v[16:19], v[72:79], v3
 v_smfmac_f32_16x16x64_bf16 v[24:27], v[20:23], v[80:87], v3
 v_smfmac_f32_16x16x64_bf16 v[28:31], v[20:23], v[88:95], v3
 v_smfmac_f32_16x16x64_bf16 v[32:35], v[20:23], v[96:103], v3
 v_smfmac_f32_16x16x64_bf16 v[36:39], v[20:23], v[104:111], v3
 v_smfmac_f32_16x16x64_bf16 v[40:43], v[20:23], v[112:119], v3
 v_smfmac_f32_16x16x64_bf16 v[44:47], v[20:23], v[120:127], v3
 s_branch L_Gqd
L_Gloop:
 s_cmp_lg_u32 s14, 2
 s_cbranch_scc1 L_Gz
 ds_read2st64_b32 v[8:9], v49 offset0:0 offset1:10
 ds_read_b128 v[16:19], v50
 ds_read2st64_b32 v[10:11], v49 offset0:20 offset1:30
 s_waitcnt lgkmcnt(1)
 v_mul_f32 v8, v8, v16
 v_fmac_f32 v8, v9, v17
 s_waitcnt lgkmcnt(0)
 v_fmac_f32 v8, v10, v18
 v_fmac_f32 v8, v11, v19
 s_nop 1
 v_mov_b32_dpp v9, v8 quad_perm:[1,1,3,3] row_mask:0xf bank_mask:0xf
 v_cvt_pk_bf16_f32 v8, v8, v9
 v_cndmask_b32 v8, v8, 1.0, s[52:53]
 s_mov_b64 exec, 0xffff
 buffer_atomic_pk_add_bf16 v8, v51, s[4:7], s47 offen offset:384 sc1
 s_mov_b64 exec, -1
 s_branch L_Gz2
L_Gz:
 s_sleep 6
L_Gz2:
 v_mov_b64 v[24:25], 0
 v_mov_b64 v[26:27], 0
 v_mov_b64 v[28:29], 0
 v_mov_b64 v[30:31], 0
 v_mov_b64 v[32:33], 0
 v_mov_b64 v[34:35], 0
 v_mov_b64 v[36:37], 0
 v_mov_b64 v[38:39], 0
 v_mov_b64 v[40:41], 0
 v_mov_b64 v[42:43], 0
 v_mov_b64 v[44:45], 0
 v_mov_b64 v[46:47], 0
 s_sleep 9
L_Gis:
 buffer_load_dword v60, v2, s[4:7], s47 offen offset:384 sc1
 buffer_load_dwordx4 v[8:11], v1, s[4:7], s47 offen offset:0 sc1
 buffer_load_dwordx4 v[12:15], v1, s[4:7], s47 offen offset:512 sc1
 buffer_load_dwordx4 v[16:19], v1, s[4:7], s47 offen offset:1024 sc1
 buffer_load_dwordx4 v[20:23], v1, s[4:7], s47 offen offset:1536 sc1
 s_mov_b32 s56, 15
 s_waitcnt vmcnt(4)
L_Go:
 v_mov_b32_dpp v61, v60 quad_perm:[0,0,0,0] row_mask:0xf bank_mask:0xf
 v_mov_b32_dpp v62, v60 quad_perm:[2,2,2,2] row_mask:0xf bank_mask:0xf
 s_mov_b64 exec, s[84:85]
 v_cmp_gt_u32 vcc, s50, v60
 s_waitcnt vmcnt(3)
 s_cbranch_vccnz L_Gor
 v_cmp_gt_u32 vcc, s50, v11
 v_perm_b32 v11, v61, v11, s42
 s_nop 1
 v_smfmac_f32_16x16x64_bf16 v[24:27], v[8:11], a[0:7], v3
 v_smfmac_f32_16x16x64_bf16 v[28:31], v[8:11], a[8:15], v3
 s_cbranch_vccnz L_P0
 v_smfmac_f32_16x16x64_bf16 v[32:35], v[8:11], a[16:23], v3
 v_smfmac_f32_16x16x64_bf16 v[36:39], v[8:11], a[24:31], v3
 s_waitcnt vmcnt(2)
 v_cmp_gt_u32 vcc, s50, v15
 v_perm_b32 v15, v61, v15, s49
 v_smfmac_f32_16x16x64_bf16 v[40:43], v[8:11], a[32:39], v3
 v_smfmac_f32_16x16x64_bf16 v[44:47], v[8:11], a[40:47], v3
 v_smfmac_f32_16x16x64_bf16 v[24:27], v[12:15], a[48:55], v3
 v_smfmac_f32_16x16x64_bf16 v[28:31], v[12:15], a[56:63], v3
 s_cbranch_vccnz L_P1
 v_smfmac_f32_16x16x64_bf16 v[32:35], v[12:15], a[64:71], v3
 v_smfmac_f32_16x16x64_bf16 v[36:39], v[12:15], a[72:79], v3
 s_waitcnt vmcnt(1)
 v_cmp_gt_u32 vcc, s50, v19
 v_perm_b32 v19, v62, v19, s42
 v_smfmac_f32_16x16x64_bf16 v[40:43], v[12:15], a[80:87], v3
 v_smfmac_f32_16x16x64_bf16 v[44:47], v[12:15], a[88:95], v3
 v_smfmac_f32_16x16x64_bf16 v[24:27], v[16:19], a[96:103], v3
 v_smfmac_f32_16x16x64_bf16 v[28:31], v[16:19], a[104:111], v3
 s_cbranch_vccnz L_P2
 s_waitcnt vmcnt(0)
 v_cmp_gt_u32 vcc, s50, v23
 v_perm_b32 v23, v62, v23, s49
 s_mov_b64 exec, -1
 v_smfmac_f32_16x16x64_bf16 v[32:35], v[16:19], a[112:119], v3
 v_smfmac_f32_16x16x64_bf16 v[36:39], v[16:19], a[120:127], v3
 v_smfmac_f32_16x16x64_bf16 v[24:27], v[20:23], v[80:87], v3
 v_smfmac_f32_16x16x64_bf16 v[28:31], v[20:23], v[88:95], v3
 s_cbranch_vccnz L_P3
 v_smfmac_f32_16x16x64_bf16 v[32:35], v[20:23], v[96:103], v3
 v_smfmac_f32_16x16x64_bf16 v[36:39], v[20:23], v[104:111], v3
 v_permlane32_swap_b32 v24, v28
 v_permlane32_swap_b32 v25, v29
 v_smfmac_f32_16x16x64_bf16 v[40:43], v[16:19], v[64:71], v3
 v_permlane32_swap_b32 v26, v30
 v_permlane32_swap_b32 v27, v31
 v_smfmac_f32_16x16x64_bf16 v[44:47], v[16:19], v[72:79], v3
 v_add_f32 v24, v24, v28
 v_add_f32 v28, v26, v30
 v_smfmac_f32_16x16x64_bf16 v[40:43], v[20:23], v[112:119], v3
 v_add_f32 v26, v25, v29
 v_add_f32 v30, v27, v31
 v_smfmac_f32_16x16x64_bf16 v[44:47], v[20:23], v[120:127], v3
L_Gqe:
 v_permlane32_swap_b32 v32, v36
 v_permlane32_swap_b32 v33, v37
 v_permlane32_swap_b32 v34, v38
 v_permlane32_swap_b32 v35, v39
 v_add_f32 v25, v32, v36
 v_add_f32 v27, v33, v37
 ds_write2_b64 v4, v[24:25], v[26:27] offset0:0 offset1:52
 v_add_f32 v29, v34, v38
 v_add_f32 v31, v35, v39
 ds_write2_b64 v4, v[28:29], v[30:31] offset0:104 offset1:156
 v_permlane32_swap_b32 v40, v44
 v_permlane32_swap_b32 v41, v45
 v_permlane32_swap_b32 v42, v46
 v_permlane32_swap_b32 v43, v47
 v_add_f32 v40, v40, v44
 v_add_f32 v41, v41, v45
 ds_write2_b32 v5, v40, v41 offset0:0 offset1:104
 v_add_f32 v42, v42, v46
 v_add_f32 v43, v43, v47
 ds_write_b32 v5, v42 offset:832
 ds_write_b32 v5, v43 offset:1248
 s_cmp_lt_u32 s14, 2
 s_cbranch_scc0 L_GB23
 s_cmp_eq_u32 s14, 0
 s_cbranch_scc0 L_GB1
 s_waitcnt lgkmcnt(0)
 s_barrier
 ds_read_b128 v[24:27], v63 offset:7168
 ds_read_b128 v[28:31], v63 offset:7184
 ds_read_b128 v[32:35], v63 offset:10752
 ds_read_b128 v[36:39], v63 offset:10768
 ds_read_b128 v[8:11], v63 offset:0
 ds_read_b128 v[12:15], v63 offset:16
 ds_read_b128 v[16:19], v63 offset:3584
 ds_read_b128 v[20:23], v63 offset:3600
 s_waitcnt lgkmcnt(5)
 v_pk_add_f32 v[24:25], v[24:25], v[32:33]
 v_pk_add_f32 v[26:27], v[26:27], v[34:35]
 s_waitcnt lgkmcnt(4)
 v_pk_add_f32 v[28:29], v[28:29], v[36:37]
 v_pk_add_f32 v[30:31], v[30:31], v[38:39]
 s_waitcnt lgkmcnt(3)
 v_pk_add_f32 v[24:25], v[24:25], v[8:9]
 v_pk_add_f32 v[26:27], v[26:27], v[10:11]
 s_waitcnt lgkmcnt(2)
 v_pk_add_f32 v[28:29], v[28:29], v[12:13]
 v_pk_add_f32 v[30:31], v[30:31], v[14:15]
 s_waitcnt lgkmcnt(1)
 v_pk_add_f32 v[24:25], v[24:25], v[16:17]
 v_pk_add_f32 v[26:27], v[26:27], v[18:19]
 v_cvt_pk_bf16_f32 v40, v24, v25
 v_cvt_pk_bf16_f32 v41, v26, v27
 s_waitcnt lgkmcnt(0)
 v_pk_add_f32 v[28:29], v[28:29], v[20:21]
 v_pk_add_f32 v[30:31], v[30:31], v[22:23]
 v_cvt_pk_bf16_f32 v42, v28, v29
 v_cvt_pk_bf16_f32 v43, v30, v31
 s_nop 1
 v_mfma_f32_16x16x32_bf16 v[8:11], v[48:51], v[40:43], 0
 v_mfma_f32_16x16x32_bf16 v[12:15], v[52:55], v[40:43], 0
 v_mfma_f32_16x16x32_bf16 v[44:47], v[40:43], v[40:43], 0
 s_mov_b64 exec, s[52:53]
 v_cvt_pk_bf16_f32 v16, v8, v9
 v_cvt_pk_bf16_f32 v17, v10, v11
 v_min_u32 v16, s44, v16
 v_cvt_pk_bf16_f32 v18, v12, v13
 v_cvt_pk_bf16_f32 v19, v14, v15
 buffer_store_dwordx4 v[16:19], v56, s[4:7], s45 offen
 s_mov_b64 exec, s[54:55]
 v_cvt_pk_bf16_f32 v20, v44, v45
 v_cvt_pk_bf16_f32 v21, v46, v47
 v_min_u32 v20, s44, v20
 buffer_store_dwordx2 v[20:21], v59, s[4:7], s45 offen offset:512
 s_mov_b64 exec, -1
 s_branch L_Gtail
L_G123:
L_GB23:
 s_cmp_eq_u32 s14, 2
 s_cbranch_scc0 L_G3
 s_mov_b64 exec, 0xffff
 buffer_store_dword v54, v59, s[4:7], 0 offen
 s_mov_b64 exec, -1
 s_waitcnt lgkmcnt(0)
 s_barrier
 s_add_u32 s36, s15, 1
 v_mov_b32 v60, s36
 s_mov_b64 exec, 0xffff
 v_add_u32 v54, 1, v60
 s_add_u32 s86, s15, 3
 s_min_u32 s86, s86, 64
 s_cmp_ge_u32 s87, s86
 s_cbranch_scc1 L_G12
 s_mov_b32 exec_lo, 4160223223
 s_mov_b32 exec_hi, 0
 buffer_load_dword v52, v56, s[4:7], 0 offen sc1
L_G12:
 s_mov_b64 exec, -1
L_G13:
 s_branch L_Gtail
L_GB1:
 s_lshl_b32 s36, s15, 2
 s_add_u32 s36, s36, 4
 s_waitcnt lgkmcnt(0)
 s_barrier
L_Gv:
 ds_read2st64_b64 v[8:11], v63 offset0:0 offset1:7
 ds_read2st64_b64 v[12:15], v58 offset0:0 offset1:7
 ds_read2st64_b64 v[16:19], v63 offset0:14 offset1:21
 ds_read2st64_b64 v[20:23], v58 offset0:14 offset1:21
 s_waitcnt lgkmcnt(2)
 v_pk_add_f32 v[8:9], v[8:9], v[10:11]
 v_pk_add_f32 v[12:13], v[12:13], v[14:15]
 s_waitcnt lgkmcnt(0)
 v_pk_add_f32 v[16:17], v[16:17], v[18:19]
 v_pk_add_f32 v[20:21], v[20:21], v[22:23]
 v_pk_add_f32 v[8:9], v[8:9], v[16:17]
 v_pk_add_f32 v[12:13], v[12:13], v[20:21]
 v_cvt_pk_bf16_f32 v40, v8, v9
 v_cvt_pk_bf16_f32 v41, v12, v13
 v_min_u32 v40, s44, v40
 buffer_store_dwordx2 v[40:41], v56, s[4:7], s45 offen
L_Gtail:
 s_setprio 0
 v_add_u32 v45, 8704, v57
 v_add_u32 v46, 17408, v57
 v_add_u32 v47, 26112, v57
 ds_read_b128 v[40:43], v6 offset:256
 ds_read2_b64 v[8:11], v57 offset0:0 offset1:2
 ds_read2_b64 v[12:15], v57 offset0:4 offset1:6
 ds_read2_b64 v[16:19], v45 offset0:0 offset1:2
 ds_read2_b64 v[20:23], v45 offset0:4 offset1:6
 ds_read2_b64 v[24:27], v46 offset0:0 offset1:2
 ds_read2_b64 v[28:31], v46 offset0:4 offset1:6
 ds_read2_b64 v[32:35], v47 offset0:0 offset1:2
 ds_read2_b64 v[36:39], v47 offset0:4 offset1:6
 v_xor_b32 v57, 0x10000, v57
 v_xor_b32 v6, 0x10000, v6
 s_waitcnt lgkmcnt(6)
 v_mul_f32 v8, v8, v40
 v_mul_f32 v9, v9, v40
 v_mul_f32 v10, v10, v40
 v_mul_f32 v11, v11, v40
 v_mul_f32 v12, v12, v40
 v_mul_f32 v13, v13, v40
 v_mul_f32 v14, v14, v40
 v_mul_f32 v15, v15, v40
 s_waitcnt lgkmcnt(4)
 v_fmac_f32 v8, v16, v41
 v_fmac_f32 v9, v17, v41
 v_fmac_f32 v10, v18, v41
 v_fmac_f32 v11, v19, v41
 v_fmac_f32 v12, v20, v41
 v_fmac_f32 v13, v21, v41
 v_fmac_f32 v14, v22, v41
 v_fmac_f32 v15, v23, v41
 s_waitcnt lgkmcnt(2)
 v_fmac_f32 v8, v24, v42
 v_fmac_f32 v9, v25, v42
 v_fmac_f32 v10, v26, v42
 v_fmac_f32 v11, v27, v42
 v_fmac_f32 v12, v28, v42
 v_fmac_f32 v13, v29, v42
 v_fmac_f32 v14, v30, v42
 v_fmac_f32 v15, v31, v42
 s_waitcnt lgkmcnt(0)
 v_fmac_f32 v8, v32, v43
 v_fmac_f32 v9, v33, v43
 v_fmac_f32 v10, v34, v43
 v_fmac_f32 v11, v35, v43
 v_fmac_f32 v12, v36, v43
 v_fmac_f32 v13, v37, v43
 v_fmac_f32 v14, v38, v43
 v_fmac_f32 v15, v39, v43
 v_cvt_pk_bf16_f32 v44, v8, v10
 v_cvt_pk_bf16_f32 v45, v12, v14
 v_cvt_pk_bf16_f32 v46, v9, v11
 v_cvt_pk_bf16_f32 v47, v13, v15
 v_min_u32 v44, s44, v44
 s_xor_b32 s37, s45, 262144
 s_add_u32 s15, s15, 1
 s_and_b32 s45, s15, 3
 s_lshl_b32 s47, s45, 16
 s_add_u32 s47, s47, s59
 s_lshl_b32 s45, s45, 17
 s_xor_b32 s19, s47, 131072
 s_lshl_b32 s62, s15, 18
 s_add_u32 s48, s15, 1
 s_min_u32 s18, s48, 63
 s_lshl_b32 s18, s18, 18
 v_mov_b32 v20, -1
 v_mov_b32 v21, -1
 v_mov_b32 v22, -1
 v_mov_b32 v23, -1
 v_mov_b32 v12, 24576
 s_cmp_ge_u32 s87, s86
 s_cbranch_scc1 L_Gf
L_Gp:
 s_waitcnt vmcnt(0)
 v_min_u32_dpp v53, v52, v52 row_ror:8 row_mask:0xf bank_mask:0xf
 s_nop 1
 v_min_u32_dpp v53, v53, v53 row_ror:4 row_mask:0xf bank_mask:0xf
 s_nop 1
 v_min_u32_dpp v53, v53, v53 row_ror:2 row_mask:0xf bank_mask:0xf
 s_nop 1
 v_min_u32_dpp v53, v53, v53 row_ror:1 row_mask:0xf bank_mask:0xf
 s_nop 0
 v_readlane_b32 s87, v53, 0
 v_readlane_b32 s36, v53, 16
 s_min_u32 s87, s87, s36
 s_cmp_ge_u32 s87, s86
 s_cbranch_scc1 L_Gf
 s_mov_b32 exec_lo, 4160223223
 s_mov_b32 exec_hi, 0
 buffer_load_dword v52, v56, s[4:7], 0 offen sc1
 s_mov_b64 exec, -1
 s_add_u32 s60, s60, 16
 s_cmp_gt_u32 s60, 134217728
 s_cbranch_scc1 L_end
 s_branch L_Gp
L_Gf:
 s_sleep 1
 ds_read_b128 v[8:11], v12
 s_add_u32 s60, s60, 2
 s_cmp_gt_u32 s60, 134217728
 s_cbranch_scc1 L_end
 s_waitcnt lgkmcnt(0)
 v_min3_u32 v8, v8, v9, v10
 v_min_u32 v8, v8, v11
 v_cmp_ne_u32 vcc, s15, v8
 s_cbranch_vccnz L_Gf
 buffer_store_dwordx4 v[44:47], v7, s[4:7], s58 offen sc1
 s_add_u32 s58, s58, 0x80000
 s_cmp_eq_u32 s14, 2
 s_cbranch_scc1 L_Gh2
 s_cmp_lg_u32 s14, 0
 s_cbranch_scc1 L_Gh1
 s_mov_b64 exec, s[52:53]
 buffer_store_dwordx4 v[20:23], v56, s[4:7], s37 offen
 s_mov_b64 exec, s[54:55]
 buffer_store_dwordx2 v[20:21], v59, s[4:7], s37 offen offset:512
 s_mov_b64 exec, -1
 buffer_load_dwordx4 v[48:51], v58, s[4:7], s62 offen sc1
 buffer_load_dwordx4 v[52:55], v58, s[4:7], s62 offen offset:128 sc1
 s_branch L_Gh
L_Gh1:
 buffer_store_dwordx2 v[20:21], v56, s[4:7], s37 offen
 s_cmp_eq_u32 s14, 1
 s_cbranch_scc1 L_Gh3
 buffer_load_dwordx4 v[48:51], v58, s[4:7], s62 offen sc1
 buffer_load_dwordx4 v[52:55], v58, s[4:7], s62 offen offset:256 sc1
 s_branch L_Gh
L_Gh3:
 s_and_b32 s36, s15, 7
 s_cmp_lg_u32 s36, s12
 s_cbranch_scc1 L_Gh
 buffer_store_dwordx4 v[48:51], v59, s[4:7], s19 offen sc1
 s_mov_b64 exec, 15
 buffer_store_dwordx4 v[48:51], v59, s[4:7], s19 offen offset:384 sc1
 s_branch L_Gh
L_Gh2:
 s_mov_b32 exec_hi, 2097151
 buffer_load_dword v48, v58, s[4:7], s18 offen sc1
 v_mov_b32 v8, s15
 s_mov_b64 exec, 1
 buffer_store_dword v8, off, s[4:7], s51 sc1
L_Gh:
 s_mov_b64 exec, -1
 v_mov_b32 v61, 1
 s_setprio 2
 s_cmp_eq_u32 s15, 64
 s_barrier
 s_cbranch_scc0 L_Gloop
L_Gx:
 s_mov_b64 exec, -1
 s_barrier
 v_add_u32 v45, 8704, v57
 v_add_u32 v46, 17408, v57
 v_add_u32 v47, 26112, v57
 ds_read_b128 v[40:43], v6 offset:256
 ds_read2_b64 v[8:11], v57 offset0:0 offset1:2
 ds_read2_b64 v[12:15], v57 offset0:4 offset1:6
 ds_read2_b64 v[16:19], v45 offset0:0 offset1:2
 ds_read2_b64 v[20:23], v45 offset0:4 offset1:6
 ds_read2_b64 v[24:27], v46 offset0:0 offset1:2
 ds_read2_b64 v[28:31], v46 offset0:4 offset1:6
 ds_read2_b64 v[32:35], v47 offset0:0 offset1:2
 ds_read2_b64 v[36:39], v47 offset0:4 offset1:6
 v_xor_b32 v57, 0x10000, v57
 v_xor_b32 v6, 0x10000, v6
 s_waitcnt lgkmcnt(6)
 v_mul_f32 v8, v8, v40
 v_mul_f32 v9, v9, v40
 v_mul_f32 v10, v10, v40
 v_mul_f32 v11, v11, v40
 v_mul_f32 v12, v12, v40
 v_mul_f32 v13, v13, v40
 v_mul_f32 v14, v14, v40
 v_mul_f32 v15, v15, v40
 s_waitcnt lgkmcnt(4)
 v_fmac_f32 v8, v16, v41
 v_fmac_f32 v9, v17, v41
 v_fmac_f32 v10, v18, v41
 v_fmac_f32 v11, v19, v41
 v_fmac_f32 v12, v20, v41
 v_fmac_f32 v13, v21, v41
 v_fmac_f32 v14, v22, v41
 v_fmac_f32 v15, v23, v41
 s_waitcnt lgkmcnt(2)
 v_fmac_f32 v8, v24, v42
 v_fmac_f32 v9, v25, v42
 v_fmac_f32 v10, v26, v42
 v_fmac_f32 v11, v27, v42
 v_fmac_f32 v12, v28, v42
 v_fmac_f32 v13, v29, v42
 v_fmac_f32 v14, v30, v42
 v_fmac_f32 v15, v31, v42
 s_waitcnt lgkmcnt(0)
 v_fmac_f32 v8, v32, v43
 v_fmac_f32 v9, v33, v43
 v_fmac_f32 v10, v34, v43
 v_fmac_f32 v11, v35, v43
 v_fmac_f32 v12, v36, v43
 v_fmac_f32 v13, v37, v43
 v_fmac_f32 v14, v38, v43
 v_fmac_f32 v15, v39, v43
 v_cvt_pk_bf16_f32 v44, v8, v10
 v_cvt_pk_bf16_f32 v45, v12, v14
 v_cvt_pk_bf16_f32 v46, v9, v11
 v_cvt_pk_bf16_f32 v47, v13, v15
 v_min_u32 v44, s44, v44
 buffer_store_dwordx4 v[44:47], v7, s[4:7], s58 offen sc1
 s_add_u32 s58, s58, 0x80000
 s_branch L_cend
L_P0:
L_P1:
L_P2:
L_P3:
L_Gor:
 s_mov_b64 exec, -1
 s_nop 1
 v_mov_b64 v[24:25], 0
 v_mov_b64 v[26:27], 0
 s_nop 1
 v_mov_b64 v[28:29], 0
 v_mov_b64 v[30:31], 0
 v_mov_b64 v[32:33], 0
 v_mov_b64 v[34:35], 0
 v_mov_b64 v[36:37], 0
 v_mov_b64 v[38:39], 0
 v_mov_b64 v[40:41], 0
 v_mov_b64 v[42:43], 0
 v_mov_b64 v[44:45], 0
 v_mov_b64 v[46:47], 0
 s_add_u32 s60, s60, 10
 s_cmp_gt_u32 s60, 134217728
 s_cbranch_scc1 L_end
 s_branch L_Gis
L_G3:
 s_waitcnt lgkmcnt(0)
 s_barrier
 ds_read_b128 v[8:11], v63 offset:0
 ds_read_b128 v[12:15], v63 offset:16
 ds_read_b128 v[16:19], v63 offset:3584
 ds_read_b128 v[20:23], v63 offset:3600
 ds_read_b128 v[24:27], v63 offset:7168
 ds_read_b128 v[28:31], v63 offset:7184
 ds_read_b128 v[32:35], v63 offset:10752
 ds_read_b128 v[36:39], v63 offset:10768
 s_waitcnt lgkmcnt(4)
 v_pk_add_f32 v[8:9], v[8:9], v[16:17]
 v_pk_add_f32 v[10:11], v[10:11], v[18:19]
 v_pk_add_f32 v[12:13], v[12:13], v[20:21]
 v_pk_add_f32 v[14:15], v[14:15], v[22:23]
 s_waitcnt lgkmcnt(0)
 v_pk_add_f32 v[24:25], v[24:25], v[32:33]
 v_pk_add_f32 v[26:27], v[26:27], v[34:35]
 v_pk_add_f32 v[28:29], v[28:29], v[36:37]
 v_pk_add_f32 v[30:31], v[30:31], v[38:39]
 v_pk_add_f32 v[8:9], v[8:9], v[24:25]
 v_pk_add_f32 v[10:11], v[10:11], v[26:27]
 v_pk_add_f32 v[12:13], v[12:13], v[28:29]
 v_pk_add_f32 v[14:15], v[14:15], v[30:31]
 v_cvt_pk_bf16_f32 v40, v8, v9
 v_cvt_pk_bf16_f32 v41, v10, v11
 v_cvt_pk_bf16_f32 v42, v12, v13
 v_cvt_pk_bf16_f32 v43, v14, v15
 s_nop 1
 v_mfma_f32_16x16x32_bf16 v[8:11], v[40:43], v[48:51], 0
 v_mfma_f32_16x16x32_bf16 v[12:15], v[40:43], v[52:55], 0
 s_nop 3
 v_cvt_pk_bf16_f32 v44, v8, v9
 v_cvt_pk_bf16_f32 v45, v10, v11
 s_mov_b64 exec, s[52:53]
 s_nop 0
 v_cvt_pk_bf16_f32 v44, v12, v13
 v_cvt_pk_bf16_f32 v45, v14, v15
 s_mov_b64 exec, -1
 v_min_u32 v44, s44, v44
 buffer_store_dwordx2 v[44:45], v56, s[4:7], s45 offen
 s_branch L_Gtail
L_Gqd:
 v_permlane32_swap_b32 v24, v28
 v_permlane32_swap_b32 v25, v29
 v_permlane32_swap_b32 v26, v30
 v_permlane32_swap_b32 v27, v31
 v_add_f32 v24, v24, v28
 v_add_f32 v28, v26, v30
 v_add_f32 v26, v25, v29
 v_add_f32 v30, v27, v31
 s_branch L_Gqe
L_T:
 s_add_u32 s95, s95, 512
 s_load_dwordx2 s[8:9], s[0:1], 80
 s_mov_b32 s10, 0x800000
 s_mov_b32 s11, 0x20000
 s_mov_b32 s39, 1040356334
 s_lshl_b32 s23, s12, 2
 s_add_u32 s23, s23, s21
 s_lshl_b32 s24, s12, 4
 s_add_u32 s24, s24, s13
 v_mov_b32_e64 v8, 0
 v_mov_b32_e64 v9, 0
 v_mov_b32_e64 v10, 0
 v_mov_b32_e64 v11, 0
 s_lshl_b32 s36, s24, 8
 s_lshl_b32 s37, s21, 6
 s_add_u32 s36, s36, s37
 s_add_u32 s36, s36, 2228224
 v_lshlrev_b32_e64 v12, 4, v0
 s_mov_b64 exec, 15
 buffer_store_dwordx4 v[8:11], v12, s[4:7], s36 offen sc1
 s_lshl_b32 s36, s24, 7
 s_add_u32 s36, s36, 2260992
 buffer_store_dwordx4 v[8:11], v12, s[4:7], s36 offen sc1
 s_sub_u32 s36, s36, 98304
 buffer_store_dwordx4 v[8:11], v12, s[4:7], s36 offen
 s_mov_b64 exec, -1
 v_lshlrev_b32_e64 v18, 14, v57
 v_lshl_add_u32 v18, v56, 3, v18
 s_lshl_b32 s36, s13, 7
 v_add_u32 v18, s36, v18
 s_lshl_b32 s36, s23, 18
 s_setprio 0
 s_waitcnt lgkmcnt(0)
 s_add_u32 s37, s36, 0
 buffer_load_dwordx2 v[64:65], v18, s[8:11], s37 offen nt
 s_add_u32 s37, s36, 2048
 buffer_load_dwordx2 v[66:67], v18, s[8:11], s37 offen nt
 s_add_u32 s37, s36, 4096
 buffer_load_dwordx2 v[68:69], v18, s[8:11], s37 offen nt
 s_add_u32 s37, s36, 6144
 buffer_load_dwordx2 v[70:71], v18, s[8:11], s37 offen nt
 s_add_u32 s37, s36, 8192
 buffer_load_dwordx2 v[72:73], v18, s[8:11], s37 offen nt
 s_add_u32 s37, s36, 10240
 buffer_load_dwordx2 v[74:75], v18, s[8:11], s37 offen nt
 s_add_u32 s37, s36, 12288
 buffer_load_dwordx2 v[76:77], v18, s[8:11], s37 offen nt
 s_add_u32 s37, s36, 14336
 buffer_load_dwordx2 v[78:79], v18, s[8:11], s37 offen nt
 s_add_u32 s37, s36, 65536
 buffer_load_dwordx2 v[80:81], v18, s[8:11], s37 offen nt
 s_add_u32 s37, s36, 67584
 buffer_load_dwordx2 v[82:83], v18, s[8:11], s37 offen nt
 s_add_u32 s37, s36, 69632
 buffer_load_dwordx2 v[84:85], v18, s[8:11], s37 offen nt
 s_add_u32 s37, s36, 71680
 buffer_load_dwordx2 v[86:87], v18, s[8:11], s37 offen nt
 s_add_u32 s37, s36, 73728
 buffer_load_dwordx2 v[88:89], v18, s[8:11], s37 offen nt
 s_add_u32 s37, s36, 75776
 buffer_load_dwordx2 v[90:91], v18, s[8:11], s37 offen nt
 s_add_u32 s37, s36, 77824
 buffer_load_dwordx2 v[92:93], v18, s[8:11], s37 offen nt
 s_add_u32 s37, s36, 79872
 buffer_load_dwordx2 v[94:95], v18, s[8:11], s37 offen nt
 s_add_u32 s37, s36, 131072
 buffer_load_dwordx2 v[96:97], v18, s[8:11], s37 offen nt
 s_add_u32 s37, s36, 133120
 buffer_load_dwordx2 v[98:99], v18, s[8:11], s37 offen nt
 s_add_u32 s37, s36, 135168
 buffer_load_dwordx2 v[100:101], v18, s[8:11], s37 offen nt
 s_add_u32 s37, s36, 137216
 buffer_load_dwordx2 v[102:103], v18, s[8:11], s37 offen nt
 s_add_u32 s37, s36, 139264
 buffer_load_dwordx2 v[104:105], v18, s[8:11], s37 offen nt
 s_add_u32 s37, s36, 141312
 buffer_load_dwordx2 v[106:107], v18, s[8:11], s37 offen nt
 s_add_u32 s37, s36, 143360
 buffer_load_dwordx2 v[108:109], v18, s[8:11], s37 offen nt
 s_add_u32 s37, s36, 145408
 buffer_load_dwordx2 v[110:111], v18, s[8:11], s37 offen nt
 s_add_u32 s37, s36, 196608
 buffer_load_dwordx2 v[112:113], v18, s[8:11], s37 offen nt
 s_add_u32 s37, s36, 198656
 buffer_load_dwordx2 v[114:115], v18, s[8:11], s37 offen nt
 s_add_u32 s37, s36, 200704
 buffer_load_dwordx2 v[116:117], v18, s[8:11], s37 offen nt
 s_add_u32 s37, s36, 202752
 buffer_load_dwordx2 v[118:119], v18, s[8:11], s37 offen nt
 s_add_u32 s37, s36, 204800
 buffer_load_dwordx2 v[120:121], v18, s[8:11], s37 offen nt
 s_add_u32 s37, s36, 206848
 buffer_load_dwordx2 v[122:123], v18, s[8:11], s37 offen nt
 s_add_u32 s37, s36, 208896
 buffer_load_dwordx2 v[124:125], v18, s[8:11], s37 offen nt
 s_add_u32 s37, s36, 210944
 buffer_load_dwordx2 v[126:127], v18, s[8:11], s37 offen nt
 s_lshl_b32 s36, s21, 12
 s_add_u32 s36, s36, s20
 s_add_u32 s36, s36, 1048576
 v_lshl_add_u32 v7, v57, 10, s36
 v_lshl_add_u32 v1, v56, 4, v7
 v_lshl_add_u32 v7, v56, 3, v7
 v_lshlrev_b32 v59, 4, v0
 s_lshl_b32 s36, s21, 11
 s_add_u32 s36, s36, s20
 s_add_u32 s36, s36, 1572864
 v_add_u32 v2, s36, v59
 s_lshl_b32 s36, s23, 13
 s_add_u32 s36, s36, 33554432
 v_lshl_add_u32 v5, v57, 9, s36
 v_lshl_add_u32 v5, v56, 4, v5
 v_and_b32 v59, 1, v57
 v_mul_u32_u24 v4, 1280, v59
 v_lshl_add_u32 v4, v56, 4, v4
 v_lshrrev_b32 v59, 1, v57
 v_lshl_add_u32 v4, v59, 3, v4
 s_mul_i32 s36, s21, 2560
 s_add_u32 s36, s36, 14336
 v_add_u32 v4, s36, v4
 v_mov_b32 v63, 0x4444
 v_and_b32 v59, 4, v0
 v_cmp_ne_u32 vcc, 0, v59
 s_nop 1
 v_cndmask_b32 v63, v63, v58, vcc
 s_lshl_b32 s36, s21, 2
 s_add_u32 s37, s36, 24576
 v_mov_b32 v58, s37
 v_and_b32 v59, 7, v0
 s_add_u32 s37, s36, 24704
 v_lshl_add_u32 v6, v59, 4, s37
 v_and_b32 v59, 31, v0
 v_mul_u32_u24 v52, 272, v59
 s_add_u32 s37, s36, 33024
 v_add_u32 v52, s37, v52
 s_lshl_b32 s36, s24, 7
 s_lshl_b32 s37, s21, 4
 s_add_u32 s36, s36, s37
 s_add_u32 s36, s36, 2162688
 v_lshlrev_b32 v53, 2, v0
 v_add_u32 v53, s36, v53
 v_mov_b32 v55, 0
 v_mov_b32 v12, -1
 ds_write_b32 v58, v8
 ds_write_b32 v58, v8 offset:16
 ds_write_b32 v58, v12 offset:32
 v_mov_b32 v16, s40
 v_mov_b32 v17, s41
 v_cmp_eq_u32 vcc, 0, v56
 s_nop 1
 v_cndmask_b32 v12, 0, v16, vcc
 v_cmp_eq_u32 vcc, 1, v56
 s_nop 1
 v_cndmask_b32 v12, v12, v17, vcc
 v_accvgpr_write_b32 a96, v12
 v_cmp_eq_u32 vcc, 2, v56
 s_nop 1
 v_cndmask_b32 v12, 0, v16, vcc
 v_cmp_eq_u32 vcc, 3, v56
 s_nop 1
 v_cndmask_b32 v12, v12, v17, vcc
 v_accvgpr_write_b32 a97, v12
 v_cmp_eq_u32 vcc, 4, v56
 s_nop 1
 v_cndmask_b32 v12, 0, v16, vcc
 v_cmp_eq_u32 vcc, 5, v56
 s_nop 1
 v_cndmask_b32 v12, v12, v17, vcc
 v_accvgpr_write_b32 a98, v12
 v_cmp_eq_u32 vcc, 6, v56
 s_nop 1
 v_cndmask_b32 v12, 0, v16, vcc
 v_cmp_eq_u32 vcc, 7, v56
 s_nop 1
 v_cndmask_b32 v12, v12, v17, vcc
 v_accvgpr_write_b32 a99, v12
 v_cmp_eq_u32 vcc, 8, v56
 s_nop 1
 v_cndmask_b32 v12, 0, v16, vcc
 v_cmp_eq_u32 vcc, 9, v56
 s_nop 1
 v_cndmask_b32 v12, v12, v17, vcc
 v_accvgpr_write_b32 a100, v12
 v_cmp_eq_u32 vcc, 10, v56
 s_nop 1
 v_cndmask_b32 v12, 0, v16, vcc
 v_cmp_eq_u32 vcc, 11, v56
 s_nop 1
 v_cndmask_b32 v12, v12, v17, vcc
 v_accvgpr_write_b32 a101, v12
 v_cmp_eq_u32 vcc, 12, v56
 s_nop 1
 v_cndmask_b32 v12, 0, v16, vcc
 v_cmp_eq_u32 vcc, 13, v56
 s_nop 1
 v_cndmask_b32 v12, v12, v17, vcc
 v_accvgpr_write_b32 a102, v12
 v_cmp_eq_u32 vcc, 14, v56
 s_nop 1
 v_cndmask_b32 v12, 0, v16, vcc
 v_cmp_eq_u32 vcc, 15, v56
 s_nop 1
 v_cndmask_b32 v12, v12, v17, vcc
 v_accvgpr_write_b32 a103, v12
 v_cmp_eq_u32 vcc, 8, v56
 s_nop 1
 v_cndmask_b32 v12, 0, v16, vcc
 v_cmp_eq_u32 vcc, 9, v56
 s_nop 1
 v_cndmask_b32 v12, v12, v17, vcc
 v_accvgpr_write_b32 a104, v12
 v_cmp_eq_u32 vcc, 12, v56
 s_nop 1
 v_cndmask_b32 v12, 0, v16, vcc
 v_cmp_eq_u32 vcc, 13, v56
 s_nop 1
 v_cndmask_b32 v12, v12, v17, vcc
 v_accvgpr_write_b32 a105, v12
 v_mov_b32 v12, 0xf149f2ca
 v_cmp_gt_u32 vcc, 32, v0
 s_nop 1
 v_cndmask_b32 v28, 0, v12, vcc
 v_accvgpr_write_b32 a124, 0
 v_cndmask_b32 v29, 0, v12, vcc
 v_accvgpr_write_b32 a125, 0
 v_cndmask_b32 v30, 0, v12, vcc
 v_accvgpr_write_b32 a126, 0
 v_cndmask_b32 v31, 0, v12, vcc
 v_accvgpr_write_b32 a127, 0
 v_mov_b32 v12, 0x3f803f80
 v_mov_b32 v30, 0
 s_mov_b32 s48, 1106247680
 v_accvgpr_write_b32 a124, v12
 v_accvgpr_write_b32 a125, v12
 v_accvgpr_write_b32 a126, v12
 s_lshl_b32 s36, s21, 9
 s_add_u32 s36, s36, s22
 v_lshl_add_u32 v12, v56, 2, s36
 v_and_b32 v13, 1, v57
 v_lshl_add_u32 v12, v13, 8, v12
 v_lshrrev_b32 v14, 5, v0
 v_lshl_add_u32 v12, v14, 6, v12
 v_accvgpr_write_b32 a122, v12
 v_bfe_u32 v12, v0, 2, 2
 v_lshl_add_u32 v12, v14, 2, v12
 v_lshlrev_b32 v14, 4, v12
 v_add_u32 v14, 24704, v14
 v_accvgpr_write_b32 a121, v14
 v_mul_u32_u24 v12, 320, v12
 v_lshl_add_u32 v12, v13, 3, v12
 v_and_b32 v13, 3, v0
 v_lshl_add_u32 v12, v13, 4, v12
 s_lshl_b32 s36, s21, 6
 s_add_u32 s36, s36, 14336
 v_add_u32 v12, s36, v12
 v_accvgpr_write_b32 a120, v12
 s_mov_b32 s84, 0x80008000
 s_mov_b32 s85, 0x80008000
 s_lshl_b32 s36, s21, 11
 s_add_u32 s36, s36, s20
 s_add_u32 s36, s36, 1581056
 v_lshl_add_u32 v59, v57, 9, s36
 v_lshl_add_u32 v59, v56, 5, v59
 v_mul_u32_u24 v62, 272, v56
 v_lshl_add_u32 v62, v57, 6, v62
 s_mul_i32 s36, s21, 8704
 s_add_u32 s36, s36, 32768
 v_add_u32 v62, s36, v62
 s_lshl_b32 s36, s23, 13
 s_add_u32 s36, s36, 67108864
 v_and_b32 v57, 31, v0
 v_lshl_add_u32 v57, v57, 3, s36
 v_lshl_add_u32 v56, v0, 4, s36
 v_lshlrev_b32 v19, 2, v0
 s_waitcnt vmcnt(32) lgkmcnt(0)
 s_barrier
 s_cmp_lg_u32 s14, 4
 s_cbranch_scc1 L_Tw
 s_lshl_b32 s30, s30, 8
 v_mul_u32_u24 v9, s30, v0
 v_add_u32 v9, 1, v9
 v_lshlrev_b32 v10, s31, v19
 s_mov_b64 exec, 3
 global_atomic_add v10, v9, s[16:17] offset:128 sc1
 s_mov_b64 exec, -1
L_Tw:
 s_waitcnt vmcnt(0)
 v_perm_b32 v12, v66, v64, s42
 v_accvgpr_write_b32 a0, v12
 v_perm_b32 v12, v66, v64, s43
 v_accvgpr_write_b32 a16, v12
 v_perm_b32 v12, v67, v65, s42
 v_accvgpr_write_b32 a32, v12
 v_perm_b32 v12, v67, v65, s43
 v_accvgpr_write_b32 a48, v12
 v_perm_b32 v12, v70, v68, s42
 v_accvgpr_write_b32 a1, v12
 v_perm_b32 v12, v70, v68, s43
 v_accvgpr_write_b32 a17, v12
 v_perm_b32 v12, v71, v69, s42
 v_accvgpr_write_b32 a33, v12
 v_perm_b32 v12, v71, v69, s43
 v_accvgpr_write_b32 a49, v12
 v_perm_b32 v12, v74, v72, s42
 v_accvgpr_write_b32 a2, v12
 v_perm_b32 v12, v74, v72, s43
 v_accvgpr_write_b32 a18, v12
 v_perm_b32 v12, v75, v73, s42
 v_accvgpr_write_b32 a34, v12
 v_perm_b32 v12, v75, v73, s43
 v_accvgpr_write_b32 a50, v12
 v_perm_b32 v12, v78, v76, s42
 v_accvgpr_write_b32 a3, v12
 v_perm_b32 v12, v78, v76, s43
 v_accvgpr_write_b32 a19, v12
 v_perm_b32 v12, v79, v77, s42
 v_accvgpr_write_b32 a35, v12
 v_perm_b32 v12, v79, v77, s43
 v_accvgpr_write_b32 a51, v12
 v_perm_b32 v12, v82, v80, s42
 v_accvgpr_write_b32 a4, v12
 v_perm_b32 v12, v82, v80, s43
 v_accvgpr_write_b32 a20, v12
 v_perm_b32 v12, v83, v81, s42
 v_accvgpr_write_b32 a36, v12
 v_perm_b32 v12, v83, v81, s43
 v_accvgpr_write_b32 a52, v12
 v_perm_b32 v12, v86, v84, s42
 v_accvgpr_write_b32 a5, v12
 v_perm_b32 v12, v86, v84, s43
 v_accvgpr_write_b32 a21, v12
 v_perm_b32 v12, v87, v85, s42
 v_accvgpr_write_b32 a37, v12
 v_perm_b32 v12, v87, v85, s43
 v_accvgpr_write_b32 a53, v12
 v_perm_b32 v12, v90, v88, s42
 v_accvgpr_write_b32 a6, v12
 v_perm_b32 v12, v90, v88, s43
 v_accvgpr_write_b32 a22, v12
 v_perm_b32 v12, v91, v89, s42
 v_accvgpr_write_b32 a38, v12
 v_perm_b32 v12, v91, v89, s43
 v_accvgpr_write_b32 a54, v12
 v_perm_b32 v12, v94, v92, s42
 v_accvgpr_write_b32 a7, v12
 v_perm_b32 v12, v94, v92, s43
 v_accvgpr_write_b32 a23, v12
 v_perm_b32 v12, v95, v93, s42
 v_accvgpr_write_b32 a39, v12
 v_perm_b32 v12, v95, v93, s43
 v_accvgpr_write_b32 a55, v12
 v_perm_b32 v12, v98, v96, s42
 v_accvgpr_write_b32 a8, v12
 v_perm_b32 v12, v98, v96, s43
 v_accvgpr_write_b32 a24, v12
 v_perm_b32 v12, v99, v97, s42
 v_accvgpr_write_b32 a40, v12
 v_perm_b32 v12, v99, v97, s43
 v_accvgpr_write_b32 a56, v12
 v_perm_b32 v12, v102, v100, s42
 v_accvgpr_write_b32 a9, v12
 v_perm_b32 v12, v102, v100, s43
 v_accvgpr_write_b32 a25, v12
 v_perm_b32 v12, v103, v101, s42
 v_accvgpr_write_b32 a41, v12
 v_perm_b32 v12, v103, v101, s43
 v_accvgpr_write_b32 a57, v12
 v_perm_b32 v12, v106, v104, s42
 v_accvgpr_write_b32 a10, v12
 v_perm_b32 v12, v106, v104, s43
 v_accvgpr_write_b32 a26, v12
 v_perm_b32 v12, v107, v105, s42
 v_accvgpr_write_b32 a42, v12
 v_perm_b32 v12, v107, v105, s43
 v_accvgpr_write_b32 a58, v12
 v_perm_b32 v12, v110, v108, s42
 v_accvgpr_write_b32 a11, v12
 v_perm_b32 v12, v110, v108, s43
 v_accvgpr_write_b32 a27, v12
 v_perm_b32 v12, v111, v109, s42
 v_accvgpr_write_b32 a43, v12
 v_perm_b32 v12, v111, v109, s43
 v_accvgpr_write_b32 a59, v12
 v_perm_b32 v12, v114, v112, s42
 v_accvgpr_write_b32 a12, v12
 v_perm_b32 v12, v114, v112, s43
 v_accvgpr_write_b32 a28, v12
 v_perm_b32 v12, v115, v113, s42
 v_accvgpr_write_b32 a44, v12
 v_perm_b32 v12, v115, v113, s43
 v_accvgpr_write_b32 a60, v12
 v_perm_b32 v12, v118, v116, s42
 v_accvgpr_write_b32 a13, v12
 v_perm_b32 v12, v118, v116, s43
 v_accvgpr_write_b32 a29, v12
 v_perm_b32 v12, v119, v117, s42
 v_accvgpr_write_b32 a45, v12
 v_perm_b32 v12, v119, v117, s43
 v_accvgpr_write_b32 a61, v12
 v_perm_b32 v12, v122, v120, s42
 v_accvgpr_write_b32 a14, v12
 v_perm_b32 v12, v122, v120, s43
 v_accvgpr_write_b32 a30, v12
 v_perm_b32 v12, v123, v121, s42
 v_accvgpr_write_b32 a46, v12
 v_perm_b32 v12, v123, v121, s43
 v_accvgpr_write_b32 a62, v12
 v_perm_b32 v12, v126, v124, s42
 v_accvgpr_write_b32 a15, v12
 v_perm_b32 v12, v126, v124, s43
 v_accvgpr_write_b32 a31, v12
 v_perm_b32 v12, v127, v125, s42
 v_accvgpr_write_b32 a47, v12
 v_perm_b32 v12, v127, v125, s43
 v_accvgpr_write_b32 a63, v12
 v_mov_b64 v[66:67], 0
 v_mov_b64 v[74:75], 0
 v_mov_b64 v[82:83], 0
 v_mov_b64 v[90:91], 0
 s_cmp_lg_u32 s14, 4
 s_cbranch_scc1 L_Ti2
 s_mov_b64 exec, 1
L_Ti:
 s_sleep 40
 global_load_dwordx3 v[10:12], v19, s[16:17] offset:128 sc1
 s_add_u32 s60, s60, 48
 s_cmp_gt_u32 s60, 134217728
 s_cbranch_scc1 L_end
 s_waitcnt vmcnt(0)
 v_and_b32 v13, 0xff, v11
 v_and_b32 v14, 0xff, v12
 v_add_u32 v9, v13, v14
 v_add_u32 v9, v9, v10
 v_cmp_ne_u32 vcc, 376, v9
 s_cbranch_vccnz L_Ti
 v_lshrrev_b32 v11, 8, v11
 v_lshrrev_b32 v12, 8, v12
 v_mul_u32_u24 v11, v11, v14
 v_mul_u32_u24 v12, v12, v13
 v_mov_b32 v9, 0x2000
 v_cmp_lt_u32 vcc, v12, v11
 s_nop 1
 v_cndmask_b32 v10, 0, v9, vcc
 s_lshl_b32 s36, s12, 10
 s_add_u32 s36, s36, 2293760
 s_mov_b64 exec, -1
 v_lshrrev_b32 v12, 2, v0
 v_and_b32 v13, 3, v0
 v_lshlrev_b32 v13, 2, v13
 v_lshl_add_u32 v13, v12, 8, v13
 s_mov_b64 exec, 0x7777
L_kv0:
 s_sleep 10
 buffer_load_dword v9, v13, s[4:7], s36 offen sc1
 s_add_u32 s60, s60, 24
 s_cmp_gt_u32 s60, 134217728
 s_cbranch_scc1 L_end
 s_waitcnt vmcnt(0)
 v_cmp_gt_u32 vcc, 2, v9
 s_cbranch_vccnz L_kv0
 s_mov_b64 exec, -1
 s_mov_b64 exec, 1
 ds_write_b32 v58, v10 offset:32
 s_mov_b64 exec, -1
L_Ti2:
 v_mov_b32 v25, 24576
L_lwt:
 s_sleep 1
 ds_read_b32 v24, v25 offset:32
 s_add_u32 s60, s60, 2
 s_cmp_gt_u32 s60, 134217728
 s_cbranch_scc1 L_end
 s_waitcnt lgkmcnt(0)
 v_readfirstlane_b32 s59, v24
 s_cmp_eq_u32 s59, -1
 s_cbranch_scc1 L_lwt
 s_mov_b32 s49, 0
 s_mov_b32 s50, 4096
 s_setprio 0
 buffer_load_dwordx4 a[64:67], v5, s[4:7], s49 offen offset:0 sc1
 buffer_load_dwordx4 a[68:71], v5, s[4:7], s49 offen offset:2048 sc1
 buffer_load_dwordx4 a[72:75], v5, s[4:7], s50 offen offset:0 sc1
 buffer_load_dwordx4 a[76:79], v5, s[4:7], s50 offen offset:2048 sc1
 buffer_load_dwordx4 a[80:83], v5, s[4:7], s49 offen offset:256 sc1
 buffer_load_dwordx4 a[84:87], v5, s[4:7], s49 offen offset:2304 sc1
 buffer_load_dwordx4 a[88:91], v5, s[4:7], s50 offen offset:256 sc1
 buffer_load_dwordx4 a[92:95], v5, s[4:7], s50 offen offset:2304 sc1
 s_waitcnt vmcnt(0)
 v_mfma_f32_16x16x32_bf16 v[20:23], a[64:67], a[0:3], 0
 v_mfma_f32_16x16x32_bf16 v[24:27], a[64:67], a[16:19], 0
 v_mfma_f32_16x16x32_bf16 v[120:123], a[64:67], a[32:35], 0
 v_mfma_f32_16x16x32_bf16 v[124:127], a[64:67], a[48:51], 0
 v_mfma_f32_16x16x32_bf16 v[20:23], a[68:71], a[4:7], v[20:23]
 v_mfma_f32_16x16x32_bf16 v[24:27], a[68:71], a[20:23], v[24:27]
 v_mfma_f32_16x16x32_bf16 v[120:123], a[68:71], a[36:39], v[120:123]
 v_mfma_f32_16x16x32_bf16 v[124:127], a[68:71], a[52:55], v[124:127]
 v_mfma_f32_16x16x32_bf16 v[20:23], a[72:75], a[8:11], v[20:23]
 v_mfma_f32_16x16x32_bf16 v[24:27], a[72:75], a[24:27], v[24:27]
 v_mfma_f32_16x16x32_bf16 v[120:123], a[72:75], a[40:43], v[120:123]
 v_mfma_f32_16x16x32_bf16 v[124:127], a[72:75], a[56:59], v[124:127]
 v_mfma_f32_16x16x32_bf16 v[20:23], a[76:79], a[12:15], v[20:23]
 v_mfma_f32_16x16x32_bf16 v[24:27], a[76:79], a[28:31], v[24:27]
 v_mfma_f32_16x16x32_bf16 v[120:123], a[76:79], a[44:47], v[120:123]
 v_mfma_f32_16x16x32_bf16 v[124:127], a[76:79], a[60:63], v[124:127]
 s_waitcnt vmcnt(6)
 v_mfma_f32_16x16x32_bf16 v[8:11], a[80:83], a[0:3], 0
 v_mfma_f32_16x16x32_bf16 v[12:15], a[80:83], a[16:19], 0
 v_mfma_f32_16x16x32_bf16 v[112:115], a[80:83], a[32:35], 0
 v_mfma_f32_16x16x32_bf16 v[116:119], a[80:83], a[48:51], 0
 s_waitcnt vmcnt(5)
 v_mfma_f32_16x16x32_bf16 v[8:11], a[84:87], a[4:7], v[8:11]
 v_cvt_pk_bf16_f32 v64, v20, v21
 v_mfma_f32_16x16x32_bf16 v[12:15], a[84:87], a[20:23], v[12:15]
 v_cvt_pk_bf16_f32 v65, v22, v23
 v_mfma_f32_16x16x32_bf16 v[112:115], a[84:87], a[36:39], v[112:115]
 v_cvt_pk_bf16_f32 v72, v24, v25
 v_mfma_f32_16x16x32_bf16 v[116:119], a[84:87], a[52:55], v[116:119]
 v_cvt_pk_bf16_f32 v73, v26, v27
 s_waitcnt vmcnt(4)
 v_mfma_f32_16x16x32_bf16 v[8:11], a[88:91], a[8:11], v[8:11]
 v_cvt_pk_bf16_f32 v80, v120, v121
 v_mfma_f32_16x16x32_bf16 v[12:15], a[88:91], a[24:27], v[12:15]
 v_cvt_pk_bf16_f32 v81, v122, v123
 v_mfma_f32_16x16x32_bf16 v[112:115], a[88:91], a[40:43], v[112:115]
 v_cvt_pk_bf16_f32 v88, v124, v125
 v_mfma_f32_16x16x32_bf16 v[116:119], a[88:91], a[56:59], v[116:119]
 v_cvt_pk_bf16_f32 v89, v126, v127
 s_waitcnt vmcnt(3)
 v_mfma_f32_16x16x32_bf16 v[8:11], a[92:95], a[12:15], v[8:11]
 v_mfma_f32_16x16x32_bf16 v[12:15], a[92:95], a[28:31], v[12:15]
 v_mfma_f32_16x16x32_bf16 v[112:115], a[92:95], a[44:47], v[112:115]
 v_mfma_f32_16x16x32_bf16 v[116:119], a[92:95], a[60:63], v[116:119]
L_Tux:
 v_mfma_f32_32x32x8_bf16 v[36:51], v[66:67], v[66:67], 0
 s_and_b32 s45, s15, 3
 s_lshl_b32 s45, s45, 17
 s_add_u32 s38, s15, 1
 s_mov_b32 s46, s49
 s_min_u32 s49, s38, 63
 s_lshl_b32 s49, s49, 18
 s_add_u32 s50, s49, 4096
 v_mfma_f32_32x32x8_bf16 v[96:111], v[66:67], v[66:67], 0
 s_and_b32 s82, s38, 3
 s_lshl_b32 s82, s82, 16
 s_add_u32 s82, s82, s59
 v_mov_b32 v54, s38
 v_cvt_pk_bf16_f32 v68, v8, v9
 v_cvt_pk_bf16_f32 v69, v10, v11
 v_cvt_pk_bf16_f32 v76, v12, v13
 v_cvt_pk_bf16_f32 v77, v14, v15
 v_cvt_pk_bf16_f32 v84, v112, v113
 v_cvt_pk_bf16_f32 v85, v114, v115
 v_cvt_pk_bf16_f32 v92, v116, v117
 v_cvt_pk_bf16_f32 v93, v118, v119
 s_setprio 1
 s_waitcnt lgkmcnt(0)
 s_barrier
 buffer_load_dwordx4 a[64:67], v5, s[4:7], s49 offen offset:0 sc1
 buffer_load_dwordx4 a[68:71], v5, s[4:7], s49 offen offset:2048 sc1
 buffer_load_dwordx4 a[72:75], v5, s[4:7], s50 offen offset:0 sc1
 buffer_load_dwordx4 a[76:79], v5, s[4:7], s50 offen offset:2048 sc1
L_Th0:
 s_mov_b64 exec, 0xf
L_Th:
 buffer_load_dword v55, v53, s[4:7], 0 offen sc1
 s_add_u32 s60, s60, 4
 s_cmp_gt_u32 s60, 134217728
 s_cbranch_scc1 L_end
 s_waitcnt vmcnt(1)
 v_cmp_gt_u32 vcc, s38, v55
 s_cbranch_vccnz L_Th
 s_mov_b64 exec, -1
L_Tl:
 buffer_load_dwordx4 v[112:115], v1, s[4:7], s45 offen sc1
 buffer_load_dwordx4 v[116:119], v1, s[4:7], s45 offen offset:256 sc1
 buffer_load_dwordx2 v[120:121], v7, s[4:7], s45 offen offset:512 sc1
 buffer_load_dwordx4 v[20:23], v2, s[4:7], s45 offen sc1
 buffer_load_dwordx4 v[24:27], v2, s[4:7], s45 offen offset:1024 sc1
 s_waitcnt vmcnt(4)
 v_mfma_f32_16x16x32_bf16 v[8:11], a[96:99], v[112:115], 0
 s_waitcnt vmcnt(3)
 v_mfma_f32_16x16x32_bf16 v[8:11], a[100:103], v[116:119], v[8:11]
 s_waitcnt vmcnt(2)
L_Ts:
 v_mfma_f32_16x16x16_bf16 v[12:15], a[104:105], v[120:121], v[28:31]
 v_max3_u32 v16, v112, v116, v120
 v_cmp_eq_u32 vcc, -1, v16
 s_cbranch_vccnz L_Tsr
 s_waitcnt vmcnt(1)
 v_smfmac_f32_16x16x64_bf16 v[36:39], v[20:23], a[0:7], v63
 v_smfmac_f32_16x16x64_bf16 v[44:47], v[20:23], a[32:39], v63
 v_fma_f32 v122, v8, s39, -v30
 v_fma_f32 v123, v9, s39, -v30
 v_smfmac_f32_16x16x64_bf16 v[40:43], v[20:23], a[16:23], v63
 v_exp_f32 v122, v122
 v_exp_f32 v123, v123
 v_smfmac_f32_16x16x64_bf16 v[48:51], v[20:23], a[48:55], v63
 v_fma_f32 v124, v10, s39, -v30
 v_fma_f32 v125, v11, s39, -v30
 s_waitcnt vmcnt(0)
 v_smfmac_f32_16x16x64_bf16 v[36:39], v[24:27], a[8:15], v63
 v_max_u32 v19, v20, v24
 v_exp_f32 v124, v124
 v_exp_f32 v125, v125
 v_smfmac_f32_16x16x64_bf16 v[44:47], v[24:27], a[40:47], v63
 v_cmp_eq_u32 vcc, -1, v19
 v_fma_f32 v126, v12, s39, -v30
 v_fma_f32 v127, v13, s39, -v30
 v_smfmac_f32_16x16x64_bf16 v[40:43], v[24:27], a[24:31], v63
 ds_write_b32 v58, v54
 v_exp_f32 v126, v126
 v_exp_f32 v127, v127
 v_smfmac_f32_16x16x64_bf16 v[48:51], v[24:27], a[56:63], v63
 v_cvt_pk_bf16_f32 v32, v122, v123
 v_cvt_pk_bf16_f32 v34, v124, v125
 s_cbranch_vccnz L_Tvr
L_Tv:
 v_cvt_pk_bf16_f32 v70, v36, v37
 v_cvt_pk_bf16_f32 v71, v38, v39
 v_cvt_pk_bf16_f32 v33, v126, v127
 v_cvt_pk_bf16_f32 v35, v126, v127
 v_cvt_pk_bf16_f32 v86, v44, v45
 v_cvt_pk_bf16_f32 v87, v46, v47
 v_smfmac_f32_16x16x64_bf16 v[96:99], v[32:35], v[64:71], v3
 v_cvt_pk_bf16_f32 v78, v40, v41
 v_cvt_pk_bf16_f32 v79, v42, v43
 v_smfmac_f32_16x16x64_bf16 v[104:107], v[32:35], v[80:87], v3
 v_cvt_pk_bf16_f32 v94, v48, v49
 v_cvt_pk_bf16_f32 v95, v50, v51
 v_smfmac_f32_16x16x64_bf16 v[100:103], v[32:35], v[72:79], v3
 s_nop 0
 v_smfmac_f32_16x16x64_bf16 v[108:111], v[32:35], v[88:95], v3
 v_mfma_f32_16x16x32_bf16 v[16:19], a[124:127], v[32:35], 0
 buffer_load_dwordx4 v[112:115], v59, s[4:7], s45 offen sc1
 buffer_load_dwordx4 v[116:119], v59, s[4:7], s45 offen offset:16 sc1
 v_permlane32_swap_b32 v96, v104
 v_permlane32_swap_b32 v97, v105
 v_permlane32_swap_b32 v98, v106
 v_permlane32_swap_b32 v99, v107
 v_permlane32_swap_b32 v100, v108
 v_permlane32_swap_b32 v101, v109
 v_add_f32_dpp v16, v16, v16 row_ror:8 row_mask:0xf bank_mask:0xf
 v_add_f32 v20, v96, v104
 v_add_f32 v21, v100, v108
 v_rcp_f32 v17, v16
 v_add_f32 v22, v97, v105
 v_add_f32 v23, v101, v109
 ds_write2_b64 v4, v[20:21], v[22:23] offset0:0 offset1:40
 v_permlane32_swap_b32 v102, v110
 v_permlane32_swap_b32 v103, v111
 ds_write_b32 v6, v17
 v_add_f32 v24, v98, v106
 v_add_f32 v25, v102, v110
 v_add_f32 v26, v99, v107
 v_add_f32 v27, v103, v111
 ds_write2_b64 v4, v[24:25], v[26:27] offset0:80 offset1:120
 v_log_f32 v18, v16
 v_accvgpr_read_b32 v120, a120
 v_accvgpr_read_b32 v121, a121
 v_cmp_nlt_f32 vcc, |v18|, s48
 v_accvgpr_read_b32 v122, a122
 v_add_f32 v30, v30, v18
 s_setprio 3
 s_cbranch_vccnz L_Tmx
L_Tb:
 s_waitcnt lgkmcnt(0)
 s_barrier
 ds_read2st64_b64 v[8:11], v120 offset0:0 offset1:5
 ds_read_b128 v[16:19], v121
 ds_read2st64_b64 v[12:15], v120 offset0:10 offset1:15
 s_waitcnt lgkmcnt(1)
 v_pk_mul_f32 v[8:9], v[8:9], v[16:17] op_sel:[0,0] op_sel_hi:[1,0]
 v_pk_fma_f32 v[8:9], v[10:11], v[16:17], v[8:9] op_sel:[0,1,0] op_sel_hi:[1,1,1]
 s_waitcnt lgkmcnt(0)
 v_pk_fma_f32 v[8:9], v[12:13], v[18:19], v[8:9] op_sel:[0,0,0] op_sel_hi:[1,0,1]
 v_pk_fma_f32 v[8:9], v[14:15], v[18:19], v[8:9] op_sel:[0,1,0] op_sel_hi:[1,1,1]
 v_cndmask_b32 v9, v9, 1.0, s[84:85]
 v_cvt_pk_bf16_f32 v123, v8, v9
 buffer_atomic_pk_add_bf16 v123, v122, s[4:7], s82 offen sc1
 s_setprio 0
 s_cmp_lt_u32 s15, 1
 s_cbranch_scc1 L_Te0
 s_waitcnt vmcnt(1)
L_Te:
 v_max_u32 v16, v112, v116
 v_cmp_eq_u32 vcc, -1, v16
 s_cbranch_vccnz L_Ter
 v_mfma_f32_16x16x32_bf16 v[8:11], a[96:99], v[112:115], 0
 v_mfma_f32_16x16x32_bf16 v[20:23], a[64:67], a[0:3], 0
 v_mfma_f32_16x16x32_bf16 v[8:11], a[100:103], v[116:119], v[8:11]
 v_mfma_f32_16x16x16_bf16 v[96:99], v[64:65], a[108:109], 0
 v_mfma_f32_16x16x16_bf16 v[100:103], v[72:73], a[108:109], 0
 v_mfma_f32_16x16x32_bf16 v[24:27], a[64:67], a[16:19], 0
 v_fma_f32 v12, v8, s39, -v60
 v_fma_f32 v13, v9, s39, -v60
 v_mfma_f32_16x16x16_bf16 v[104:107], v[80:81], a[108:109], 0
 v_fma_f32 v14, v10, s39, -v60
 v_fma_f32 v15, v11, s39, -v60
 v_mfma_f32_16x16x16_bf16 v[108:111], v[88:89], a[108:109], 0
 v_max3_f32 v16, v12, v13, v14
 v_max_f32 v16, v16, v15
 v_mfma_f32_16x16x16_bf16 v[36:39], v[64:65], a[114:115], 0
 v_cmp_lt_f32 vcc, 1109393408, v16
 v_exp_f32 v12, v12
 v_mfma_f32_16x16x16_bf16 v[40:43], v[72:73], a[114:115], 0
 v_exp_f32 v13, v13
 v_exp_f32 v14, v14
 v_mfma_f32_16x16x16_bf16 v[44:47], v[80:81], a[114:115], 0
 v_exp_f32 v15, v15
 s_add_u32 s15, s15, 1
 v_mfma_f32_16x16x16_bf16 v[48:51], v[88:89], a[114:115], 0
 buffer_load_dwordx4 a[80:83], v5, s[4:7], s49 offen offset:256 sc1
 v_mfma_f32_16x16x32_bf16 v[120:123], a[64:67], a[32:35], 0
 buffer_load_dwordx4 a[84:87], v5, s[4:7], s49 offen offset:2304 sc1
 v_mfma_f32_16x16x32_bf16 v[124:127], a[64:67], a[48:51], 0
 buffer_load_dwordx4 a[88:91], v5, s[4:7], s50 offen offset:256 sc1
 v_mfma_f32_16x16x32_bf16 v[20:23], a[68:71], a[4:7], v[20:23]
 buffer_load_dwordx4 a[92:95], v5, s[4:7], s50 offen offset:2304 sc1
 v_mfma_f32_16x16x32_bf16 v[24:27], a[68:71], a[20:23], v[24:27]
 s_cbranch_vccnz L_Tfb
 v_cvt_pk_bf16_f32 v8, v12, v13
 v_cvt_pk_bf16_f32 v10, v12, v13
 v_mfma_f32_16x16x32_bf16 v[120:123], a[68:71], a[36:39], v[120:123]
 v_cvt_pk_bf16_f32 v9, v14, v15
 v_cvt_pk_bf16_f32 v11, v14, v15
 v_add_f32 v16, v12, v13
 v_mfma_f32_16x16x32_bf16 v[124:127], a[68:71], a[52:55], v[124:127]
 v_permlane16_swap_b32 v8, v10
 v_add_f32 v17, v14, v15
 v_permlane16_swap_b32 v9, v11
 v_mfma_f32_16x16x32_bf16 v[20:23], a[72:75], a[8:11], v[20:23]
 v_accvgpr_write_b32 a112, v8
 v_add_f32 v16, v16, v17
 v_accvgpr_write_b32 a113, v9
 v_mfma_f32_16x16x32_bf16 v[24:27], a[72:75], a[24:27], v[24:27]
 v_accvgpr_write_b32 a118, v10
 v_accvgpr_write_b32 a119, v11
 v_mfma_f32_16x16x32_bf16 v[120:123], a[72:75], a[40:43], v[120:123]
 v_mfma_f32_16x16x32_bf16 v[96:99], v[68:71], a[110:113], v[96:99]
 v_mov_b32 v17, v16
 v_mfma_f32_16x16x32_bf16 v[100:103], v[76:79], a[110:113], v[100:103]
 v_mfma_f32_16x16x32_bf16 v[104:107], v[84:87], a[110:113], v[104:107]
 v_permlane32_swap_b32 v16, v17
 v_mfma_f32_16x16x32_bf16 v[108:111], v[92:95], a[110:113], v[108:111]
 v_add_f32 v16, v16, v17
 v_mfma_f32_16x16x32_bf16 v[36:39], v[68:71], a[116:119], v[36:39]
 v_add_f32 v16, v16, v61
 v_mfma_f32_16x16x32_bf16 v[40:43], v[76:79], a[116:119], v[40:43]
 v_mfma_f32_16x16x32_bf16 v[44:47], v[84:87], a[116:119], v[44:47]
 v_mfma_f32_16x16x32_bf16 v[48:51], v[92:95], a[116:119], v[48:51]
 v_mfma_f32_16x16x32_bf16 v[124:127], a[72:75], a[56:59], v[124:127]
L_Tj:
 v_rcp_f32 v16, v16
 v_mfma_f32_16x16x32_bf16 v[20:23], a[76:79], a[12:15], v[20:23]
 ds_write_b128 v62, v[96:99] offset:0
 v_mfma_f32_16x16x32_bf16 v[24:27], a[76:79], a[28:31], v[24:27]
 ds_write_b128 v62, v[100:103] offset:16
 v_mfma_f32_16x16x32_bf16 v[120:123], a[76:79], a[44:47], v[120:123]
 ds_write_b128 v62, v[104:107] offset:32
 v_mfma_f32_16x16x32_bf16 v[124:127], a[76:79], a[60:63], v[124:127]
 ds_write_b128 v62, v[108:111] offset:48
 s_waitcnt vmcnt(3)
 v_mfma_f32_16x16x32_bf16 v[8:11], a[80:83], a[0:3], 0
 ds_write_b32 v52, v16
 v_mfma_f32_16x16x32_bf16 v[12:15], a[80:83], a[16:19], 0
 ds_write_b128 v62, v[36:39] offset:4352
 v_mfma_f32_16x16x32_bf16 v[112:115], a[80:83], a[32:35], 0
 v_cvt_pk_bf16_f32 v64, v20, v21
 v_mfma_f32_16x16x32_bf16 v[116:119], a[80:83], a[48:51], 0
 ds_write_b128 v62, v[40:43] offset:4368
 s_waitcnt vmcnt(2)
 v_mfma_f32_16x16x32_bf16 v[8:11], a[84:87], a[4:7], v[8:11]
 v_cvt_pk_bf16_f32 v65, v22, v23
 v_mfma_f32_16x16x32_bf16 v[12:15], a[84:87], a[20:23], v[12:15]
 ds_write_b128 v62, v[44:47] offset:4384
 v_mfma_f32_16x16x32_bf16 v[112:115], a[84:87], a[36:39], v[112:115]
 v_cvt_pk_bf16_f32 v72, v24, v25
 v_mfma_f32_16x16x32_bf16 v[116:119], a[84:87], a[52:55], v[116:119]
 ds_write_b128 v62, v[48:51] offset:4400
 s_waitcnt vmcnt(1)
 v_mfma_f32_16x16x32_bf16 v[8:11], a[88:91], a[8:11], v[8:11]
 buffer_load_dwordx4 a[108:111], v56, s[4:7], s49 offen sc1
 v_cvt_pk_bf16_f32 v73, v26, v27
 v_mfma_f32_16x16x32_bf16 v[12:15], a[88:91], a[24:27], v[12:15]
 v_cvt_pk_bf16_f32 v80, v120, v121
 v_mfma_f32_16x16x32_bf16 v[112:115], a[88:91], a[40:43], v[112:115]
 buffer_load_dwordx4 a[114:117], v56, s[4:7], s49 offen offset:1024 sc1
 v_cvt_pk_bf16_f32 v81, v122, v123
 v_mfma_f32_16x16x32_bf16 v[116:119], a[88:91], a[56:59], v[116:119]
 v_cvt_pk_bf16_f32 v88, v124, v125
 s_waitcnt vmcnt(2)
 v_mfma_f32_16x16x32_bf16 v[8:11], a[92:95], a[12:15], v[8:11]
 buffer_load_dwordx2 v[60:61], v57, s[4:7], s49 offen offset:2048 sc1
 v_cvt_pk_bf16_f32 v89, v126, v127
 v_mfma_f32_16x16x32_bf16 v[12:15], a[92:95], a[28:31], v[12:15]
 v_mfma_f32_16x16x32_bf16 v[112:115], a[92:95], a[44:47], v[112:115]
 v_mfma_f32_16x16x32_bf16 v[116:119], a[92:95], a[60:63], v[116:119]
 v_xor_b32 v62, 0x10000, v62
 v_xor_b32 v52, 0x10000, v52
 s_cmp_lg_u32 s15, 64
 s_cbranch_scc1 L_Tux
 s_waitcnt lgkmcnt(0)
 s_barrier
 s_branch L_cend
L_Tfb:
 v_max3_f32 v16, v8, v9, v10
 v_max_f32 v16, v16, v11
 v_mov_b32 v17, v16
 s_nop 1
 v_permlane32_swap_b32 v16, v17
 v_max_f32 v16, v16, v17
 v_mul_f32 v16, s39, v16
 v_max_f32 v16, v16, v60
 v_fma_f32 v8, v8, s39, -v16
 v_fma_f32 v9, v9, s39, -v16
 v_fma_f32 v10, v10, s39, -v16
 v_fma_f32 v11, v11, s39, -v16
 v_sub_f32 v18, v60, v16
 v_exp_f32 v8, v8
 v_exp_f32 v9, v9
 v_exp_f32 v10, v10
 v_exp_f32 v11, v11
 v_exp_f32 v18, v18
 v_mfma_f32_16x16x16_bf16 v[96:99], v[68:69], a[110:111], v[96:99]
 v_mfma_f32_16x16x16_bf16 v[100:103], v[76:77], a[110:111], v[100:103]
 v_mfma_f32_16x16x16_bf16 v[104:107], v[84:85], a[110:111], v[104:107]
 v_mfma_f32_16x16x16_bf16 v[108:111], v[92:93], a[110:111], v[108:111]
 v_mfma_f32_16x16x16_bf16 v[36:39], v[68:69], a[116:117], v[36:39]
 v_mfma_f32_16x16x16_bf16 v[40:43], v[76:77], a[116:117], v[40:43]
 v_mfma_f32_16x16x16_bf16 v[44:47], v[84:85], a[116:117], v[44:47]
 v_mfma_f32_16x16x16_bf16 v[48:51], v[92:93], a[116:117], v[48:51]
 v_add_f32 v16, v8, v9
 v_add_f32 v17, v10, v11
 v_add_f32 v16, v16, v17
 v_mov_b32 v17, v16
 s_nop 1
 v_permlane32_swap_b32 v16, v17
 v_add_f32 v16, v16, v17
 v_fmac_f32 v16, v18, v61
 v_cvt_pk_bf16_f32 v12, v8, v9
 v_cvt_pk_bf16_f32 v13, v10, v11
 v_cvt_pk_bf16_f32 v14, v8, v9
 v_cvt_pk_bf16_f32 v15, v10, v11
 v_mov_b32 v19, v18
 v_permlane16_swap_b32 v12, v14
 v_permlane16_swap_b32 v13, v15
 v_permlane16_swap_b32 v18, v19
 v_mul_f32 v96, v96, v18
 v_mul_f32 v97, v97, v18
 v_mul_f32 v98, v98, v18
 v_mul_f32 v99, v99, v18
 v_mul_f32 v100, v100, v18
 v_mul_f32 v101, v101, v18
 v_mul_f32 v102, v102, v18
 v_mul_f32 v103, v103, v18
 v_mul_f32 v104, v104, v18
 v_mul_f32 v105, v105, v18
 v_mul_f32 v106, v106, v18
 v_mul_f32 v107, v107, v18
 v_mul_f32 v108, v108, v18
 v_mul_f32 v109, v109, v18
 v_mul_f32 v110, v110, v18
 v_mul_f32 v111, v111, v18
 v_mul_f32 v36, v36, v19
 v_mul_f32 v37, v37, v19
 v_mul_f32 v38, v38, v19
 v_mul_f32 v39, v39, v19
 v_mul_f32 v40, v40, v19
 v_mul_f32 v41, v41, v19
 v_mul_f32 v42, v42, v19
 v_mul_f32 v43, v43, v19
 v_mul_f32 v44, v44, v19
 v_mul_f32 v45, v45, v19
 v_mul_f32 v46, v46, v19
 v_mul_f32 v47, v47, v19
 v_mul_f32 v48, v48, v19
 v_mul_f32 v49, v49, v19
 v_mul_f32 v50, v50, v19
 v_mul_f32 v51, v51, v19
 v_mfma_f32_16x16x16_bf16 v[96:99], v[70:71], v[12:13], v[96:99]
 v_mfma_f32_16x16x16_bf16 v[100:103], v[78:79], v[12:13], v[100:103]
 v_mfma_f32_16x16x16_bf16 v[104:107], v[86:87], v[12:13], v[104:107]
 v_mfma_f32_16x16x16_bf16 v[108:111], v[94:95], v[12:13], v[108:111]
 v_mfma_f32_16x16x16_bf16 v[36:39], v[70:71], v[14:15], v[36:39]
 v_mfma_f32_16x16x16_bf16 v[40:43], v[78:79], v[14:15], v[40:43]
 v_mfma_f32_16x16x16_bf16 v[44:47], v[86:87], v[14:15], v[44:47]
 v_mfma_f32_16x16x16_bf16 v[48:51], v[94:95], v[14:15], v[48:51]
 v_mfma_f32_16x16x32_bf16 v[120:123], a[68:71], a[36:39], v[120:123]
 v_mfma_f32_16x16x32_bf16 v[124:127], a[68:71], a[52:55], v[124:127]
 v_mfma_f32_16x16x32_bf16 v[20:23], a[72:75], a[8:11], v[20:23]
 v_mfma_f32_16x16x32_bf16 v[24:27], a[72:75], a[24:27], v[24:27]
 v_mfma_f32_16x16x32_bf16 v[120:123], a[72:75], a[40:43], v[120:123]
 v_mfma_f32_16x16x32_bf16 v[124:127], a[72:75], a[56:59], v[124:127]
 s_branch L_Tj
L_Te0:
 buffer_load_dwordx4 a[108:111], v56, s[4:7], 0 offen sc1
 buffer_load_dwordx4 a[114:117], v56, s[4:7], 0 offen offset:1024 sc1
 buffer_load_dwordx2 v[60:61], v57, s[4:7], 0 offen offset:2048 sc1
 s_waitcnt vmcnt(0)
 s_branch L_Te
L_Ter:
 buffer_load_dwordx4 v[112:115], v59, s[4:7], s45 offen sc1
 buffer_load_dwordx4 v[116:119], v59, s[4:7], s45 offen offset:16 sc1
 s_add_u32 s60, s60, 6
 s_cmp_gt_u32 s60, 134217728
 s_cbranch_scc1 L_end
 s_waitcnt vmcnt(0)
 s_branch L_Te
L_Tmx:
 v_max3_f32 v16, v8, v9, v10
 v_max3_f32 v16, v16, v11, v12
 v_max_f32 v16, v16, v13
 s_nop 1
 v_max_f32_dpp v17, v16, v16 row_ror:8 row_mask:0xf bank_mask:0xf
 v_max_f32_dpp v16, v16, v16 row_ror:8 row_mask:0xf bank_mask:0xf
 s_nop 1
 v_permlane16_swap_b32 v16, v17
 v_max_f32 v18, v16, v17
 v_max_f32 v16, v16, v17
 s_nop 1
 v_permlane32_swap_b32 v16, v18
 v_max_f32 v16, v16, v18
 v_mul_f32 v30, s39, v16
 v_mov_b32 v96, 0
 v_mov_b32 v97, 0
 v_mov_b32 v98, 0
 v_mov_b32 v99, 0
 v_mov_b32 v100, 0
 v_mov_b32 v101, 0
 v_mov_b32 v102, 0
 v_mov_b32 v103, 0
 v_mov_b32 v104, 0
 v_mov_b32 v105, 0
 v_mov_b32 v106, 0
 v_mov_b32 v107, 0
 v_mov_b32 v108, 0
 v_mov_b32 v109, 0
 v_mov_b32 v110, 0
 v_mov_b32 v111, 0
 v_fma_f32 v122, v8, s39, -v30
 v_fma_f32 v123, v9, s39, -v30
 v_fma_f32 v124, v10, s39, -v30
 v_fma_f32 v125, v11, s39, -v30
 v_fma_f32 v126, v12, s39, -v30
 v_fma_f32 v127, v13, s39, -v30
 v_exp_f32 v122, v122
 v_exp_f32 v123, v123
 v_exp_f32 v124, v124
 v_exp_f32 v125, v125
 v_exp_f32 v126, v126
 v_exp_f32 v127, v127
 v_cvt_pk_bf16_f32 v32, v122, v123
 v_cvt_pk_bf16_f32 v34, v124, v125
 v_cvt_pk_bf16_f32 v33, v126, v127
 v_cvt_pk_bf16_f32 v35, v126, v127
 s_nop 1
 v_smfmac_f32_16x16x64_bf16 v[96:99], v[32:35], v[64:71], v3
 v_smfmac_f32_16x16x64_bf16 v[104:107], v[32:35], v[80:87], v3
 v_smfmac_f32_16x16x64_bf16 v[100:103], v[32:35], v[72:79], v3
 v_smfmac_f32_16x16x64_bf16 v[108:111], v[32:35], v[88:95], v3
 v_mfma_f32_16x16x32_bf16 v[16:19], a[124:127], v[32:35], 0
 v_permlane32_swap_b32 v96, v104
 v_permlane32_swap_b32 v97, v105
 v_permlane32_swap_b32 v98, v106
 v_permlane32_swap_b32 v99, v107
 v_permlane32_swap_b32 v100, v108
 v_permlane32_swap_b32 v101, v109
 v_permlane32_swap_b32 v102, v110
 v_permlane32_swap_b32 v103, v111
 v_add_f32_dpp v16, v16, v16 row_ror:8 row_mask:0xf bank_mask:0xf
 v_rcp_f32 v17, v16
 v_add_f32 v20, v96, v104
 v_add_f32 v21, v100, v108
 v_add_f32 v22, v97, v105
 v_add_f32 v23, v101, v109
 ds_write2_b64 v4, v[20:21], v[22:23] offset0:0 offset1:40
 v_add_f32 v24, v98, v106
 v_add_f32 v25, v102, v110
 v_add_f32 v26, v99, v107
 v_add_f32 v27, v103, v111
 ds_write2_b64 v4, v[24:25], v[26:27] offset0:80 offset1:120
 ds_write_b32 v6, v17
 v_accvgpr_read_b32 v122, a122
 s_branch L_Tb
L_Tsr:
 s_mov_b64 exec, vcc
 buffer_load_dwordx4 v[112:115], v1, s[4:7], s45 offen sc1
 buffer_load_dwordx4 v[116:119], v1, s[4:7], s45 offen offset:256 sc1
 buffer_load_dwordx2 v[120:121], v7, s[4:7], s45 offen offset:512 sc1
 s_mov_b64 exec, -1
 buffer_load_dwordx4 v[20:23], v2, s[4:7], s45 offen offset:0 sc1
 buffer_load_dwordx4 v[24:27], v2, s[4:7], s45 offen offset:1024 sc1
 s_add_u32 s60, s60, 6
 s_cmp_gt_u32 s60, 134217728
 s_cbranch_scc1 L_end
 s_waitcnt vmcnt(2)
 v_mfma_f32_16x16x32_bf16 v[8:11], a[96:99], v[112:115], 0
 v_mfma_f32_16x16x32_bf16 v[8:11], a[100:103], v[116:119], v[8:11]
 s_branch L_Ts
L_Tvr:
 s_mov_b64 exec, vcc
 buffer_load_dwordx4 v[20:23], v2, s[4:7], s45 offen offset:0 sc1
 buffer_load_dwordx4 v[24:27], v2, s[4:7], s45 offen offset:1024 sc1
 s_mov_b64 exec, -1
 s_add_u32 s60, s60, 6
 s_cmp_gt_u32 s60, 134217728
 s_cbranch_scc1 L_end
 v_mov_b32 v36, 0
 v_mov_b32 v37, 0
 v_mov_b32 v38, 0
 v_mov_b32 v39, 0
 v_mov_b32 v40, 0
 v_mov_b32 v41, 0
 v_mov_b32 v42, 0
 v_mov_b32 v43, 0
 v_mov_b32 v44, 0
 v_mov_b32 v45, 0
 v_mov_b32 v46, 0
 v_mov_b32 v47, 0
 v_mov_b32 v48, 0
 v_mov_b32 v49, 0
 v_mov_b32 v50, 0
 v_mov_b32 v51, 0
 s_waitcnt vmcnt(0)
 v_max_u32 v19, v20, v24
 v_cmp_eq_u32 vcc, -1, v19
 s_cbranch_vccnz L_Tvr
 v_smfmac_f32_16x16x64_bf16 v[36:39], v[20:23], a[0:7], v63
 v_smfmac_f32_16x16x64_bf16 v[40:43], v[20:23], a[16:23], v63
 v_smfmac_f32_16x16x64_bf16 v[44:47], v[20:23], a[32:39], v63
 v_smfmac_f32_16x16x64_bf16 v[48:51], v[20:23], a[48:55], v63
 v_smfmac_f32_16x16x64_bf16 v[36:39], v[24:27], a[8:15], v63
 v_smfmac_f32_16x16x64_bf16 v[40:43], v[24:27], a[24:31], v63
 v_smfmac_f32_16x16x64_bf16 v[44:47], v[24:27], a[40:47], v63
 v_smfmac_f32_16x16x64_bf16 v[48:51], v[24:27], a[56:63], v63
 s_branch L_Tv
L_cend:
 s_waitcnt vmcnt(0)
 s_barrier
 s_cmp_lg_u32 s14, 2
 s_cbranch_scc1 L_end
 v_mov_b32 v8, 100
 s_mov_b64 exec, 1
 buffer_store_dword v8, off, s[4:7], s51 sc1
 s_branch L_end
L_next:
 s_add_u32 s62, s62, 1
 s_cmp_gt_u32 s62, 400
 s_cbranch_scc1 L_end
 s_waitcnt vmcnt(0)
 s_barrier
 v_mov_b32 v11, 163776
 s_cmp_lg_u32 s14, 0
 s_cbranch_scc1 L_n2
 s_mov_b64 exec, 1
 s_lshl_b32 s10, s12, 5
 s_add_u32 s10, s10, 24
 v_mov_b32 v8, s10
 v_mov_b32 v9, 1
 global_atomic_add v10, v8, v9, s[16:17] sc0 sc1
 s_cmp_lg_u32 s63, 0
 s_cbranch_scc1 L_n0
 v_mov_b32 v8, 128
L_ni:
 s_sleep 8
 global_load_dword v9, v8, s[16:17] sc1
 s_waitcnt vmcnt(0)
 s_add_u32 s61, s61, 1
 s_cmp_gt_u32 s61, 2000000
 s_cbranch_scc1 L_n0
 v_cmp_ne_u32 vcc, 248, v9
 s_cbranch_vccnz L_ni
L_n0:
 s_cmp_eq_u32 s37, 0
 s_cbranch_scc1 L_n1
 s_mov_b32 exec_lo, s37
 v_lshlrev_b32 v8, 7, v0
 v_mov_b32 v9, s39
 buffer_atomic_add v9, v8, s[4:7], s36 offen sc1
 s_mov_b64 exec, 1
 s_waitcnt vmcnt(1)
 s_branch L_n3
L_n1:
 s_waitcnt vmcnt(0)
L_n3:
 ds_write_b32 v11, v10
 s_mov_b64 exec, -1
 s_waitcnt lgkmcnt(0)
L_n2:
 s_mov_b32 s63, 1
 s_barrier
 ds_read_b32 v10, v11
 s_waitcnt lgkmcnt(0)
 v_readfirstlane_b32 s40, v10
 s_add_u32 s40, s40, 16
L_disp:
 s_mov_b32 s37, 1
 s_mov_b32 s39, 1
 s_load_dwordx2 s[8:9], s[0:1], 0
 s_mov_b32 s10, 4194304
 s_mov_b32 s11, 0x20000
 s_cmp_ge_u32 s40, 12
 s_cbranch_scc1 L_d0
 s_lshr_b32 s41, s40, 2
 s_lshl_b32 s33, s41, 3
 s_lshr_b32 s34, 0x483840, s33
 s_and_b32 s34, s34, 0xff
 s_load_dwordx2 s[20:21], s[0:1], s34
 s_mov_b32 s22, 0x800000
 s_mov_b32 s23, 0x20000
 s_and_b32 s34, s40, 3
 s_lshl_b32 s35, s12, 2
 s_add_u32 s34, s34, s35
 s_lshl_b32 s25, s34, 8
 s_lshl_b32 s27, s34, 13
 s_lshr_b32 s34, 0x020301, s33
 s_lshl_b32 s34, s34, 24
 s_add_u32 s27, s27, s34
 s_mov_b32 s28, 0x40000
 s_mov_b32 s32, 8192
 s_lshl_b32 s36, s41, 2
 s_add_u32 s36, s36, s25
 s_add_u32 s36, s36, 2293760
 s_branch L_ws
L_d0:
 s_sub_u32 s40, s40, 12
 s_cmp_ge_u32 s40, 1
 s_cbranch_scc1 L_d1
 s_load_dwordx2 s[20:21], s[0:1], 8
 s_mov_b32 s22, 0x200000
 s_mov_b32 s23, 0x20000
 s_lshl_b32 s25, s12, 8
 s_lshl_b32 s27, s12, 13
 s_add_u32 s27, s27, 100663296
 s_mov_b32 s28, 65536
 s_mov_b32 s32, 2048
 s_lshl_b32 s36, s12, 2
 s_add_u32 s36, s36, 2301952
 s_branch L_ws
L_d1:
 s_sub_u32 s40, s40, 1
 s_cmp_ge_u32 s40, 1
 s_cbranch_scc1 L_d2
 s_branch L_akv
L_d2:
 s_sub_u32 s40, s40, 1
 s_cmp_ge_u32 s40, 2
 s_cbranch_scc1 L_d3
 s_add_u32 s24, s40, 0
 s_branch L_sx
L_d3:
 s_sub_u32 s40, s40, 2
 s_cmp_ge_u32 s40, 16
 s_cbranch_scc1 L_d4
 s_add_u32 s40, s40, 0
 s_lshr_b32 s24, s40, 1
 s_lshl_b32 s24, s24, 3
 s_add_u32 s24, s24, s12
 s_and_b32 s25, s40, 1
 s_branch L_attA
L_d4:
 s_sub_u32 s40, s40, 16
 s_cmp_ge_u32 s40, 6
 s_cbranch_scc1 L_d5
 s_branch L_pr
L_d5:
 s_sub_u32 s40, s40, 6
 s_cmp_ge_u32 s40, 16
 s_cbranch_scc1 L_d6
 s_lshl_b32 s25, s40, 7
 s_branch L_op
L_d6:
 s_sub_u32 s40, s40, 16
 s_branch L_end
L_ws:
 v_mov_b32 v1, 0
 v_mov_b32 v2, 1
 v_mov_b32 v3, 128
 s_cmp_lg_u32 s14, 7
 s_cbranch_scc1 L_ws0
 s_mov_b64 exec, 1
 buffer_store_dword v1, off, s[4:7], s36 sc1
 s_mov_b64 exec, -1
L_ws0:
 s_lshl_b32 s33, s14, 2
 v_lshrrev_b32 v16, 4, v0
 v_and_b32 v17, 15, v0
 v_add_u32 v18, s33, v16
 v_lshlrev_b32 v19, 2, v16
 v_xor_b32 v19, v19, v17
 v_mul_u32_u24 v4, s32, v18
 v_lshl_add_u32 v4, v19, 4, v4
 s_lshl_b32 s33, s32, 9
 s_sub_u32 s33, s33, 1024
 v_add_u32 v5, s33, v4
 v_and_b32 v19, 15, v18
 v_xor_b32 v19, v19, v17
 v_lshlrev_b32 v6, 11, v18
 v_lshl_add_u32 v6, v19, 4, v6
 v_and_b32 v11, 32767, v6
 s_lshl_b32 s26, s32, 5
 s_lshl_b32 s30, s14, 11
 s_and_b32 s33, s13, 3
 s_lshl_b32 s24, s33, 8
 s_mul_i32 s34, s24, s32
 s_lshr_b32 s34, s34, 1
 s_add_u32 s25, s25, s34
 s_mul_i32 s49, s26, -15
 s_cmp_eq_u32 s33, 3
 s_mov_b32 s34, -768
 s_cselect_b32 s44, s34, 256
 s_cmp_eq_u32 s33, 2
 s_mov_b32 s34, -768
 s_cselect_b32 s45, s34, 256
 s_cmp_eq_u32 s33, 1
 s_mov_b32 s34, -768
 s_cselect_b32 s46, s34, 256
 s_cmp_eq_u32 s33, 0
 s_mov_b32 s34, 64768
 s_cselect_b32 s47, s34, 65792
 s_add_u32 s31, s30, 131072
 s_mov_b32 s42, s24
 s_add_u32 s24, s24, 0x20000
 s_waitcnt lgkmcnt(0)
 s_barrier
 s_lshl_b32 s50, s32, 4
 s_cmp_lt_u32 s14, 4
 s_cbranch_scc1 L_wsw
 s_add_u32 m0, s31, -8192
 s_add_u32 s43, s42, 0
 buffer_load_dwordx4 v11, s[8:11], s43 offen lds
 buffer_load_dwordx4 v11, s[8:11], s43 offen offset:1024 lds
 s_add_u32 m0, s31, 0
 s_add_u32 s43, s42, 32768
 buffer_load_dwordx4 v11, s[8:11], s43 offen lds
 buffer_load_dwordx4 v11, s[8:11], s43 offen offset:1024 lds
 s_add_u32 m0, s31, 8192
 s_add_u32 s43, s42, 65536
 buffer_load_dwordx4 v11, s[8:11], s43 offen lds
 buffer_load_dwordx4 v11, s[8:11], s43 offen offset:1024 lds
 s_add_u32 m0, s31, 16384
 s_add_u32 s43, s42, 98304
 buffer_load_dwordx4 v11, s[8:11], s43 offen lds
 buffer_load_dwordx4 v11, s[8:11], s43 offen offset:1024 lds
 s_add_u32 s42, s42, s44
 s_branch L_wsx
L_wsw:
 s_add_u32 m0, s30, 0
 s_add_u32 s43, s25, s50
 buffer_load_dwordx4 v4, s[20:23], s25 offen nt lds
 buffer_load_dwordx4 v5, s[20:23], s25 offen offset:1024 nt lds
 s_add_u32 m0, s30, 8192
 s_add_u32 s25, s25, s26
 buffer_load_dwordx4 v4, s[20:23], s43 offen nt lds
 buffer_load_dwordx4 v5, s[20:23], s43 offen offset:1024 nt lds
 s_add_u32 m0, s30, 16384
 s_add_u32 s43, s25, s50
 buffer_load_dwordx4 v4, s[20:23], s25 offen nt lds
 buffer_load_dwordx4 v5, s[20:23], s25 offen offset:1024 nt lds
 s_add_u32 m0, s30, 24576
 s_add_u32 s25, s25, s26
 buffer_load_dwordx4 v4, s[20:23], s43 offen nt lds
 buffer_load_dwordx4 v5, s[20:23], s43 offen offset:1024 nt lds
 s_add_u32 m0, s30, 32768
 s_add_u32 s43, s25, s50
 buffer_load_dwordx4 v4, s[20:23], s25 offen nt lds
 buffer_load_dwordx4 v5, s[20:23], s25 offen offset:1024 nt lds
 s_add_u32 m0, s30, 40960
 s_add_u32 s25, s25, s26
 buffer_load_dwordx4 v4, s[20:23], s43 offen nt lds
 buffer_load_dwordx4 v5, s[20:23], s43 offen offset:1024 nt lds
 s_add_u32 m0, s30, 49152
 s_add_u32 s43, s25, s50
 buffer_load_dwordx4 v4, s[20:23], s25 offen nt lds
 buffer_load_dwordx4 v5, s[20:23], s25 offen offset:1024 nt lds
 s_add_u32 m0, s30, 57344
 s_cmp_lt_i32 s44, 0
 s_cselect_b32 s48, s49, s26
 s_add_u32 s25, s25, s48
 buffer_load_dwordx4 v4, s[20:23], s43 offen nt lds
 buffer_load_dwordx4 v5, s[20:23], s43 offen offset:1024 nt lds
 s_add_u32 m0, s30, 65536
 s_add_u32 s43, s25, s50
 buffer_load_dwordx4 v4, s[20:23], s25 offen nt lds
 buffer_load_dwordx4 v5, s[20:23], s25 offen offset:1024 nt lds
 s_add_u32 m0, s30, 73728
 s_add_u32 s25, s25, s26
 buffer_load_dwordx4 v4, s[20:23], s43 offen nt lds
 buffer_load_dwordx4 v5, s[20:23], s43 offen offset:1024 nt lds
 s_add_u32 m0, s30, 81920
 s_add_u32 s43, s25, s50
 buffer_load_dwordx4 v4, s[20:23], s25 offen nt lds
 buffer_load_dwordx4 v5, s[20:23], s25 offen offset:1024 nt lds
 s_add_u32 m0, s30, 90112
 s_add_u32 s25, s25, s26
 buffer_load_dwordx4 v4, s[20:23], s43 offen nt lds
 buffer_load_dwordx4 v5, s[20:23], s43 offen offset:1024 nt lds
 s_add_u32 m0, s30, 98304
 s_add_u32 s43, s25, s50
 buffer_load_dwordx4 v4, s[20:23], s25 offen nt lds
 buffer_load_dwordx4 v5, s[20:23], s25 offen offset:1024 nt lds
 s_add_u32 m0, s30, 106496
 s_add_u32 s25, s25, s26
 buffer_load_dwordx4 v4, s[20:23], s43 offen nt lds
 buffer_load_dwordx4 v5, s[20:23], s43 offen offset:1024 nt lds
L_wsx:
 s_lshr_b32 s33, s14, 2
 s_and_b32 s34, s14, 3
 s_lshl_b32 s35, s33, 10
 v_bfe_u32 v18, v0, 2, 2
 v_and_b32 v19, 3, v0
 v_lshl_add_u32 v7, v16, 12, s35
 v_lshl_add_u32 v7, v18, 8, v7
 v_xor_b32 v20, s34, v18
 v_lshl_add_u32 v20, v20, 2, v19
 v_lshl_add_u32 v7, v20, 4, v7
 v_add_u32 v8, 65536, v7
 v_lshlrev_b32 v15, 9, v16
 v_lshl_add_u32 v15, v17, 4, v15
 v_lshl_add_u32 v18, v18, 11, s35
 v_lshl_add_u32 v18, v19, 8, v18
 v_xor_b32 v16, v16, v17
 v_lshl_add_u32 v16, v16, 4, v18
 v_xor_b32 v17, 64, v16
 v_xor_b32 v18, 128, v16
 v_xor_b32 v19, 192, v16
 v_add_u32 v20, 65536, v16
 v_add_u32 v24, 131072, v16
 v_add_u32 v21, 65536, v17
 v_add_u32 v25, 131072, v17
 v_add_u32 v22, 65536, v18
 v_add_u32 v26, 131072, v18
 v_add_u32 v23, 65536, v19
 v_add_u32 v27, 131072, v19
 v_lshl_add_u32 v9, v0, 4, s31
 v_xor_b32 v10, 8192, v9
 s_lshl_b32 s34, s34, 11
 s_add_u32 s27, s27, s34
 s_lshl_b32 s34, s33, 8
 s_add_u32 s27, s27, s34
 s_mov_b32 s29, 0
 s_mov_b32 s38, 2
 s_cmp_lg_u32 s14, 7
 s_cbranch_scc1 L_ws1
 s_waitcnt vmcnt(8)
 s_mov_b64 exec, 1
 global_atomic_add v3, v2, s[16:17] sc1
 s_mov_b64 exec, -1
L_ws1:
 s_cmp_lg_u32 s33, 0
 s_cbranch_scc1 L_wsb
L_wsa:
 s_waitcnt vmcnt(24) lgkmcnt(0)
 s_barrier
 s_add_u32 m0, s30, 114688
 s_add_u32 s43, s25, s50
 buffer_load_dwordx4 v4, s[20:23], s25 offen nt lds
 buffer_load_dwordx4 v5, s[20:23], s25 offen offset:1024 nt lds
 s_add_u32 m0, s30, 122880
 s_cmp_lt_i32 s45, 0
 s_cselect_b32 s48, s49, s26
 s_add_u32 s25, s25, s48
 buffer_load_dwordx4 v4, s[20:23], s43 offen nt lds
 buffer_load_dwordx4 v5, s[20:23], s43 offen offset:1024 nt lds
 ds_read_b64_tr_b16 a[0:1], v7 offset:0
 ds_read_b64_tr_b16 a[2:3], v7 offset:2048
 ds_read_b64_tr_b16 a[4:5], v7 offset:8
 ds_read_b64_tr_b16 a[6:7], v7 offset:2056
 ds_read_b128 v[96:99], v24 offset:0
 ds_read_b128 v[100:103], v24 offset:8192
 ds_read_b128 v[104:107], v25 offset:0
 ds_read_b128 v[108:111], v25 offset:8192
 ds_read_b128 v[112:115], v26 offset:0
 ds_read_b128 v[116:119], v26 offset:8192
 ds_read_b128 v[120:123], v27 offset:0
 ds_read_b128 v[124:127], v27 offset:8192
 ds_read_b128 v[32:35], v24 offset:16384
 ds_read_b128 v[36:39], v24 offset:24576
 ds_read_b128 v[40:43], v25 offset:16384
 ds_read_b128 v[44:47], v25 offset:24576
 ds_read_b128 v[48:51], v26 offset:16384
 ds_read_b128 v[52:55], v26 offset:24576
 ds_read_b128 v[56:59], v27 offset:16384
 ds_read_b128 v[60:63], v27 offset:24576
 s_waitcnt vmcnt(24) lgkmcnt(0)
 s_barrier
 s_add_u32 m0, s30, 0
 s_add_u32 s43, s25, s50
 buffer_load_dwordx4 v4, s[20:23], s25 offen nt lds
 buffer_load_dwordx4 v5, s[20:23], s25 offen offset:1024 nt lds
 s_add_u32 m0, s30, 8192
 s_add_u32 s25, s25, s26
 buffer_load_dwordx4 v4, s[20:23], s43 offen nt lds
 buffer_load_dwordx4 v5, s[20:23], s43 offen offset:1024 nt lds
 ds_read_b64_tr_b16 a[8:9], v7 offset:16384
 ds_read_b64_tr_b16 a[10:11], v7 offset:18432
 ds_read_b64_tr_b16 a[12:13], v7 offset:16392
 ds_read_b64_tr_b16 a[14:15], v7 offset:18440
 v_mfma_f32_16x16x32_bf16 v[64:67], a[0:3], v[96:99], 0
 v_mfma_f32_16x16x32_bf16 v[68:71], a[4:7], v[96:99], 0
 v_mfma_f32_16x16x32_bf16 v[72:75], a[0:3], v[100:103], 0
 v_mfma_f32_16x16x32_bf16 v[76:79], a[4:7], v[100:103], 0
 v_mfma_f32_16x16x32_bf16 v[80:83], a[0:3], v[32:35], 0
 v_mfma_f32_16x16x32_bf16 v[84:87], a[4:7], v[32:35], 0
 v_mfma_f32_16x16x32_bf16 v[88:91], a[0:3], v[36:39], 0
 v_mfma_f32_16x16x32_bf16 v[92:95], a[4:7], v[36:39], 0
 s_waitcnt vmcnt(24) lgkmcnt(0)
 s_barrier
 s_add_u32 m0, s30, 16384
 s_add_u32 s43, s25, s50
 buffer_load_dwordx4 v4, s[20:23], s25 offen nt lds
 buffer_load_dwordx4 v5, s[20:23], s25 offen offset:1024 nt lds
 s_add_u32 m0, s30, 24576
 s_add_u32 s25, s25, s26
 buffer_load_dwordx4 v4, s[20:23], s43 offen nt lds
 buffer_load_dwordx4 v5, s[20:23], s43 offen offset:1024 nt lds
 ds_read_b64_tr_b16 a[16:17], v7 offset:32768
 ds_read_b64_tr_b16 a[18:19], v7 offset:34816
 ds_read_b64_tr_b16 a[20:21], v7 offset:32776
 ds_read_b64_tr_b16 a[22:23], v7 offset:34824
 v_mfma_f32_16x16x32_bf16 v[64:67], a[8:11], v[104:107], v[64:67]
 v_mfma_f32_16x16x32_bf16 v[68:71], a[12:15], v[104:107], v[68:71]
 v_mfma_f32_16x16x32_bf16 v[72:75], a[8:11], v[108:111], v[72:75]
 v_mfma_f32_16x16x32_bf16 v[76:79], a[12:15], v[108:111], v[76:79]
 v_mfma_f32_16x16x32_bf16 v[80:83], a[8:11], v[40:43], v[80:83]
 v_mfma_f32_16x16x32_bf16 v[84:87], a[12:15], v[40:43], v[84:87]
 v_mfma_f32_16x16x32_bf16 v[88:91], a[8:11], v[44:47], v[88:91]
 v_mfma_f32_16x16x32_bf16 v[92:95], a[12:15], v[44:47], v[92:95]
 s_waitcnt vmcnt(24) lgkmcnt(0)
 s_barrier
 s_add_u32 m0, s30, 32768
 s_add_u32 s43, s25, s50
 buffer_load_dwordx4 v4, s[20:23], s25 offen nt lds
 buffer_load_dwordx4 v5, s[20:23], s25 offen offset:1024 nt lds
 s_add_u32 m0, s30, 40960
 s_add_u32 s25, s25, s26
 buffer_load_dwordx4 v4, s[20:23], s43 offen nt lds
 buffer_load_dwordx4 v5, s[20:23], s43 offen offset:1024 nt lds
 ds_read_b64_tr_b16 a[24:25], v7 offset:49152
 ds_read_b64_tr_b16 a[26:27], v7 offset:51200
 ds_read_b64_tr_b16 a[28:29], v7 offset:49160
 ds_read_b64_tr_b16 a[30:31], v7 offset:51208
 v_mfma_f32_16x16x32_bf16 v[64:67], a[16:19], v[112:115], v[64:67]
 v_mfma_f32_16x16x32_bf16 v[68:71], a[20:23], v[112:115], v[68:71]
 v_mfma_f32_16x16x32_bf16 v[72:75], a[16:19], v[116:119], v[72:75]
 v_mfma_f32_16x16x32_bf16 v[76:79], a[20:23], v[116:119], v[76:79]
 v_mfma_f32_16x16x32_bf16 v[80:83], a[16:19], v[48:51], v[80:83]
 v_mfma_f32_16x16x32_bf16 v[84:87], a[20:23], v[48:51], v[84:87]
 v_mfma_f32_16x16x32_bf16 v[88:91], a[16:19], v[52:55], v[88:91]
 v_mfma_f32_16x16x32_bf16 v[92:95], a[20:23], v[52:55], v[92:95]
 s_waitcnt vmcnt(24) lgkmcnt(0)
 s_barrier
 s_add_u32 m0, s30, 49152
 s_add_u32 s43, s25, s50
 buffer_load_dwordx4 v4, s[20:23], s25 offen nt lds
 buffer_load_dwordx4 v5, s[20:23], s25 offen offset:1024 nt lds
 s_add_u32 m0, s30, 57344
 s_cmp_lt_i32 s46, 0
 s_cselect_b32 s48, s49, s26
 s_add_u32 s25, s25, s48
 buffer_load_dwordx4 v4, s[20:23], s43 offen nt lds
 buffer_load_dwordx4 v5, s[20:23], s43 offen offset:1024 nt lds
 ds_read_b64_tr_b16 a[32:33], v8 offset:0
 ds_read_b64_tr_b16 a[34:35], v8 offset:2048
 ds_read_b64_tr_b16 a[36:37], v8 offset:8
 ds_read_b64_tr_b16 a[38:39], v8 offset:2056
 v_mfma_f32_16x16x32_bf16 v[64:67], a[24:27], v[120:123], v[64:67]
 v_mfma_f32_16x16x32_bf16 v[68:71], a[28:31], v[120:123], v[68:71]
 v_mfma_f32_16x16x32_bf16 v[72:75], a[24:27], v[124:127], v[72:75]
 v_mfma_f32_16x16x32_bf16 v[76:79], a[28:31], v[124:127], v[76:79]
 v_mfma_f32_16x16x32_bf16 v[80:83], a[24:27], v[56:59], v[80:83]
 v_mfma_f32_16x16x32_bf16 v[84:87], a[28:31], v[56:59], v[84:87]
 v_mfma_f32_16x16x32_bf16 v[88:91], a[24:27], v[60:63], v[88:91]
 v_mfma_f32_16x16x32_bf16 v[92:95], a[28:31], v[60:63], v[92:95]
 ds_read_b128 v[96:99], v24 offset:0
 ds_read_b128 v[100:103], v24 offset:8192
 ds_read_b128 v[104:107], v25 offset:0
 ds_read_b128 v[108:111], v25 offset:8192
 ds_read_b128 v[112:115], v26 offset:0
 ds_read_b128 v[116:119], v26 offset:8192
 ds_read_b128 v[120:123], v27 offset:0
 ds_read_b128 v[124:127], v27 offset:8192
 ds_read_b128 v[32:35], v24 offset:16384
 ds_read_b128 v[36:39], v24 offset:24576
 ds_read_b128 v[40:43], v25 offset:16384
 ds_read_b128 v[44:47], v25 offset:24576
 ds_read_b128 v[48:51], v26 offset:16384
 ds_read_b128 v[52:55], v26 offset:24576
 ds_read_b128 v[56:59], v27 offset:16384
 ds_read_b128 v[60:63], v27 offset:24576
 s_waitcnt vmcnt(24) lgkmcnt(0)
 s_barrier
 s_add_u32 m0, s30, 65536
 s_add_u32 s43, s25, s50
 buffer_load_dwordx4 v4, s[20:23], s25 offen nt lds
 buffer_load_dwordx4 v5, s[20:23], s25 offen offset:1024 nt lds
 s_add_u32 m0, s30, 73728
 s_add_u32 s25, s25, s26
 buffer_load_dwordx4 v4, s[20:23], s43 offen nt lds
 buffer_load_dwordx4 v5, s[20:23], s43 offen offset:1024 nt lds
 ds_read_b64_tr_b16 a[40:41], v8 offset:16384
 ds_read_b64_tr_b16 a[42:43], v8 offset:18432
 ds_read_b64_tr_b16 a[44:45], v8 offset:16392
 ds_read_b64_tr_b16 a[46:47], v8 offset:18440
 v_mfma_f32_16x16x32_bf16 v[64:67], a[32:35], v[96:99], v[64:67]
 v_mfma_f32_16x16x32_bf16 v[68:71], a[36:39], v[96:99], v[68:71]
 v_mfma_f32_16x16x32_bf16 v[72:75], a[32:35], v[100:103], v[72:75]
 v_mfma_f32_16x16x32_bf16 v[76:79], a[36:39], v[100:103], v[76:79]
 v_mfma_f32_16x16x32_bf16 v[80:83], a[32:35], v[32:35], v[80:83]
 v_mfma_f32_16x16x32_bf16 v[84:87], a[36:39], v[32:35], v[84:87]
 v_mfma_f32_16x16x32_bf16 v[88:91], a[32:35], v[36:39], v[88:91]
 v_mfma_f32_16x16x32_bf16 v[92:95], a[36:39], v[36:39], v[92:95]
 s_waitcnt vmcnt(24) lgkmcnt(0)
 s_barrier
 s_add_u32 m0, s30, 81920
 s_add_u32 s43, s25, s50
 buffer_load_dwordx4 v4, s[20:23], s25 offen nt lds
 buffer_load_dwordx4 v5, s[20:23], s25 offen offset:1024 nt lds
 s_add_u32 m0, s30, 90112
 s_add_u32 s25, s25, s26
 buffer_load_dwordx4 v4, s[20:23], s43 offen nt lds
 buffer_load_dwordx4 v5, s[20:23], s43 offen offset:1024 nt lds
 ds_read_b64_tr_b16 a[48:49], v8 offset:32768
 ds_read_b64_tr_b16 a[50:51], v8 offset:34816
 ds_read_b64_tr_b16 a[52:53], v8 offset:32776
 ds_read_b64_tr_b16 a[54:55], v8 offset:34824
 v_mfma_f32_16x16x32_bf16 v[64:67], a[40:43], v[104:107], v[64:67]
 v_mfma_f32_16x16x32_bf16 v[68:71], a[44:47], v[104:107], v[68:71]
 v_mfma_f32_16x16x32_bf16 v[72:75], a[40:43], v[108:111], v[72:75]
 v_mfma_f32_16x16x32_bf16 v[76:79], a[44:47], v[108:111], v[76:79]
 v_mfma_f32_16x16x32_bf16 v[80:83], a[40:43], v[40:43], v[80:83]
 v_mfma_f32_16x16x32_bf16 v[84:87], a[44:47], v[40:43], v[84:87]
 v_mfma_f32_16x16x32_bf16 v[88:91], a[40:43], v[44:47], v[88:91]
 v_mfma_f32_16x16x32_bf16 v[92:95], a[44:47], v[44:47], v[92:95]
 s_waitcnt vmcnt(24) lgkmcnt(0)
 s_barrier
 s_add_u32 m0, s30, 98304
 s_add_u32 s43, s25, s50
 buffer_load_dwordx4 v4, s[20:23], s25 offen nt lds
 buffer_load_dwordx4 v5, s[20:23], s25 offen offset:1024 nt lds
 s_add_u32 m0, s30, 106496
 s_add_u32 s25, s25, s26
 buffer_load_dwordx4 v4, s[20:23], s43 offen nt lds
 buffer_load_dwordx4 v5, s[20:23], s43 offen offset:1024 nt lds
 ds_read_b64_tr_b16 a[56:57], v8 offset:49152
 ds_read_b64_tr_b16 a[58:59], v8 offset:51200
 ds_read_b64_tr_b16 a[60:61], v8 offset:49160
 ds_read_b64_tr_b16 a[62:63], v8 offset:51208
 v_mfma_f32_16x16x32_bf16 v[64:67], a[48:51], v[112:115], v[64:67]
 v_mfma_f32_16x16x32_bf16 v[68:71], a[52:55], v[112:115], v[68:71]
 v_mfma_f32_16x16x32_bf16 v[72:75], a[48:51], v[116:119], v[72:75]
 v_mfma_f32_16x16x32_bf16 v[76:79], a[52:55], v[116:119], v[76:79]
 v_mfma_f32_16x16x32_bf16 v[80:83], a[48:51], v[48:51], v[80:83]
 v_mfma_f32_16x16x32_bf16 v[84:87], a[52:55], v[48:51], v[84:87]
 v_mfma_f32_16x16x32_bf16 v[88:91], a[48:51], v[52:55], v[88:91]
 v_mfma_f32_16x16x32_bf16 v[92:95], a[52:55], v[52:55], v[92:95]
 s_waitcnt vmcnt(24) lgkmcnt(0)
 s_barrier
 s_add_u32 m0, s30, 114688
 s_add_u32 s43, s25, s50
 buffer_load_dwordx4 v4, s[20:23], s25 offen nt lds
 buffer_load_dwordx4 v5, s[20:23], s25 offen offset:1024 nt lds
 s_add_u32 m0, s30, 122880
 s_cmp_lt_i32 s47, 0
 s_cselect_b32 s48, s49, s26
 s_add_u32 s25, s25, s48
 buffer_load_dwordx4 v4, s[20:23], s43 offen nt lds
 buffer_load_dwordx4 v5, s[20:23], s43 offen offset:1024 nt lds
 ds_read_b64_tr_b16 a[64:65], v7 offset:0
 ds_read_b64_tr_b16 a[66:67], v7 offset:2048
 ds_read_b64_tr_b16 a[68:69], v7 offset:8
 ds_read_b64_tr_b16 a[70:71], v7 offset:2056
 v_mfma_f32_16x16x32_bf16 v[64:67], a[56:59], v[120:123], v[64:67]
 v_mfma_f32_16x16x32_bf16 v[68:71], a[60:63], v[120:123], v[68:71]
 v_mfma_f32_16x16x32_bf16 v[72:75], a[56:59], v[124:127], v[72:75]
 v_mfma_f32_16x16x32_bf16 v[76:79], a[60:63], v[124:127], v[76:79]
 v_mfma_f32_16x16x32_bf16 v[80:83], a[56:59], v[56:59], v[80:83]
 v_mfma_f32_16x16x32_bf16 v[84:87], a[60:63], v[56:59], v[84:87]
 v_mfma_f32_16x16x32_bf16 v[88:91], a[56:59], v[60:63], v[88:91]
 v_mfma_f32_16x16x32_bf16 v[92:95], a[60:63], v[60:63], v[92:95]
 ds_read_b128 v[96:99], v24 offset:0
 ds_read_b128 v[100:103], v24 offset:8192
 ds_read_b128 v[104:107], v25 offset:0
 ds_read_b128 v[108:111], v25 offset:8192
 ds_read_b128 v[112:115], v26 offset:0
 ds_read_b128 v[116:119], v26 offset:8192
 ds_read_b128 v[120:123], v27 offset:0
 ds_read_b128 v[124:127], v27 offset:8192
 ds_read_b128 v[32:35], v24 offset:16384
 ds_read_b128 v[36:39], v24 offset:24576
 ds_read_b128 v[40:43], v25 offset:16384
 ds_read_b128 v[44:47], v25 offset:24576
 ds_read_b128 v[48:51], v26 offset:16384
 ds_read_b128 v[52:55], v26 offset:24576
 ds_read_b128 v[56:59], v27 offset:16384
 ds_read_b128 v[60:63], v27 offset:24576
 s_waitcnt vmcnt(24) lgkmcnt(0)
 s_barrier
 ds_read_b64_tr_b16 a[72:73], v7 offset:16384
 ds_read_b64_tr_b16 a[74:75], v7 offset:18432
 ds_read_b64_tr_b16 a[76:77], v7 offset:16392
 ds_read_b64_tr_b16 a[78:79], v7 offset:18440
 v_mfma_f32_16x16x32_bf16 v[64:67], a[64:67], v[96:99], v[64:67]
 v_mfma_f32_16x16x32_bf16 v[68:71], a[68:71], v[96:99], v[68:71]
 v_mfma_f32_16x16x32_bf16 v[72:75], a[64:67], v[100:103], v[72:75]
 v_mfma_f32_16x16x32_bf16 v[76:79], a[68:71], v[100:103], v[76:79]
 v_mfma_f32_16x16x32_bf16 v[80:83], a[64:67], v[32:35], v[80:83]
 v_mfma_f32_16x16x32_bf16 v[84:87], a[68:71], v[32:35], v[84:87]
 v_mfma_f32_16x16x32_bf16 v[88:91], a[64:67], v[36:39], v[88:91]
 v_mfma_f32_16x16x32_bf16 v[92:95], a[68:71], v[36:39], v[92:95]
 s_waitcnt vmcnt(20) lgkmcnt(0)
 s_barrier
 s_add_u32 m0, s30, 0
 s_nop 0
 buffer_load_dwordx4 v6, s[8:11], s24 offen lds
 buffer_load_dwordx4 v6, s[8:11], s24 offen offset:1024 lds
 s_add_u32 s24, s24, s44
 ds_read_b64_tr_b16 a[80:81], v7 offset:32768
 ds_read_b64_tr_b16 a[82:83], v7 offset:34816
 ds_read_b64_tr_b16 a[84:85], v7 offset:32776
 ds_read_b64_tr_b16 a[86:87], v7 offset:34824
 v_mfma_f32_16x16x32_bf16 v[64:67], a[72:75], v[104:107], v[64:67]
 v_mfma_f32_16x16x32_bf16 v[68:71], a[76:79], v[104:107], v[68:71]
 v_mfma_f32_16x16x32_bf16 v[72:75], a[72:75], v[108:111], v[72:75]
 v_mfma_f32_16x16x32_bf16 v[76:79], a[76:79], v[108:111], v[76:79]
 v_mfma_f32_16x16x32_bf16 v[80:83], a[72:75], v[40:43], v[80:83]
 v_mfma_f32_16x16x32_bf16 v[84:87], a[76:79], v[40:43], v[84:87]
 v_mfma_f32_16x16x32_bf16 v[88:91], a[72:75], v[44:47], v[88:91]
 v_mfma_f32_16x16x32_bf16 v[92:95], a[76:79], v[44:47], v[92:95]
 s_waitcnt vmcnt(18) lgkmcnt(0)
 s_barrier
 s_add_u32 m0, s30, 16384
 s_nop 0
 buffer_load_dwordx4 v6, s[8:11], s24 offen lds
 buffer_load_dwordx4 v6, s[8:11], s24 offen offset:1024 lds
 s_add_u32 s24, s24, s45
 ds_read_b64_tr_b16 a[88:89], v7 offset:49152
 ds_read_b64_tr_b16 a[90:91], v7 offset:51200
 ds_read_b64_tr_b16 a[92:93], v7 offset:49160
 ds_read_b64_tr_b16 a[94:95], v7 offset:51208
 v_mfma_f32_16x16x32_bf16 v[64:67], a[80:83], v[112:115], v[64:67]
 v_mfma_f32_16x16x32_bf16 v[68:71], a[84:87], v[112:115], v[68:71]
 v_mfma_f32_16x16x32_bf16 v[72:75], a[80:83], v[116:119], v[72:75]
 v_mfma_f32_16x16x32_bf16 v[76:79], a[84:87], v[116:119], v[76:79]
 v_mfma_f32_16x16x32_bf16 v[80:83], a[80:83], v[48:51], v[80:83]
 v_mfma_f32_16x16x32_bf16 v[84:87], a[84:87], v[48:51], v[84:87]
 v_mfma_f32_16x16x32_bf16 v[88:91], a[80:83], v[52:55], v[88:91]
 v_mfma_f32_16x16x32_bf16 v[92:95], a[84:87], v[52:55], v[92:95]
 s_waitcnt vmcnt(16) lgkmcnt(0)
 s_barrier
 s_add_u32 m0, s30, 32768
 s_nop 0
 buffer_load_dwordx4 v6, s[8:11], s24 offen lds
 buffer_load_dwordx4 v6, s[8:11], s24 offen offset:1024 lds
 s_add_u32 s24, s24, s46
 ds_read_b64_tr_b16 a[96:97], v8 offset:0
 ds_read_b64_tr_b16 a[98:99], v8 offset:2048
 ds_read_b64_tr_b16 a[100:101], v8 offset:8
 ds_read_b64_tr_b16 a[102:103], v8 offset:2056
 v_mfma_f32_16x16x32_bf16 v[64:67], a[88:91], v[120:123], v[64:67]
 v_mfma_f32_16x16x32_bf16 v[68:71], a[92:95], v[120:123], v[68:71]
 v_mfma_f32_16x16x32_bf16 v[72:75], a[88:91], v[124:127], v[72:75]
 v_mfma_f32_16x16x32_bf16 v[76:79], a[92:95], v[124:127], v[76:79]
 v_mfma_f32_16x16x32_bf16 v[80:83], a[88:91], v[56:59], v[80:83]
 v_mfma_f32_16x16x32_bf16 v[84:87], a[92:95], v[56:59], v[84:87]
 v_mfma_f32_16x16x32_bf16 v[88:91], a[88:91], v[60:63], v[88:91]
 v_mfma_f32_16x16x32_bf16 v[92:95], a[92:95], v[60:63], v[92:95]
 ds_read_b128 v[96:99], v24 offset:0
 ds_read_b128 v[100:103], v24 offset:8192
 ds_read_b128 v[104:107], v25 offset:0
 ds_read_b128 v[108:111], v25 offset:8192
 ds_read_b128 v[112:115], v26 offset:0
 ds_read_b128 v[116:119], v26 offset:8192
 ds_read_b128 v[120:123], v27 offset:0
 ds_read_b128 v[124:127], v27 offset:8192
 ds_read_b128 v[32:35], v24 offset:16384
 ds_read_b128 v[36:39], v24 offset:24576
 ds_read_b128 v[40:43], v25 offset:16384
 ds_read_b128 v[44:47], v25 offset:24576
 ds_read_b128 v[48:51], v26 offset:16384
 ds_read_b128 v[52:55], v26 offset:24576
 ds_read_b128 v[56:59], v27 offset:16384
 ds_read_b128 v[60:63], v27 offset:24576
 s_waitcnt vmcnt(14) lgkmcnt(0)
 s_barrier
 s_add_u32 m0, s30, 49152
 s_nop 0
 buffer_load_dwordx4 v6, s[8:11], s24 offen lds
 buffer_load_dwordx4 v6, s[8:11], s24 offen offset:1024 lds
 s_add_u32 s24, s24, s47
 ds_read_b64_tr_b16 a[104:105], v8 offset:16384
 ds_read_b64_tr_b16 a[106:107], v8 offset:18432
 ds_read_b64_tr_b16 a[108:109], v8 offset:16392
 ds_read_b64_tr_b16 a[110:111], v8 offset:18440
 v_mfma_f32_16x16x32_bf16 v[64:67], a[96:99], v[96:99], v[64:67]
 v_mfma_f32_16x16x32_bf16 v[68:71], a[100:103], v[96:99], v[68:71]
 v_mfma_f32_16x16x32_bf16 v[72:75], a[96:99], v[100:103], v[72:75]
 v_mfma_f32_16x16x32_bf16 v[76:79], a[100:103], v[100:103], v[76:79]
 v_mfma_f32_16x16x32_bf16 v[80:83], a[96:99], v[32:35], v[80:83]
 v_mfma_f32_16x16x32_bf16 v[84:87], a[100:103], v[32:35], v[84:87]
 v_mfma_f32_16x16x32_bf16 v[88:91], a[96:99], v[36:39], v[88:91]
 v_mfma_f32_16x16x32_bf16 v[92:95], a[100:103], v[36:39], v[92:95]
 s_waitcnt vmcnt(12) lgkmcnt(0)
 s_barrier
 s_add_u32 m0, s30, 65536
 s_nop 0
 buffer_load_dwordx4 v6, s[8:11], s24 offen lds
 buffer_load_dwordx4 v6, s[8:11], s24 offen offset:1024 lds
 s_add_u32 s24, s24, s44
 ds_read_b64_tr_b16 a[112:113], v8 offset:32768
 ds_read_b64_tr_b16 a[114:115], v8 offset:34816
 ds_read_b64_tr_b16 a[116:117], v8 offset:32776
 ds_read_b64_tr_b16 a[118:119], v8 offset:34824
 v_mfma_f32_16x16x32_bf16 v[64:67], a[104:107], v[104:107], v[64:67]
 v_mfma_f32_16x16x32_bf16 v[68:71], a[108:111], v[104:107], v[68:71]
 v_mfma_f32_16x16x32_bf16 v[72:75], a[104:107], v[108:111], v[72:75]
 v_mfma_f32_16x16x32_bf16 v[76:79], a[108:111], v[108:111], v[76:79]
 v_mfma_f32_16x16x32_bf16 v[80:83], a[104:107], v[40:43], v[80:83]
 v_mfma_f32_16x16x32_bf16 v[84:87], a[108:111], v[40:43], v[84:87]
 v_mfma_f32_16x16x32_bf16 v[88:91], a[104:107], v[44:47], v[88:91]
 v_mfma_f32_16x16x32_bf16 v[92:95], a[108:111], v[44:47], v[92:95]
 s_waitcnt vmcnt(10) lgkmcnt(0)
 s_barrier
 s_add_u32 m0, s30, 81920
 s_nop 0
 buffer_load_dwordx4 v6, s[8:11], s24 offen lds
 buffer_load_dwordx4 v6, s[8:11], s24 offen offset:1024 lds
 s_add_u32 s24, s24, s45
 ds_read_b64_tr_b16 a[120:121], v8 offset:49152
 ds_read_b64_tr_b16 a[122:123], v8 offset:51200
 ds_read_b64_tr_b16 a[124:125], v8 offset:49160
 ds_read_b64_tr_b16 a[126:127], v8 offset:51208
 v_mfma_f32_16x16x32_bf16 v[64:67], a[112:115], v[112:115], v[64:67]
 v_mfma_f32_16x16x32_bf16 v[68:71], a[116:119], v[112:115], v[68:71]
 v_mfma_f32_16x16x32_bf16 v[72:75], a[112:115], v[116:119], v[72:75]
 v_mfma_f32_16x16x32_bf16 v[76:79], a[116:119], v[116:119], v[76:79]
 s_waitcnt lgkmcnt(0)
 v_mfma_f32_16x16x32_bf16 v[64:67], a[120:123], v[120:123], v[64:67]
 v_mfma_f32_16x16x32_bf16 v[68:71], a[124:127], v[120:123], v[68:71]
 v_mfma_f32_16x16x32_bf16 v[72:75], a[120:123], v[124:127], v[72:75]
 v_mfma_f32_16x16x32_bf16 v[76:79], a[124:127], v[124:127], v[76:79]
 s_nop 3
 ds_write_b128 v9, v[72:75] offset:0
 s_nop 2
 ds_write_b128 v9, v[76:79] offset:1024
 s_waitcnt lgkmcnt(0)
 s_barrier
 ds_read_b128 v[96:99], v10 offset:0
 ds_read_b128 v[100:103], v10 offset:1024
 s_waitcnt lgkmcnt(0)
 v_add_f32 v96, v96, v64
 v_add_f32 v97, v97, v65
 v_add_f32 v98, v98, v66
 v_add_f32 v99, v99, v67
 v_add_f32 v100, v100, v68
 v_add_f32 v101, v101, v69
 v_add_f32 v102, v102, v70
 v_add_f32 v103, v103, v71
 v_cvt_pk_bf16_f32 v104, v96, v97
 v_cvt_pk_bf16_f32 v105, v98, v99
 v_cvt_pk_bf16_f32 v106, v100, v101
 v_cvt_pk_bf16_f32 v107, v102, v103
 buffer_store_dwordx4 v[104:107], v15, s[4:7], s27 offen sc1
 s_add_u32 s27, s27, s28
L_wla:
 s_waitcnt vmcnt(4)
 s_barrier
 s_waitcnt lgkmcnt(3)
 v_mfma_f32_16x16x32_bf16 v[80:83], a[112:115], v[48:51], v[80:83]
 ds_read_b128 v[32:35], v16 offset:0
 v_mfma_f32_16x16x32_bf16 v[84:87], a[116:119], v[48:51], v[84:87]
 s_add_u32 m0, s30, 98304
 s_nop 0
 buffer_load_dwordx4 v6, s[8:11], s24 offen lds
 s_waitcnt lgkmcnt(3)
 v_mfma_f32_16x16x32_bf16 v[88:91], a[112:115], v[52:55], v[88:91]
 ds_read_b128 v[36:39], v16 offset:8192
 v_mfma_f32_16x16x32_bf16 v[92:95], a[116:119], v[52:55], v[92:95]
 s_waitcnt lgkmcnt(3)
 v_mfma_f32_16x16x32_bf16 v[80:83], a[120:123], v[56:59], v[80:83]
 ds_read_b128 v[40:43], v17 offset:0
 v_mfma_f32_16x16x32_bf16 v[84:87], a[124:127], v[56:59], v[84:87]
 buffer_load_dwordx4 v6, s[8:11], s24 offen offset:1024 lds
 s_add_u32 s24, s24, s46
 s_waitcnt lgkmcnt(3)
 v_mfma_f32_16x16x32_bf16 v[88:91], a[120:123], v[60:63], v[88:91]
 ds_read_b128 v[44:47], v17 offset:8192
 v_mfma_f32_16x16x32_bf16 v[92:95], a[124:127], v[60:63], v[92:95]
 s_waitcnt lgkmcnt(3)
 v_mfma_f32_16x16x32_bf16 v[64:67], a[0:3], v[32:35], 0
 ds_read_b128 v[48:51], v18 offset:0
 v_mfma_f32_16x16x32_bf16 v[68:71], a[4:7], v[32:35], 0
 s_waitcnt lgkmcnt(3)
 v_mfma_f32_16x16x32_bf16 v[72:75], a[0:3], v[36:39], 0
 ds_read_b128 v[52:55], v18 offset:8192
 v_mfma_f32_16x16x32_bf16 v[76:79], a[4:7], v[36:39], 0
 ds_write_b128 v9, v[88:91] offset:0
 s_waitcnt lgkmcnt(4)
 v_mfma_f32_16x16x32_bf16 v[64:67], a[8:11], v[40:43], v[64:67]
 ds_read_b128 v[56:59], v19 offset:0
 v_mfma_f32_16x16x32_bf16 v[68:71], a[12:15], v[40:43], v[68:71]
 ds_write_b128 v9, v[92:95] offset:1024
 s_waitcnt lgkmcnt(5)
 v_mfma_f32_16x16x32_bf16 v[72:75], a[8:11], v[44:47], v[72:75]
 ds_read_b128 v[60:63], v19 offset:8192
 v_mfma_f32_16x16x32_bf16 v[76:79], a[12:15], v[44:47], v[76:79]
 s_waitcnt lgkmcnt(1)
 s_waitcnt vmcnt(10)
 s_barrier
 s_waitcnt lgkmcnt(5)
 v_mfma_f32_16x16x32_bf16 v[64:67], a[16:19], v[48:51], v[64:67]
 ds_read_b128 v[32:35], v16 offset:16384
 v_mfma_f32_16x16x32_bf16 v[68:71], a[20:23], v[48:51], v[68:71]
 s_add_u32 m0, s30, 114688
 s_nop 0
 buffer_load_dwordx4 v6, s[8:11], s24 offen lds
 ds_read_b128 v[96:99], v10 offset:0
 ds_read_b128 v[100:103], v10 offset:1024
 s_waitcnt lgkmcnt(7)
 v_mfma_f32_16x16x32_bf16 v[72:75], a[16:19], v[52:55], v[72:75]
 ds_read_b128 v[36:39], v16 offset:24576
 v_mfma_f32_16x16x32_bf16 v[76:79], a[20:23], v[52:55], v[76:79]
 s_waitcnt lgkmcnt(6)
 v_mfma_f32_16x16x32_bf16 v[64:67], a[24:27], v[56:59], v[64:67]
 ds_read_b128 v[40:43], v17 offset:16384
 v_mfma_f32_16x16x32_bf16 v[68:71], a[28:31], v[56:59], v[68:71]
 buffer_load_dwordx4 v6, s[8:11], s24 offen offset:1024 lds
 s_add_u32 s24, s24, s47
 s_waitcnt lgkmcnt(5)
 v_mfma_f32_16x16x32_bf16 v[72:75], a[24:27], v[60:63], v[72:75]
 ds_read_b128 v[44:47], v17 offset:24576
 s_waitcnt lgkmcnt(3)
 v_add_f32 v96, v96, v80
 v_add_f32 v97, v97, v81
 v_mfma_f32_16x16x32_bf16 v[76:79], a[28:31], v[60:63], v[76:79]
 v_add_f32 v98, v98, v82
 v_add_f32 v99, v99, v83
 s_waitcnt lgkmcnt(5)
 v_mfma_f32_16x16x32_bf16 v[64:67], a[32:35], v[32:35], v[64:67]
 ds_read_b128 v[48:51], v18 offset:16384
 v_add_f32 v100, v100, v84
 v_add_f32 v101, v101, v85
 v_mfma_f32_16x16x32_bf16 v[68:71], a[36:39], v[32:35], v[68:71]
 v_add_f32 v102, v102, v86
 v_add_f32 v103, v103, v87
 s_waitcnt lgkmcnt(3)
 v_mfma_f32_16x16x32_bf16 v[72:75], a[32:35], v[36:39], v[72:75]
 ds_read_b128 v[52:55], v18 offset:24576
 v_cvt_pk_bf16_f32 v104, v96, v97
 v_cvt_pk_bf16_f32 v105, v98, v99
 v_mfma_f32_16x16x32_bf16 v[76:79], a[36:39], v[36:39], v[76:79]
 v_cvt_pk_bf16_f32 v106, v100, v101
 v_cvt_pk_bf16_f32 v107, v102, v103
 s_waitcnt lgkmcnt(3)
 v_mfma_f32_16x16x32_bf16 v[64:67], a[40:43], v[40:43], v[64:67]
 ds_read_b128 v[56:59], v19 offset:16384
 v_mfma_f32_16x16x32_bf16 v[68:71], a[44:47], v[40:43], v[68:71]
 buffer_store_dwordx4 v[104:107], v15, s[4:7], s27 offen sc1
 s_add_u32 s27, s27, s28
 s_waitcnt lgkmcnt(3)
 v_mfma_f32_16x16x32_bf16 v[72:75], a[40:43], v[44:47], v[72:75]
 ds_read_b128 v[60:63], v19 offset:24576
 v_mfma_f32_16x16x32_bf16 v[76:79], a[44:47], v[44:47], v[76:79]
 s_waitcnt vmcnt(10)
 s_barrier
 s_waitcnt lgkmcnt(3)
 v_mfma_f32_16x16x32_bf16 v[64:67], a[48:51], v[48:51], v[64:67]
 ds_read_b128 v[32:35], v16 offset:32768
 v_mfma_f32_16x16x32_bf16 v[68:71], a[52:55], v[48:51], v[68:71]
 s_add_u32 m0, s30, 0
 s_nop 0
 buffer_load_dwordx4 v6, s[8:11], s24 offen lds
 s_waitcnt lgkmcnt(3)
 v_mfma_f32_16x16x32_bf16 v[72:75], a[48:51], v[52:55], v[72:75]
 ds_read_b128 v[36:39], v16 offset:40960
 v_mfma_f32_16x16x32_bf16 v[76:79], a[52:55], v[52:55], v[76:79]
 s_waitcnt lgkmcnt(3)
 v_mfma_f32_16x16x32_bf16 v[64:67], a[56:59], v[56:59], v[64:67]
 ds_read_b128 v[40:43], v17 offset:32768
 v_mfma_f32_16x16x32_bf16 v[68:71], a[60:63], v[56:59], v[68:71]
 buffer_load_dwordx4 v6, s[8:11], s24 offen offset:1024 lds
 s_add_u32 s24, s24, s44
 s_waitcnt lgkmcnt(3)
 v_mfma_f32_16x16x32_bf16 v[72:75], a[56:59], v[60:63], v[72:75]
 ds_read_b128 v[44:47], v17 offset:40960
 v_mfma_f32_16x16x32_bf16 v[76:79], a[60:63], v[60:63], v[76:79]
 s_waitcnt lgkmcnt(3)
 v_mfma_f32_16x16x32_bf16 v[64:67], a[64:67], v[32:35], v[64:67]
 ds_read_b128 v[48:51], v18 offset:32768
 v_mfma_f32_16x16x32_bf16 v[68:71], a[68:71], v[32:35], v[68:71]
 s_waitcnt lgkmcnt(3)
 v_mfma_f32_16x16x32_bf16 v[72:75], a[64:67], v[36:39], v[72:75]
 ds_read_b128 v[52:55], v18 offset:40960
 v_mfma_f32_16x16x32_bf16 v[76:79], a[68:71], v[36:39], v[76:79]
 s_waitcnt lgkmcnt(3)
 v_mfma_f32_16x16x32_bf16 v[64:67], a[72:75], v[40:43], v[64:67]
 ds_read_b128 v[56:59], v19 offset:32768
 v_mfma_f32_16x16x32_bf16 v[68:71], a[76:79], v[40:43], v[68:71]
 s_waitcnt lgkmcnt(3)
 v_mfma_f32_16x16x32_bf16 v[72:75], a[72:75], v[44:47], v[72:75]
 ds_read_b128 v[60:63], v19 offset:40960
 v_mfma_f32_16x16x32_bf16 v[76:79], a[76:79], v[44:47], v[76:79]
 s_waitcnt vmcnt(10)
 s_barrier
 s_add_u32 s38, s38, 1
 s_waitcnt lgkmcnt(3)
 v_mfma_f32_16x16x32_bf16 v[64:67], a[80:83], v[48:51], v[64:67]
 ds_read_b128 v[32:35], v16 offset:49152
 v_mfma_f32_16x16x32_bf16 v[68:71], a[84:87], v[48:51], v[68:71]
 s_add_u32 m0, s30, 16384
 s_nop 0
 buffer_load_dwordx4 v6, s[8:11], s24 offen lds
 s_waitcnt lgkmcnt(3)
 v_mfma_f32_16x16x32_bf16 v[72:75], a[80:83], v[52:55], v[72:75]
 ds_read_b128 v[36:39], v16 offset:57344
 v_mfma_f32_16x16x32_bf16 v[76:79], a[84:87], v[52:55], v[76:79]
 s_waitcnt lgkmcnt(3)
 v_mfma_f32_16x16x32_bf16 v[64:67], a[88:91], v[56:59], v[64:67]
 ds_read_b128 v[40:43], v17 offset:49152
 v_mfma_f32_16x16x32_bf16 v[68:71], a[92:95], v[56:59], v[68:71]
 buffer_load_dwordx4 v6, s[8:11], s24 offen offset:1024 lds
 s_add_u32 s24, s24, s45
 s_waitcnt lgkmcnt(3)
 v_mfma_f32_16x16x32_bf16 v[72:75], a[88:91], v[60:63], v[72:75]
 ds_read_b128 v[44:47], v17 offset:57344
 v_mfma_f32_16x16x32_bf16 v[76:79], a[92:95], v[60:63], v[76:79]
 s_waitcnt lgkmcnt(3)
 v_mfma_f32_16x16x32_bf16 v[64:67], a[96:99], v[32:35], v[64:67]
 ds_read_b128 v[48:51], v18 offset:49152
 v_mfma_f32_16x16x32_bf16 v[68:71], a[100:103], v[32:35], v[68:71]
 s_waitcnt lgkmcnt(3)
 v_mfma_f32_16x16x32_bf16 v[72:75], a[96:99], v[36:39], v[72:75]
 ds_read_b128 v[52:55], v18 offset:57344
 v_mfma_f32_16x16x32_bf16 v[76:79], a[100:103], v[36:39], v[76:79]
 s_waitcnt lgkmcnt(3)
 v_mfma_f32_16x16x32_bf16 v[64:67], a[104:107], v[40:43], v[64:67]
 ds_read_b128 v[56:59], v19 offset:49152
 v_mfma_f32_16x16x32_bf16 v[68:71], a[108:111], v[40:43], v[68:71]
 s_waitcnt lgkmcnt(3)
 v_mfma_f32_16x16x32_bf16 v[72:75], a[104:107], v[44:47], v[72:75]
 ds_read_b128 v[60:63], v19 offset:57344
 v_mfma_f32_16x16x32_bf16 v[76:79], a[108:111], v[44:47], v[76:79]
 s_waitcnt vmcnt(4)
 s_barrier
 s_waitcnt lgkmcnt(3)
 v_mfma_f32_16x16x32_bf16 v[64:67], a[112:115], v[48:51], v[64:67]
 ds_read_b128 v[32:35], v20 offset:0
 v_mfma_f32_16x16x32_bf16 v[68:71], a[116:119], v[48:51], v[68:71]
 s_add_u32 m0, s30, 32768
 s_nop 0
 buffer_load_dwordx4 v6, s[8:11], s24 offen lds
 s_waitcnt lgkmcnt(3)
 v_mfma_f32_16x16x32_bf16 v[72:75], a[112:115], v[52:55], v[72:75]
 ds_read_b128 v[36:39], v20 offset:8192
 v_mfma_f32_16x16x32_bf16 v[76:79], a[116:119], v[52:55], v[76:79]
 s_waitcnt lgkmcnt(3)
 v_mfma_f32_16x16x32_bf16 v[64:67], a[120:123], v[56:59], v[64:67]
 ds_read_b128 v[40:43], v21 offset:0
 v_mfma_f32_16x16x32_bf16 v[68:71], a[124:127], v[56:59], v[68:71]
 buffer_load_dwordx4 v6, s[8:11], s24 offen offset:1024 lds
 s_add_u32 s24, s24, s46
 s_waitcnt lgkmcnt(3)
 v_mfma_f32_16x16x32_bf16 v[72:75], a[120:123], v[60:63], v[72:75]
 ds_read_b128 v[44:47], v21 offset:8192
 v_mfma_f32_16x16x32_bf16 v[76:79], a[124:127], v[60:63], v[76:79]
 s_waitcnt lgkmcnt(3)
 v_mfma_f32_16x16x32_bf16 v[80:83], a[0:3], v[32:35], 0
 ds_read_b128 v[48:51], v22 offset:0
 v_mfma_f32_16x16x32_bf16 v[84:87], a[4:7], v[32:35], 0
 s_waitcnt lgkmcnt(3)
 v_mfma_f32_16x16x32_bf16 v[88:91], a[0:3], v[36:39], 0
 ds_read_b128 v[52:55], v22 offset:8192
 v_mfma_f32_16x16x32_bf16 v[92:95], a[4:7], v[36:39], 0
 ds_write_b128 v9, v[72:75] offset:0
 s_waitcnt lgkmcnt(4)
 v_mfma_f32_16x16x32_bf16 v[80:83], a[8:11], v[40:43], v[80:83]
 ds_read_b128 v[56:59], v23 offset:0
 v_mfma_f32_16x16x32_bf16 v[84:87], a[12:15], v[40:43], v[84:87]
 ds_write_b128 v9, v[76:79] offset:1024
 s_waitcnt lgkmcnt(5)
 v_mfma_f32_16x16x32_bf16 v[88:91], a[8:11], v[44:47], v[88:91]
 ds_read_b128 v[60:63], v23 offset:8192
 v_mfma_f32_16x16x32_bf16 v[92:95], a[12:15], v[44:47], v[92:95]
 s_waitcnt lgkmcnt(1)
 s_waitcnt vmcnt(10)
 s_barrier
 s_waitcnt lgkmcnt(5)
 v_mfma_f32_16x16x32_bf16 v[80:83], a[16:19], v[48:51], v[80:83]
 ds_read_b128 v[32:35], v20 offset:16384
 v_mfma_f32_16x16x32_bf16 v[84:87], a[20:23], v[48:51], v[84:87]
 s_add_u32 m0, s30, 49152
 s_nop 0
 buffer_load_dwordx4 v6, s[8:11], s24 offen lds
 ds_read_b128 v[96:99], v10 offset:0
 ds_read_b128 v[100:103], v10 offset:1024
 s_waitcnt lgkmcnt(7)
 v_mfma_f32_16x16x32_bf16 v[88:91], a[16:19], v[52:55], v[88:91]
 ds_read_b128 v[36:39], v20 offset:24576
 v_mfma_f32_16x16x32_bf16 v[92:95], a[20:23], v[52:55], v[92:95]
 s_waitcnt lgkmcnt(6)
 v_mfma_f32_16x16x32_bf16 v[80:83], a[24:27], v[56:59], v[80:83]
 ds_read_b128 v[40:43], v21 offset:16384
 v_mfma_f32_16x16x32_bf16 v[84:87], a[28:31], v[56:59], v[84:87]
 buffer_load_dwordx4 v6, s[8:11], s24 offen offset:1024 lds
 s_add_u32 s24, s24, s47
 s_waitcnt lgkmcnt(5)
 v_mfma_f32_16x16x32_bf16 v[88:91], a[24:27], v[60:63], v[88:91]
 ds_read_b128 v[44:47], v21 offset:24576
 s_waitcnt lgkmcnt(3)
 v_add_f32 v96, v96, v64
 v_add_f32 v97, v97, v65
 v_mfma_f32_16x16x32_bf16 v[92:95], a[28:31], v[60:63], v[92:95]
 v_add_f32 v98, v98, v66
 v_add_f32 v99, v99, v67
 s_waitcnt lgkmcnt(5)
 v_mfma_f32_16x16x32_bf16 v[80:83], a[32:35], v[32:35], v[80:83]
 ds_read_b128 v[48:51], v22 offset:16384
 v_add_f32 v100, v100, v68
 v_add_f32 v101, v101, v69
 v_mfma_f32_16x16x32_bf16 v[84:87], a[36:39], v[32:35], v[84:87]
 v_add_f32 v102, v102, v70
 v_add_f32 v103, v103, v71
 s_waitcnt lgkmcnt(3)
 v_mfma_f32_16x16x32_bf16 v[88:91], a[32:35], v[36:39], v[88:91]
 ds_read_b128 v[52:55], v22 offset:24576
 v_cvt_pk_bf16_f32 v104, v96, v97
 v_cvt_pk_bf16_f32 v105, v98, v99
 v_mfma_f32_16x16x32_bf16 v[92:95], a[36:39], v[36:39], v[92:95]
 v_cvt_pk_bf16_f32 v106, v100, v101
 v_cvt_pk_bf16_f32 v107, v102, v103
 s_waitcnt lgkmcnt(3)
 v_mfma_f32_16x16x32_bf16 v[80:83], a[40:43], v[40:43], v[80:83]
 ds_read_b128 v[56:59], v23 offset:16384
 v_mfma_f32_16x16x32_bf16 v[84:87], a[44:47], v[40:43], v[84:87]
 buffer_store_dwordx4 v[104:107], v15, s[4:7], s27 offen sc1
 s_add_u32 s27, s27, s28
 s_waitcnt lgkmcnt(3)
 v_mfma_f32_16x16x32_bf16 v[88:91], a[40:43], v[44:47], v[88:91]
 ds_read_b128 v[60:63], v23 offset:24576
 v_mfma_f32_16x16x32_bf16 v[92:95], a[44:47], v[44:47], v[92:95]
 s_waitcnt vmcnt(10)
 s_barrier
 s_waitcnt lgkmcnt(3)
 v_mfma_f32_16x16x32_bf16 v[80:83], a[48:51], v[48:51], v[80:83]
 ds_read_b128 v[32:35], v20 offset:32768
 v_mfma_f32_16x16x32_bf16 v[84:87], a[52:55], v[48:51], v[84:87]
 s_add_u32 m0, s30, 65536
 s_nop 0
 buffer_load_dwordx4 v6, s[8:11], s24 offen lds
 s_waitcnt lgkmcnt(3)
 v_mfma_f32_16x16x32_bf16 v[88:91], a[48:51], v[52:55], v[88:91]
 ds_read_b128 v[36:39], v20 offset:40960
 v_mfma_f32_16x16x32_bf16 v[92:95], a[52:55], v[52:55], v[92:95]
 s_waitcnt lgkmcnt(3)
 v_mfma_f32_16x16x32_bf16 v[80:83], a[56:59], v[56:59], v[80:83]
 ds_read_b128 v[40:43], v21 offset:32768
 v_mfma_f32_16x16x32_bf16 v[84:87], a[60:63], v[56:59], v[84:87]
 buffer_load_dwordx4 v6, s[8:11], s24 offen offset:1024 lds
 s_add_u32 s24, s24, s44
 s_waitcnt lgkmcnt(3)
 v_mfma_f32_16x16x32_bf16 v[88:91], a[56:59], v[60:63], v[88:91]
 ds_read_b128 v[44:47], v21 offset:40960
 v_mfma_f32_16x16x32_bf16 v[92:95], a[60:63], v[60:63], v[92:95]
 s_waitcnt lgkmcnt(3)
 v_mfma_f32_16x16x32_bf16 v[80:83], a[64:67], v[32:35], v[80:83]
 ds_read_b128 v[48:51], v22 offset:32768
 v_mfma_f32_16x16x32_bf16 v[84:87], a[68:71], v[32:35], v[84:87]
 s_waitcnt lgkmcnt(3)
 v_mfma_f32_16x16x32_bf16 v[88:91], a[64:67], v[36:39], v[88:91]
 ds_read_b128 v[52:55], v22 offset:40960
 v_mfma_f32_16x16x32_bf16 v[92:95], a[68:71], v[36:39], v[92:95]
 s_waitcnt lgkmcnt(3)
 v_mfma_f32_16x16x32_bf16 v[80:83], a[72:75], v[40:43], v[80:83]
 ds_read_b128 v[56:59], v23 offset:32768
 v_mfma_f32_16x16x32_bf16 v[84:87], a[76:79], v[40:43], v[84:87]
 s_waitcnt lgkmcnt(3)
 v_mfma_f32_16x16x32_bf16 v[88:91], a[72:75], v[44:47], v[88:91]
 ds_read_b128 v[60:63], v23 offset:40960
 v_mfma_f32_16x16x32_bf16 v[92:95], a[76:79], v[44:47], v[92:95]
 s_waitcnt vmcnt(10)
 s_barrier
 s_add_u32 s38, s38, 1
 s_waitcnt lgkmcnt(3)
 v_mfma_f32_16x16x32_bf16 v[80:83], a[80:83], v[48:51], v[80:83]
 ds_read_b128 v[32:35], v20 offset:49152
 v_mfma_f32_16x16x32_bf16 v[84:87], a[84:87], v[48:51], v[84:87]
 s_add_u32 m0, s30, 81920
 s_nop 0
 buffer_load_dwordx4 v6, s[8:11], s24 offen lds
 s_waitcnt lgkmcnt(3)
 v_mfma_f32_16x16x32_bf16 v[88:91], a[80:83], v[52:55], v[88:91]
 ds_read_b128 v[36:39], v20 offset:57344
 v_mfma_f32_16x16x32_bf16 v[92:95], a[84:87], v[52:55], v[92:95]
 s_waitcnt lgkmcnt(3)
 v_mfma_f32_16x16x32_bf16 v[80:83], a[88:91], v[56:59], v[80:83]
 ds_read_b128 v[40:43], v21 offset:49152
 v_mfma_f32_16x16x32_bf16 v[84:87], a[92:95], v[56:59], v[84:87]
 buffer_load_dwordx4 v6, s[8:11], s24 offen offset:1024 lds
 s_add_u32 s24, s24, s45
 s_waitcnt lgkmcnt(3)
 v_mfma_f32_16x16x32_bf16 v[88:91], a[88:91], v[60:63], v[88:91]
 ds_read_b128 v[44:47], v21 offset:57344
 v_mfma_f32_16x16x32_bf16 v[92:95], a[92:95], v[60:63], v[92:95]
 s_waitcnt lgkmcnt(3)
 v_mfma_f32_16x16x32_bf16 v[80:83], a[96:99], v[32:35], v[80:83]
 ds_read_b128 v[48:51], v22 offset:49152
 v_mfma_f32_16x16x32_bf16 v[84:87], a[100:103], v[32:35], v[84:87]
 s_waitcnt lgkmcnt(3)
 v_mfma_f32_16x16x32_bf16 v[88:91], a[96:99], v[36:39], v[88:91]
 ds_read_b128 v[52:55], v22 offset:57344
 v_mfma_f32_16x16x32_bf16 v[92:95], a[100:103], v[36:39], v[92:95]
 s_waitcnt lgkmcnt(3)
 v_mfma_f32_16x16x32_bf16 v[80:83], a[104:107], v[40:43], v[80:83]
 ds_read_b128 v[56:59], v23 offset:49152
 v_mfma_f32_16x16x32_bf16 v[84:87], a[108:111], v[40:43], v[84:87]
 s_waitcnt lgkmcnt(3)
 v_mfma_f32_16x16x32_bf16 v[88:91], a[104:107], v[44:47], v[88:91]
 ds_read_b128 v[60:63], v23 offset:57344
 v_mfma_f32_16x16x32_bf16 v[92:95], a[108:111], v[44:47], v[92:95]
 s_cmp_lt_u32 s38, 64
 s_cbranch_scc1 L_wla
 s_waitcnt lgkmcnt(0)
 v_mfma_f32_16x16x32_bf16 v[80:83], a[112:115], v[48:51], v[80:83]
 v_mfma_f32_16x16x32_bf16 v[84:87], a[116:119], v[48:51], v[84:87]
 s_waitcnt lgkmcnt(0)
 v_mfma_f32_16x16x32_bf16 v[88:91], a[112:115], v[52:55], v[88:91]
 v_mfma_f32_16x16x32_bf16 v[92:95], a[116:119], v[52:55], v[92:95]
 s_waitcnt lgkmcnt(0)
 v_mfma_f32_16x16x32_bf16 v[80:83], a[120:123], v[56:59], v[80:83]
 v_mfma_f32_16x16x32_bf16 v[84:87], a[124:127], v[56:59], v[84:87]
 s_waitcnt lgkmcnt(0)
 v_mfma_f32_16x16x32_bf16 v[88:91], a[120:123], v[60:63], v[88:91]
 v_mfma_f32_16x16x32_bf16 v[92:95], a[124:127], v[60:63], v[92:95]
 s_nop 3
 ds_write_b128 v9, v[88:91] offset:0
 s_nop 2
 ds_write_b128 v9, v[92:95] offset:1024
 s_waitcnt lgkmcnt(0)
 s_barrier
 ds_read_b128 v[96:99], v10 offset:0
 ds_read_b128 v[100:103], v10 offset:1024
 s_waitcnt lgkmcnt(0)
 v_add_f32 v96, v96, v80
 v_add_f32 v97, v97, v81
 v_add_f32 v98, v98, v82
 v_add_f32 v99, v99, v83
 v_add_f32 v100, v100, v84
 v_add_f32 v101, v101, v85
 v_add_f32 v102, v102, v86
 v_add_f32 v103, v103, v87
 v_cvt_pk_bf16_f32 v104, v96, v97
 v_cvt_pk_bf16_f32 v105, v98, v99
 v_cvt_pk_bf16_f32 v106, v100, v101
 v_cvt_pk_bf16_f32 v107, v102, v103
 buffer_store_dwordx4 v[104:107], v15, s[4:7], s27 offen sc1
 s_add_u32 s27, s27, s28
 s_branch L_wse
L_wsb:
 s_waitcnt vmcnt(0) lgkmcnt(0)
 s_barrier
 ds_read_b64_tr_b16 a[0:1], v7 offset:0
 ds_read_b64_tr_b16 a[2:3], v7 offset:2048
 ds_read_b64_tr_b16 a[4:5], v7 offset:8
 ds_read_b64_tr_b16 a[6:7], v7 offset:2056
 ds_read_b128 v[96:99], v24 offset:0
 ds_read_b128 v[100:103], v24 offset:8192
 ds_read_b128 v[104:107], v25 offset:0
 ds_read_b128 v[108:111], v25 offset:8192
 ds_read_b128 v[112:115], v26 offset:0
 ds_read_b128 v[116:119], v26 offset:8192
 ds_read_b128 v[120:123], v27 offset:0
 ds_read_b128 v[124:127], v27 offset:8192
 ds_read_b128 v[32:35], v24 offset:16384
 ds_read_b128 v[36:39], v24 offset:24576
 ds_read_b128 v[40:43], v25 offset:16384
 ds_read_b128 v[44:47], v25 offset:24576
 ds_read_b128 v[48:51], v26 offset:16384
 ds_read_b128 v[52:55], v26 offset:24576
 ds_read_b128 v[56:59], v27 offset:16384
 ds_read_b128 v[60:63], v27 offset:24576
 s_waitcnt vmcnt(0) lgkmcnt(0)
 s_barrier
 s_add_u32 m0, s31, -8192
 s_add_u32 s43, s42, 0
 buffer_load_dwordx4 v11, s[8:11], s43 offen lds
 buffer_load_dwordx4 v11, s[8:11], s43 offen offset:1024 lds
 s_add_u32 m0, s31, 0
 s_add_u32 s43, s42, 32768
 buffer_load_dwordx4 v11, s[8:11], s43 offen lds
 buffer_load_dwordx4 v11, s[8:11], s43 offen offset:1024 lds
 s_add_u32 m0, s31, 8192
 s_add_u32 s43, s42, 65536
 buffer_load_dwordx4 v11, s[8:11], s43 offen lds
 buffer_load_dwordx4 v11, s[8:11], s43 offen offset:1024 lds
 s_add_u32 m0, s31, 16384
 s_add_u32 s43, s42, 98304
 buffer_load_dwordx4 v11, s[8:11], s43 offen lds
 buffer_load_dwordx4 v11, s[8:11], s43 offen offset:1024 lds
 s_add_u32 s42, s42, s45
 ds_read_b64_tr_b16 a[8:9], v7 offset:16384
 ds_read_b64_tr_b16 a[10:11], v7 offset:18432
 ds_read_b64_tr_b16 a[12:13], v7 offset:16392
 ds_read_b64_tr_b16 a[14:15], v7 offset:18440
 v_mfma_f32_16x16x32_bf16 v[64:67], a[0:3], v[96:99], 0
 v_mfma_f32_16x16x32_bf16 v[68:71], a[4:7], v[96:99], 0
 v_mfma_f32_16x16x32_bf16 v[72:75], a[0:3], v[100:103], 0
 v_mfma_f32_16x16x32_bf16 v[76:79], a[4:7], v[100:103], 0
 v_mfma_f32_16x16x32_bf16 v[80:83], a[0:3], v[32:35], 0
 v_mfma_f32_16x16x32_bf16 v[84:87], a[4:7], v[32:35], 0
 v_mfma_f32_16x16x32_bf16 v[88:91], a[0:3], v[36:39], 0
 v_mfma_f32_16x16x32_bf16 v[92:95], a[4:7], v[36:39], 0
 s_waitcnt vmcnt(8) lgkmcnt(0)
 s_barrier
 ds_read_b64_tr_b16 a[16:17], v7 offset:32768
 ds_read_b64_tr_b16 a[18:19], v7 offset:34816
 ds_read_b64_tr_b16 a[20:21], v7 offset:32776
 ds_read_b64_tr_b16 a[22:23], v7 offset:34824
 v_mfma_f32_16x16x32_bf16 v[64:67], a[8:11], v[104:107], v[64:67]
 v_mfma_f32_16x16x32_bf16 v[68:71], a[12:15], v[104:107], v[68:71]
 v_mfma_f32_16x16x32_bf16 v[72:75], a[8:11], v[108:111], v[72:75]
 v_mfma_f32_16x16x32_bf16 v[76:79], a[12:15], v[108:111], v[76:79]
 v_mfma_f32_16x16x32_bf16 v[80:83], a[8:11], v[40:43], v[80:83]
 v_mfma_f32_16x16x32_bf16 v[84:87], a[12:15], v[40:43], v[84:87]
 v_mfma_f32_16x16x32_bf16 v[88:91], a[8:11], v[44:47], v[88:91]
 v_mfma_f32_16x16x32_bf16 v[92:95], a[12:15], v[44:47], v[92:95]
 s_waitcnt vmcnt(8) lgkmcnt(0)
 s_barrier
 ds_read_b64_tr_b16 a[24:25], v7 offset:49152
 ds_read_b64_tr_b16 a[26:27], v7 offset:51200
 ds_read_b64_tr_b16 a[28:29], v7 offset:49160
 ds_read_b64_tr_b16 a[30:31], v7 offset:51208
 v_mfma_f32_16x16x32_bf16 v[64:67], a[16:19], v[112:115], v[64:67]
 v_mfma_f32_16x16x32_bf16 v[68:71], a[20:23], v[112:115], v[68:71]
 v_mfma_f32_16x16x32_bf16 v[72:75], a[16:19], v[116:119], v[72:75]
 v_mfma_f32_16x16x32_bf16 v[76:79], a[20:23], v[116:119], v[76:79]
 v_mfma_f32_16x16x32_bf16 v[80:83], a[16:19], v[48:51], v[80:83]
 v_mfma_f32_16x16x32_bf16 v[84:87], a[20:23], v[48:51], v[84:87]
 v_mfma_f32_16x16x32_bf16 v[88:91], a[16:19], v[52:55], v[88:91]
 v_mfma_f32_16x16x32_bf16 v[92:95], a[20:23], v[52:55], v[92:95]
 s_waitcnt vmcnt(0) lgkmcnt(0)
 s_barrier
 ds_read_b64_tr_b16 a[32:33], v8 offset:0
 ds_read_b64_tr_b16 a[34:35], v8 offset:2048
 ds_read_b64_tr_b16 a[36:37], v8 offset:8
 ds_read_b64_tr_b16 a[38:39], v8 offset:2056
 v_mfma_f32_16x16x32_bf16 v[64:67], a[24:27], v[120:123], v[64:67]
 v_mfma_f32_16x16x32_bf16 v[68:71], a[28:31], v[120:123], v[68:71]
 v_mfma_f32_16x16x32_bf16 v[72:75], a[24:27], v[124:127], v[72:75]
 v_mfma_f32_16x16x32_bf16 v[76:79], a[28:31], v[124:127], v[76:79]
 v_mfma_f32_16x16x32_bf16 v[80:83], a[24:27], v[56:59], v[80:83]
 v_mfma_f32_16x16x32_bf16 v[84:87], a[28:31], v[56:59], v[84:87]
 v_mfma_f32_16x16x32_bf16 v[88:91], a[24:27], v[60:63], v[88:91]
 v_mfma_f32_16x16x32_bf16 v[92:95], a[28:31], v[60:63], v[92:95]
 ds_read_b128 v[96:99], v24 offset:0
 ds_read_b128 v[100:103], v24 offset:8192
 ds_read_b128 v[104:107], v25 offset:0
 ds_read_b128 v[108:111], v25 offset:8192
 ds_read_b128 v[112:115], v26 offset:0
 ds_read_b128 v[116:119], v26 offset:8192
 ds_read_b128 v[120:123], v27 offset:0
 ds_read_b128 v[124:127], v27 offset:8192
 ds_read_b128 v[32:35], v24 offset:16384
 ds_read_b128 v[36:39], v24 offset:24576
 ds_read_b128 v[40:43], v25 offset:16384
 ds_read_b128 v[44:47], v25 offset:24576
 ds_read_b128 v[48:51], v26 offset:16384
 ds_read_b128 v[52:55], v26 offset:24576
 ds_read_b128 v[56:59], v27 offset:16384
 ds_read_b128 v[60:63], v27 offset:24576
 s_waitcnt vmcnt(0) lgkmcnt(0)
 s_barrier
 s_add_u32 m0, s31, -8192
 s_add_u32 s43, s42, 0
 buffer_load_dwordx4 v11, s[8:11], s43 offen lds
 buffer_load_dwordx4 v11, s[8:11], s43 offen offset:1024 lds
 s_add_u32 m0, s31, 0
 s_add_u32 s43, s42, 32768
 buffer_load_dwordx4 v11, s[8:11], s43 offen lds
 buffer_load_dwordx4 v11, s[8:11], s43 offen offset:1024 lds
 s_add_u32 m0, s31, 8192
 s_add_u32 s43, s42, 65536
 buffer_load_dwordx4 v11, s[8:11], s43 offen lds
 buffer_load_dwordx4 v11, s[8:11], s43 offen offset:1024 lds
 s_add_u32 m0, s31, 16384
 s_add_u32 s43, s42, 98304
 buffer_load_dwordx4 v11, s[8:11], s43 offen lds
 buffer_load_dwordx4 v11, s[8:11], s43 offen offset:1024 lds
 s_add_u32 s42, s42, s46
 ds_read_b64_tr_b16 a[40:41], v8 offset:16384
 ds_read_b64_tr_b16 a[42:43], v8 offset:18432
 ds_read_b64_tr_b16 a[44:45], v8 offset:16392
 ds_read_b64_tr_b16 a[46:47], v8 offset:18440
 v_mfma_f32_16x16x32_bf16 v[64:67], a[32:35], v[96:99], v[64:67]
 v_mfma_f32_16x16x32_bf16 v[68:71], a[36:39], v[96:99], v[68:71]
 v_mfma_f32_16x16x32_bf16 v[72:75], a[32:35], v[100:103], v[72:75]
 v_mfma_f32_16x16x32_bf16 v[76:79], a[36:39], v[100:103], v[76:79]
 v_mfma_f32_16x16x32_bf16 v[80:83], a[32:35], v[32:35], v[80:83]
 v_mfma_f32_16x16x32_bf16 v[84:87], a[36:39], v[32:35], v[84:87]
 v_mfma_f32_16x16x32_bf16 v[88:91], a[32:35], v[36:39], v[88:91]
 v_mfma_f32_16x16x32_bf16 v[92:95], a[36:39], v[36:39], v[92:95]
 s_waitcnt vmcnt(8) lgkmcnt(0)
 s_barrier
 ds_read_b64_tr_b16 a[48:49], v8 offset:32768
 ds_read_b64_tr_b16 a[50:51], v8 offset:34816
 ds_read_b64_tr_b16 a[52:53], v8 offset:32776
 ds_read_b64_tr_b16 a[54:55], v8 offset:34824
 v_mfma_f32_16x16x32_bf16 v[64:67], a[40:43], v[104:107], v[64:67]
 v_mfma_f32_16x16x32_bf16 v[68:71], a[44:47], v[104:107], v[68:71]
 v_mfma_f32_16x16x32_bf16 v[72:75], a[40:43], v[108:111], v[72:75]
 v_mfma_f32_16x16x32_bf16 v[76:79], a[44:47], v[108:111], v[76:79]
 v_mfma_f32_16x16x32_bf16 v[80:83], a[40:43], v[40:43], v[80:83]
 v_mfma_f32_16x16x32_bf16 v[84:87], a[44:47], v[40:43], v[84:87]
 v_mfma_f32_16x16x32_bf16 v[88:91], a[40:43], v[44:47], v[88:91]
 v_mfma_f32_16x16x32_bf16 v[92:95], a[44:47], v[44:47], v[92:95]
 s_waitcnt vmcnt(8) lgkmcnt(0)
 s_barrier
 ds_read_b64_tr_b16 a[56:57], v8 offset:49152
 ds_read_b64_tr_b16 a[58:59], v8 offset:51200
 ds_read_b64_tr_b16 a[60:61], v8 offset:49160
 ds_read_b64_tr_b16 a[62:63], v8 offset:51208
 v_mfma_f32_16x16x32_bf16 v[64:67], a[48:51], v[112:115], v[64:67]
 v_mfma_f32_16x16x32_bf16 v[68:71], a[52:55], v[112:115], v[68:71]
 v_mfma_f32_16x16x32_bf16 v[72:75], a[48:51], v[116:119], v[72:75]
 v_mfma_f32_16x16x32_bf16 v[76:79], a[52:55], v[116:119], v[76:79]
 v_mfma_f32_16x16x32_bf16 v[80:83], a[48:51], v[48:51], v[80:83]
 v_mfma_f32_16x16x32_bf16 v[84:87], a[52:55], v[48:51], v[84:87]
 v_mfma_f32_16x16x32_bf16 v[88:91], a[48:51], v[52:55], v[88:91]
 v_mfma_f32_16x16x32_bf16 v[92:95], a[52:55], v[52:55], v[92:95]
 s_waitcnt vmcnt(0) lgkmcnt(0)
 s_barrier
 ds_read_b64_tr_b16 a[64:65], v7 offset:0
 ds_read_b64_tr_b16 a[66:67], v7 offset:2048
 ds_read_b64_tr_b16 a[68:69], v7 offset:8
 ds_read_b64_tr_b16 a[70:71], v7 offset:2056
 v_mfma_f32_16x16x32_bf16 v[64:67], a[56:59], v[120:123], v[64:67]
 v_mfma_f32_16x16x32_bf16 v[68:71], a[60:63], v[120:123], v[68:71]
 v_mfma_f32_16x16x32_bf16 v[72:75], a[56:59], v[124:127], v[72:75]
 v_mfma_f32_16x16x32_bf16 v[76:79], a[60:63], v[124:127], v[76:79]
 v_mfma_f32_16x16x32_bf16 v[80:83], a[56:59], v[56:59], v[80:83]
 v_mfma_f32_16x16x32_bf16 v[84:87], a[60:63], v[56:59], v[84:87]
 v_mfma_f32_16x16x32_bf16 v[88:91], a[56:59], v[60:63], v[88:91]
 v_mfma_f32_16x16x32_bf16 v[92:95], a[60:63], v[60:63], v[92:95]
 ds_read_b128 v[96:99], v24 offset:0
 ds_read_b128 v[100:103], v24 offset:8192
 ds_read_b128 v[104:107], v25 offset:0
 ds_read_b128 v[108:111], v25 offset:8192
 ds_read_b128 v[112:115], v26 offset:0
 ds_read_b128 v[116:119], v26 offset:8192
 ds_read_b128 v[120:123], v27 offset:0
 ds_read_b128 v[124:127], v27 offset:8192
 ds_read_b128 v[32:35], v24 offset:16384
 ds_read_b128 v[36:39], v24 offset:24576
 ds_read_b128 v[40:43], v25 offset:16384
 ds_read_b128 v[44:47], v25 offset:24576
 ds_read_b128 v[48:51], v26 offset:16384
 ds_read_b128 v[52:55], v26 offset:24576
 ds_read_b128 v[56:59], v27 offset:16384
 ds_read_b128 v[60:63], v27 offset:24576
 s_waitcnt vmcnt(0) lgkmcnt(0)
 s_barrier
 s_add_u32 m0, s31, -8192
 s_add_u32 s43, s42, 0
 buffer_load_dwordx4 v11, s[8:11], s43 offen lds
 buffer_load_dwordx4 v11, s[8:11], s43 offen offset:1024 lds
 s_add_u32 m0, s31, 0
 s_add_u32 s43, s42, 32768
 buffer_load_dwordx4 v11, s[8:11], s43 offen lds
 buffer_load_dwordx4 v11, s[8:11], s43 offen offset:1024 lds
 s_add_u32 m0, s31, 8192
 s_add_u32 s43, s42, 65536
 buffer_load_dwordx4 v11, s[8:11], s43 offen lds
 buffer_load_dwordx4 v11, s[8:11], s43 offen offset:1024 lds
 s_add_u32 m0, s31, 16384
 s_add_u32 s43, s42, 98304
 buffer_load_dwordx4 v11, s[8:11], s43 offen lds
 buffer_load_dwordx4 v11, s[8:11], s43 offen offset:1024 lds
 s_add_u32 s42, s42, s47
 ds_read_b64_tr_b16 a[72:73], v7 offset:16384
 ds_read_b64_tr_b16 a[74:75], v7 offset:18432
 ds_read_b64_tr_b16 a[76:77], v7 offset:16392
 ds_read_b64_tr_b16 a[78:79], v7 offset:18440
 v_mfma_f32_16x16x32_bf16 v[64:67], a[64:67], v[96:99], v[64:67]
 v_mfma_f32_16x16x32_bf16 v[68:71], a[68:71], v[96:99], v[68:71]
 v_mfma_f32_16x16x32_bf16 v[72:75], a[64:67], v[100:103], v[72:75]
 v_mfma_f32_16x16x32_bf16 v[76:79], a[68:71], v[100:103], v[76:79]
 v_mfma_f32_16x16x32_bf16 v[80:83], a[64:67], v[32:35], v[80:83]
 v_mfma_f32_16x16x32_bf16 v[84:87], a[68:71], v[32:35], v[84:87]
 v_mfma_f32_16x16x32_bf16 v[88:91], a[64:67], v[36:39], v[88:91]
 v_mfma_f32_16x16x32_bf16 v[92:95], a[68:71], v[36:39], v[92:95]
 s_waitcnt vmcnt(8) lgkmcnt(0)
 s_barrier
 s_add_u32 m0, s30, 0
 s_nop 0
 buffer_load_dwordx4 v6, s[8:11], s24 offen lds
 buffer_load_dwordx4 v6, s[8:11], s24 offen offset:1024 lds
 s_add_u32 s24, s24, s44
 ds_read_b64_tr_b16 a[80:81], v7 offset:32768
 ds_read_b64_tr_b16 a[82:83], v7 offset:34816
 ds_read_b64_tr_b16 a[84:85], v7 offset:32776
 ds_read_b64_tr_b16 a[86:87], v7 offset:34824
 v_mfma_f32_16x16x32_bf16 v[64:67], a[72:75], v[104:107], v[64:67]
 v_mfma_f32_16x16x32_bf16 v[68:71], a[76:79], v[104:107], v[68:71]
 v_mfma_f32_16x16x32_bf16 v[72:75], a[72:75], v[108:111], v[72:75]
 v_mfma_f32_16x16x32_bf16 v[76:79], a[76:79], v[108:111], v[76:79]
 v_mfma_f32_16x16x32_bf16 v[80:83], a[72:75], v[40:43], v[80:83]
 v_mfma_f32_16x16x32_bf16 v[84:87], a[76:79], v[40:43], v[84:87]
 v_mfma_f32_16x16x32_bf16 v[88:91], a[72:75], v[44:47], v[88:91]
 v_mfma_f32_16x16x32_bf16 v[92:95], a[76:79], v[44:47], v[92:95]
 s_waitcnt vmcnt(10) lgkmcnt(0)
 s_barrier
 s_add_u32 m0, s30, 16384
 s_nop 0
 buffer_load_dwordx4 v6, s[8:11], s24 offen lds
 buffer_load_dwordx4 v6, s[8:11], s24 offen offset:1024 lds
 s_add_u32 s24, s24, s45
 ds_read_b64_tr_b16 a[88:89], v7 offset:49152
 ds_read_b64_tr_b16 a[90:91], v7 offset:51200
 ds_read_b64_tr_b16 a[92:93], v7 offset:49160
 ds_read_b64_tr_b16 a[94:95], v7 offset:51208
 v_mfma_f32_16x16x32_bf16 v[64:67], a[80:83], v[112:115], v[64:67]
 v_mfma_f32_16x16x32_bf16 v[68:71], a[84:87], v[112:115], v[68:71]
 v_mfma_f32_16x16x32_bf16 v[72:75], a[80:83], v[116:119], v[72:75]
 v_mfma_f32_16x16x32_bf16 v[76:79], a[84:87], v[116:119], v[76:79]
 v_mfma_f32_16x16x32_bf16 v[80:83], a[80:83], v[48:51], v[80:83]
 v_mfma_f32_16x16x32_bf16 v[84:87], a[84:87], v[48:51], v[84:87]
 v_mfma_f32_16x16x32_bf16 v[88:91], a[80:83], v[52:55], v[88:91]
 v_mfma_f32_16x16x32_bf16 v[92:95], a[84:87], v[52:55], v[92:95]
 s_waitcnt vmcnt(4) lgkmcnt(0)
 s_barrier
 s_add_u32 m0, s30, 32768
 s_nop 0
 buffer_load_dwordx4 v6, s[8:11], s24 offen lds
 buffer_load_dwordx4 v6, s[8:11], s24 offen offset:1024 lds
 s_add_u32 s24, s24, s46
 ds_read_b64_tr_b16 a[96:97], v8 offset:0
 ds_read_b64_tr_b16 a[98:99], v8 offset:2048
 ds_read_b64_tr_b16 a[100:101], v8 offset:8
 ds_read_b64_tr_b16 a[102:103], v8 offset:2056
 v_mfma_f32_16x16x32_bf16 v[64:67], a[88:91], v[120:123], v[64:67]
 v_mfma_f32_16x16x32_bf16 v[68:71], a[92:95], v[120:123], v[68:71]
 v_mfma_f32_16x16x32_bf16 v[72:75], a[88:91], v[124:127], v[72:75]
 v_mfma_f32_16x16x32_bf16 v[76:79], a[92:95], v[124:127], v[76:79]
 v_mfma_f32_16x16x32_bf16 v[80:83], a[88:91], v[56:59], v[80:83]
 v_mfma_f32_16x16x32_bf16 v[84:87], a[92:95], v[56:59], v[84:87]
 v_mfma_f32_16x16x32_bf16 v[88:91], a[88:91], v[60:63], v[88:91]
 v_mfma_f32_16x16x32_bf16 v[92:95], a[92:95], v[60:63], v[92:95]
 ds_read_b128 v[96:99], v24 offset:0
 ds_read_b128 v[100:103], v24 offset:8192
 ds_read_b128 v[104:107], v25 offset:0
 ds_read_b128 v[108:111], v25 offset:8192
 ds_read_b128 v[112:115], v26 offset:0
 ds_read_b128 v[116:119], v26 offset:8192
 ds_read_b128 v[120:123], v27 offset:0
 ds_read_b128 v[124:127], v27 offset:8192
 ds_read_b128 v[32:35], v24 offset:16384
 ds_read_b128 v[36:39], v24 offset:24576
 ds_read_b128 v[40:43], v25 offset:16384
 ds_read_b128 v[44:47], v25 offset:24576
 ds_read_b128 v[48:51], v26 offset:16384
 ds_read_b128 v[52:55], v26 offset:24576
 ds_read_b128 v[56:59], v27 offset:16384
 ds_read_b128 v[60:63], v27 offset:24576
 s_waitcnt vmcnt(6) lgkmcnt(0)
 s_barrier
 s_add_u32 m0, s30, 49152
 s_nop 0
 buffer_load_dwordx4 v6, s[8:11], s24 offen lds
 buffer_load_dwordx4 v6, s[8:11], s24 offen offset:1024 lds
 s_add_u32 s24, s24, s47
 ds_read_b64_tr_b16 a[104:105], v8 offset:16384
 ds_read_b64_tr_b16 a[106:107], v8 offset:18432
 ds_read_b64_tr_b16 a[108:109], v8 offset:16392
 ds_read_b64_tr_b16 a[110:111], v8 offset:18440
 v_mfma_f32_16x16x32_bf16 v[64:67], a[96:99], v[96:99], v[64:67]
 v_mfma_f32_16x16x32_bf16 v[68:71], a[100:103], v[96:99], v[68:71]
 v_mfma_f32_16x16x32_bf16 v[72:75], a[96:99], v[100:103], v[72:75]
 v_mfma_f32_16x16x32_bf16 v[76:79], a[100:103], v[100:103], v[76:79]
 v_mfma_f32_16x16x32_bf16 v[80:83], a[96:99], v[32:35], v[80:83]
 v_mfma_f32_16x16x32_bf16 v[84:87], a[100:103], v[32:35], v[84:87]
 v_mfma_f32_16x16x32_bf16 v[88:91], a[96:99], v[36:39], v[88:91]
 v_mfma_f32_16x16x32_bf16 v[92:95], a[100:103], v[36:39], v[92:95]
 s_waitcnt vmcnt(8) lgkmcnt(0)
 s_barrier
 s_add_u32 m0, s30, 65536
 s_nop 0
 buffer_load_dwordx4 v6, s[8:11], s24 offen lds
 buffer_load_dwordx4 v6, s[8:11], s24 offen offset:1024 lds
 s_add_u32 s24, s24, s44
 ds_read_b64_tr_b16 a[112:113], v8 offset:32768
 ds_read_b64_tr_b16 a[114:115], v8 offset:34816
 ds_read_b64_tr_b16 a[116:117], v8 offset:32776
 ds_read_b64_tr_b16 a[118:119], v8 offset:34824
 v_mfma_f32_16x16x32_bf16 v[64:67], a[104:107], v[104:107], v[64:67]
 v_mfma_f32_16x16x32_bf16 v[68:71], a[108:111], v[104:107], v[68:71]
 v_mfma_f32_16x16x32_bf16 v[72:75], a[104:107], v[108:111], v[72:75]
 v_mfma_f32_16x16x32_bf16 v[76:79], a[108:111], v[108:111], v[76:79]
 v_mfma_f32_16x16x32_bf16 v[80:83], a[104:107], v[40:43], v[80:83]
 v_mfma_f32_16x16x32_bf16 v[84:87], a[108:111], v[40:43], v[84:87]
 v_mfma_f32_16x16x32_bf16 v[88:91], a[104:107], v[44:47], v[88:91]
 v_mfma_f32_16x16x32_bf16 v[92:95], a[108:111], v[44:47], v[92:95]
 s_waitcnt vmcnt(10) lgkmcnt(0)
 s_barrier
 s_add_u32 m0, s30, 81920
 s_nop 0
 buffer_load_dwordx4 v6, s[8:11], s24 offen lds
 buffer_load_dwordx4 v6, s[8:11], s24 offen offset:1024 lds
 s_add_u32 s24, s24, s45
 ds_read_b64_tr_b16 a[120:121], v8 offset:49152
 ds_read_b64_tr_b16 a[122:123], v8 offset:51200
 ds_read_b64_tr_b16 a[124:125], v8 offset:49160
 ds_read_b64_tr_b16 a[126:127], v8 offset:51208
 v_mfma_f32_16x16x32_bf16 v[64:67], a[112:115], v[112:115], v[64:67]
 v_mfma_f32_16x16x32_bf16 v[68:71], a[116:119], v[112:115], v[68:71]
 v_mfma_f32_16x16x32_bf16 v[72:75], a[112:115], v[116:119], v[72:75]
 v_mfma_f32_16x16x32_bf16 v[76:79], a[116:119], v[116:119], v[76:79]
 s_waitcnt lgkmcnt(0)
 v_mfma_f32_16x16x32_bf16 v[64:67], a[120:123], v[120:123], v[64:67]
 v_mfma_f32_16x16x32_bf16 v[68:71], a[124:127], v[120:123], v[68:71]
 v_mfma_f32_16x16x32_bf16 v[72:75], a[120:123], v[124:127], v[72:75]
 v_mfma_f32_16x16x32_bf16 v[76:79], a[124:127], v[124:127], v[76:79]
 ds_write_b128 v9, v[64:67] offset:0
 ds_write_b128 v9, v[68:71] offset:1024
 s_waitcnt lgkmcnt(0)
 s_barrier
 ds_read_b128 v[96:99], v10 offset:0
 ds_read_b128 v[100:103], v10 offset:1024
 s_waitcnt lgkmcnt(0)
 v_add_f32 v96, v96, v72
 v_add_f32 v97, v97, v73
 v_add_f32 v98, v98, v74
 v_add_f32 v99, v99, v75
 v_add_f32 v100, v100, v76
 v_add_f32 v101, v101, v77
 v_add_f32 v102, v102, v78
 v_add_f32 v103, v103, v79
 v_cvt_pk_bf16_f32 v104, v96, v97
 v_cvt_pk_bf16_f32 v105, v98, v99
 v_cvt_pk_bf16_f32 v106, v100, v101
 v_cvt_pk_bf16_f32 v107, v102, v103
 buffer_store_dwordx4 v[104:107], v15, s[4:7], s27 offen sc1
 s_add_u32 s27, s27, s28
L_wlb:
 s_waitcnt vmcnt(4)
 s_barrier
 s_cmp_lg_u32 s14, 7
 s_cbranch_scc1 L_wsp0
 v_mov_b32 v1, s29
 s_mov_b32 s29, s38
 s_mov_b64 exec, 1
 buffer_store_dword v1, off, s[4:7], s36 sc1
 s_mov_b64 exec, -1
L_wsp0:
 s_waitcnt lgkmcnt(3)
 v_mfma_f32_16x16x32_bf16 v[80:83], a[112:115], v[48:51], v[80:83]
 ds_read_b128 v[32:35], v16 offset:0
 v_mfma_f32_16x16x32_bf16 v[84:87], a[116:119], v[48:51], v[84:87]
 s_waitcnt lgkmcnt(3)
 v_mfma_f32_16x16x32_bf16 v[88:91], a[112:115], v[52:55], v[88:91]
 ds_read_b128 v[36:39], v16 offset:8192
 v_mfma_f32_16x16x32_bf16 v[92:95], a[116:119], v[52:55], v[92:95]
 s_waitcnt lgkmcnt(3)
 v_mfma_f32_16x16x32_bf16 v[80:83], a[120:123], v[56:59], v[80:83]
 ds_read_b128 v[40:43], v17 offset:0
 v_mfma_f32_16x16x32_bf16 v[84:87], a[124:127], v[56:59], v[84:87]
 s_waitcnt lgkmcnt(3)
 v_mfma_f32_16x16x32_bf16 v[88:91], a[120:123], v[60:63], v[88:91]
 ds_read_b128 v[44:47], v17 offset:8192
 v_mfma_f32_16x16x32_bf16 v[92:95], a[124:127], v[60:63], v[92:95]
 s_waitcnt lgkmcnt(3)
 v_mfma_f32_16x16x32_bf16 v[64:67], a[0:3], v[32:35], 0
 ds_read_b128 v[48:51], v18 offset:0
 v_mfma_f32_16x16x32_bf16 v[68:71], a[4:7], v[32:35], 0
 s_add_u32 m0, s30, 98304
 s_nop 0
 buffer_load_dwordx4 v6, s[8:11], s24 offen lds
 s_waitcnt lgkmcnt(3)
 v_mfma_f32_16x16x32_bf16 v[72:75], a[0:3], v[36:39], 0
 ds_read_b128 v[52:55], v18 offset:8192
 v_mfma_f32_16x16x32_bf16 v[76:79], a[4:7], v[36:39], 0
 ds_write_b128 v9, v[80:83] offset:0
 s_waitcnt lgkmcnt(4)
 v_mfma_f32_16x16x32_bf16 v[64:67], a[8:11], v[40:43], v[64:67]
 ds_read_b128 v[56:59], v19 offset:0
 v_mfma_f32_16x16x32_bf16 v[68:71], a[12:15], v[40:43], v[68:71]
 buffer_load_dwordx4 v6, s[8:11], s24 offen offset:1024 lds
 s_add_u32 s24, s24, s46
 ds_write_b128 v9, v[84:87] offset:1024
 s_waitcnt lgkmcnt(5)
 v_mfma_f32_16x16x32_bf16 v[72:75], a[8:11], v[44:47], v[72:75]
 ds_read_b128 v[60:63], v19 offset:8192
 v_mfma_f32_16x16x32_bf16 v[76:79], a[12:15], v[44:47], v[76:79]
 s_waitcnt lgkmcnt(1)
 s_waitcnt vmcnt(10)
 s_barrier
 s_waitcnt lgkmcnt(5)
 v_mfma_f32_16x16x32_bf16 v[64:67], a[16:19], v[48:51], v[64:67]
 ds_read_b128 v[32:35], v16 offset:16384
 v_mfma_f32_16x16x32_bf16 v[68:71], a[20:23], v[48:51], v[68:71]
 ds_read_b128 v[96:99], v10 offset:0
 ds_read_b128 v[100:103], v10 offset:1024
 s_waitcnt lgkmcnt(7)
 v_mfma_f32_16x16x32_bf16 v[72:75], a[16:19], v[52:55], v[72:75]
 ds_read_b128 v[36:39], v16 offset:24576
 v_mfma_f32_16x16x32_bf16 v[76:79], a[20:23], v[52:55], v[76:79]
 s_waitcnt lgkmcnt(6)
 v_mfma_f32_16x16x32_bf16 v[64:67], a[24:27], v[56:59], v[64:67]
 ds_read_b128 v[40:43], v17 offset:16384
 v_mfma_f32_16x16x32_bf16 v[68:71], a[28:31], v[56:59], v[68:71]
 s_waitcnt lgkmcnt(5)
 v_mfma_f32_16x16x32_bf16 v[72:75], a[24:27], v[60:63], v[72:75]
 ds_read_b128 v[44:47], v17 offset:24576
 s_waitcnt lgkmcnt(3)
 v_add_f32 v96, v96, v88
 v_add_f32 v97, v97, v89
 v_mfma_f32_16x16x32_bf16 v[76:79], a[28:31], v[60:63], v[76:79]
 v_add_f32 v98, v98, v90
 v_add_f32 v99, v99, v91
 s_waitcnt lgkmcnt(5)
 v_mfma_f32_16x16x32_bf16 v[64:67], a[32:35], v[32:35], v[64:67]
 ds_read_b128 v[48:51], v18 offset:16384
 v_add_f32 v100, v100, v92
 v_add_f32 v101, v101, v93
 v_mfma_f32_16x16x32_bf16 v[68:71], a[36:39], v[32:35], v[68:71]
 s_add_u32 m0, s30, 114688
 s_nop 0
 buffer_load_dwordx4 v6, s[8:11], s24 offen lds
 v_add_f32 v102, v102, v94
 v_add_f32 v103, v103, v95
 s_waitcnt lgkmcnt(3)
 v_mfma_f32_16x16x32_bf16 v[72:75], a[32:35], v[36:39], v[72:75]
 ds_read_b128 v[52:55], v18 offset:24576
 v_cvt_pk_bf16_f32 v104, v96, v97
 v_cvt_pk_bf16_f32 v105, v98, v99
 v_mfma_f32_16x16x32_bf16 v[76:79], a[36:39], v[36:39], v[76:79]
 v_cvt_pk_bf16_f32 v106, v100, v101
 v_cvt_pk_bf16_f32 v107, v102, v103
 s_waitcnt lgkmcnt(3)
 v_mfma_f32_16x16x32_bf16 v[64:67], a[40:43], v[40:43], v[64:67]
 ds_read_b128 v[56:59], v19 offset:16384
 v_mfma_f32_16x16x32_bf16 v[68:71], a[44:47], v[40:43], v[68:71]
 buffer_load_dwordx4 v6, s[8:11], s24 offen offset:1024 lds
 s_add_u32 s24, s24, s47
 buffer_store_dwordx4 v[104:107], v15, s[4:7], s27 offen sc1
 s_add_u32 s27, s27, s28
 s_waitcnt lgkmcnt(3)
 v_mfma_f32_16x16x32_bf16 v[72:75], a[40:43], v[44:47], v[72:75]
 ds_read_b128 v[60:63], v19 offset:24576
 v_mfma_f32_16x16x32_bf16 v[76:79], a[44:47], v[44:47], v[76:79]
 s_waitcnt vmcnt(10)
 s_barrier
 s_waitcnt lgkmcnt(3)
 v_mfma_f32_16x16x32_bf16 v[64:67], a[48:51], v[48:51], v[64:67]
 ds_read_b128 v[32:35], v16 offset:32768
 v_mfma_f32_16x16x32_bf16 v[68:71], a[52:55], v[48:51], v[68:71]
 s_waitcnt lgkmcnt(3)
 v_mfma_f32_16x16x32_bf16 v[72:75], a[48:51], v[52:55], v[72:75]
 ds_read_b128 v[36:39], v16 offset:40960
 v_mfma_f32_16x16x32_bf16 v[76:79], a[52:55], v[52:55], v[76:79]
 s_waitcnt lgkmcnt(3)
 v_mfma_f32_16x16x32_bf16 v[64:67], a[56:59], v[56:59], v[64:67]
 ds_read_b128 v[40:43], v17 offset:32768
 v_mfma_f32_16x16x32_bf16 v[68:71], a[60:63], v[56:59], v[68:71]
 s_waitcnt lgkmcnt(3)
 v_mfma_f32_16x16x32_bf16 v[72:75], a[56:59], v[60:63], v[72:75]
 ds_read_b128 v[44:47], v17 offset:40960
 v_mfma_f32_16x16x32_bf16 v[76:79], a[60:63], v[60:63], v[76:79]
 s_waitcnt lgkmcnt(3)
 v_mfma_f32_16x16x32_bf16 v[64:67], a[64:67], v[32:35], v[64:67]
 ds_read_b128 v[48:51], v18 offset:32768
 v_mfma_f32_16x16x32_bf16 v[68:71], a[68:71], v[32:35], v[68:71]
 s_add_u32 m0, s30, 0
 s_nop 0
 buffer_load_dwordx4 v6, s[8:11], s24 offen lds
 s_waitcnt lgkmcnt(3)
 v_mfma_f32_16x16x32_bf16 v[72:75], a[64:67], v[36:39], v[72:75]
 ds_read_b128 v[52:55], v18 offset:40960
 v_mfma_f32_16x16x32_bf16 v[76:79], a[68:71], v[36:39], v[76:79]
 s_waitcnt lgkmcnt(3)
 v_mfma_f32_16x16x32_bf16 v[64:67], a[72:75], v[40:43], v[64:67]
 ds_read_b128 v[56:59], v19 offset:32768
 v_mfma_f32_16x16x32_bf16 v[68:71], a[76:79], v[40:43], v[68:71]
 buffer_load_dwordx4 v6, s[8:11], s24 offen offset:1024 lds
 s_add_u32 s24, s24, s44
 s_waitcnt lgkmcnt(3)
 v_mfma_f32_16x16x32_bf16 v[72:75], a[72:75], v[44:47], v[72:75]
 ds_read_b128 v[60:63], v19 offset:40960
 v_mfma_f32_16x16x32_bf16 v[76:79], a[76:79], v[44:47], v[76:79]
 s_waitcnt vmcnt(10)
 s_barrier
 s_add_u32 s38, s38, 1
 s_waitcnt lgkmcnt(3)
 v_mfma_f32_16x16x32_bf16 v[64:67], a[80:83], v[48:51], v[64:67]
 ds_read_b128 v[32:35], v16 offset:49152
 v_mfma_f32_16x16x32_bf16 v[68:71], a[84:87], v[48:51], v[68:71]
 s_waitcnt lgkmcnt(3)
 v_mfma_f32_16x16x32_bf16 v[72:75], a[80:83], v[52:55], v[72:75]
 ds_read_b128 v[36:39], v16 offset:57344
 v_mfma_f32_16x16x32_bf16 v[76:79], a[84:87], v[52:55], v[76:79]
 s_waitcnt lgkmcnt(3)
 v_mfma_f32_16x16x32_bf16 v[64:67], a[88:91], v[56:59], v[64:67]
 ds_read_b128 v[40:43], v17 offset:49152
 v_mfma_f32_16x16x32_bf16 v[68:71], a[92:95], v[56:59], v[68:71]
 s_waitcnt lgkmcnt(3)
 v_mfma_f32_16x16x32_bf16 v[72:75], a[88:91], v[60:63], v[72:75]
 ds_read_b128 v[44:47], v17 offset:57344
 v_mfma_f32_16x16x32_bf16 v[76:79], a[92:95], v[60:63], v[76:79]
 s_waitcnt lgkmcnt(3)
 v_mfma_f32_16x16x32_bf16 v[64:67], a[96:99], v[32:35], v[64:67]
 ds_read_b128 v[48:51], v18 offset:49152
 v_mfma_f32_16x16x32_bf16 v[68:71], a[100:103], v[32:35], v[68:71]
 s_add_u32 m0, s30, 16384
 s_nop 0
 buffer_load_dwordx4 v6, s[8:11], s24 offen lds
 s_waitcnt lgkmcnt(3)
 v_mfma_f32_16x16x32_bf16 v[72:75], a[96:99], v[36:39], v[72:75]
 ds_read_b128 v[52:55], v18 offset:57344
 v_mfma_f32_16x16x32_bf16 v[76:79], a[100:103], v[36:39], v[76:79]
 s_waitcnt lgkmcnt(3)
 v_mfma_f32_16x16x32_bf16 v[64:67], a[104:107], v[40:43], v[64:67]
 ds_read_b128 v[56:59], v19 offset:49152
 v_mfma_f32_16x16x32_bf16 v[68:71], a[108:111], v[40:43], v[68:71]
 buffer_load_dwordx4 v6, s[8:11], s24 offen offset:1024 lds
 s_add_u32 s24, s24, s45
 s_waitcnt lgkmcnt(3)
 v_mfma_f32_16x16x32_bf16 v[72:75], a[104:107], v[44:47], v[72:75]
 ds_read_b128 v[60:63], v19 offset:57344
 v_mfma_f32_16x16x32_bf16 v[76:79], a[108:111], v[44:47], v[76:79]
 s_waitcnt vmcnt(4)
 s_barrier
 s_cmp_lg_u32 s14, 7
 s_cbranch_scc1 L_wsp1
 v_mov_b32 v1, s29
 s_mov_b32 s29, s38
 s_mov_b64 exec, 1
 buffer_store_dword v1, off, s[4:7], s36 sc1
 s_mov_b64 exec, -1
L_wsp1:
 s_waitcnt lgkmcnt(3)
 v_mfma_f32_16x16x32_bf16 v[64:67], a[112:115], v[48:51], v[64:67]
 ds_read_b128 v[32:35], v20 offset:0
 v_mfma_f32_16x16x32_bf16 v[68:71], a[116:119], v[48:51], v[68:71]
 s_waitcnt lgkmcnt(3)
 v_mfma_f32_16x16x32_bf16 v[72:75], a[112:115], v[52:55], v[72:75]
 ds_read_b128 v[36:39], v20 offset:8192
 v_mfma_f32_16x16x32_bf16 v[76:79], a[116:119], v[52:55], v[76:79]
 s_waitcnt lgkmcnt(3)
 v_mfma_f32_16x16x32_bf16 v[64:67], a[120:123], v[56:59], v[64:67]
 ds_read_b128 v[40:43], v21 offset:0
 v_mfma_f32_16x16x32_bf16 v[68:71], a[124:127], v[56:59], v[68:71]
 s_waitcnt lgkmcnt(3)
 v_mfma_f32_16x16x32_bf16 v[72:75], a[120:123], v[60:63], v[72:75]
 ds_read_b128 v[44:47], v21 offset:8192
 v_mfma_f32_16x16x32_bf16 v[76:79], a[124:127], v[60:63], v[76:79]
 s_waitcnt lgkmcnt(3)
 v_mfma_f32_16x16x32_bf16 v[80:83], a[0:3], v[32:35], 0
 ds_read_b128 v[48:51], v22 offset:0
 v_mfma_f32_16x16x32_bf16 v[84:87], a[4:7], v[32:35], 0
 s_add_u32 m0, s30, 32768
 s_nop 0
 buffer_load_dwordx4 v6, s[8:11], s24 offen lds
 s_waitcnt lgkmcnt(3)
 v_mfma_f32_16x16x32_bf16 v[88:91], a[0:3], v[36:39], 0
 ds_read_b128 v[52:55], v22 offset:8192
 v_mfma_f32_16x16x32_bf16 v[92:95], a[4:7], v[36:39], 0
 ds_write_b128 v9, v[64:67] offset:0
 s_waitcnt lgkmcnt(4)
 v_mfma_f32_16x16x32_bf16 v[80:83], a[8:11], v[40:43], v[80:83]
 ds_read_b128 v[56:59], v23 offset:0
 v_mfma_f32_16x16x32_bf16 v[84:87], a[12:15], v[40:43], v[84:87]
 buffer_load_dwordx4 v6, s[8:11], s24 offen offset:1024 lds
 s_add_u32 s24, s24, s46
 ds_write_b128 v9, v[68:71] offset:1024
 s_waitcnt lgkmcnt(5)
 v_mfma_f32_16x16x32_bf16 v[88:91], a[8:11], v[44:47], v[88:91]
 ds_read_b128 v[60:63], v23 offset:8192
 v_mfma_f32_16x16x32_bf16 v[92:95], a[12:15], v[44:47], v[92:95]
 s_waitcnt lgkmcnt(1)
 s_waitcnt vmcnt(10)
 s_barrier
 s_waitcnt lgkmcnt(5)
 v_mfma_f32_16x16x32_bf16 v[80:83], a[16:19], v[48:51], v[80:83]
 ds_read_b128 v[32:35], v20 offset:16384
 v_mfma_f32_16x16x32_bf16 v[84:87], a[20:23], v[48:51], v[84:87]
 ds_read_b128 v[96:99], v10 offset:0
 ds_read_b128 v[100:103], v10 offset:1024
 s_waitcnt lgkmcnt(7)
 v_mfma_f32_16x16x32_bf16 v[88:91], a[16:19], v[52:55], v[88:91]
 ds_read_b128 v[36:39], v20 offset:24576
 v_mfma_f32_16x16x32_bf16 v[92:95], a[20:23], v[52:55], v[92:95]
 s_waitcnt lgkmcnt(6)
 v_mfma_f32_16x16x32_bf16 v[80:83], a[24:27], v[56:59], v[80:83]
 ds_read_b128 v[40:43], v21 offset:16384
 v_mfma_f32_16x16x32_bf16 v[84:87], a[28:31], v[56:59], v[84:87]
 s_waitcnt lgkmcnt(5)
 v_mfma_f32_16x16x32_bf16 v[88:91], a[24:27], v[60:63], v[88:91]
 ds_read_b128 v[44:47], v21 offset:24576
 s_waitcnt lgkmcnt(3)
 v_add_f32 v96, v96, v72
 v_add_f32 v97, v97, v73
 v_mfma_f32_16x16x32_bf16 v[92:95], a[28:31], v[60:63], v[92:95]
 v_add_f32 v98, v98, v74
 v_add_f32 v99, v99, v75
 s_waitcnt lgkmcnt(5)
 v_mfma_f32_16x16x32_bf16 v[80:83], a[32:35], v[32:35], v[80:83]
 ds_read_b128 v[48:51], v22 offset:16384
 v_add_f32 v100, v100, v76
 v_add_f32 v101, v101, v77
 v_mfma_f32_16x16x32_bf16 v[84:87], a[36:39], v[32:35], v[84:87]
 s_add_u32 m0, s30, 49152
 s_nop 0
 buffer_load_dwordx4 v6, s[8:11], s24 offen lds
 v_add_f32 v102, v102, v78
 v_add_f32 v103, v103, v79
 s_waitcnt lgkmcnt(3)
 v_mfma_f32_16x16x32_bf16 v[88:91], a[32:35], v[36:39], v[88:91]
 ds_read_b128 v[52:55], v22 offset:24576
 v_cvt_pk_bf16_f32 v104, v96, v97
 v_cvt_pk_bf16_f32 v105, v98, v99
 v_mfma_f32_16x16x32_bf16 v[92:95], a[36:39], v[36:39], v[92:95]
 v_cvt_pk_bf16_f32 v106, v100, v101
 v_cvt_pk_bf16_f32 v107, v102, v103
 s_waitcnt lgkmcnt(3)
 v_mfma_f32_16x16x32_bf16 v[80:83], a[40:43], v[40:43], v[80:83]
 ds_read_b128 v[56:59], v23 offset:16384
 v_mfma_f32_16x16x32_bf16 v[84:87], a[44:47], v[40:43], v[84:87]
 buffer_load_dwordx4 v6, s[8:11], s24 offen offset:1024 lds
 s_add_u32 s24, s24, s47
 buffer_store_dwordx4 v[104:107], v15, s[4:7], s27 offen sc1
 s_add_u32 s27, s27, s28
 s_waitcnt lgkmcnt(3)
 v_mfma_f32_16x16x32_bf16 v[88:91], a[40:43], v[44:47], v[88:91]
 ds_read_b128 v[60:63], v23 offset:24576
 v_mfma_f32_16x16x32_bf16 v[92:95], a[44:47], v[44:47], v[92:95]
 s_waitcnt vmcnt(10)
 s_barrier
 s_waitcnt lgkmcnt(3)
 v_mfma_f32_16x16x32_bf16 v[80:83], a[48:51], v[48:51], v[80:83]
 ds_read_b128 v[32:35], v20 offset:32768
 v_mfma_f32_16x16x32_bf16 v[84:87], a[52:55], v[48:51], v[84:87]
 s_waitcnt lgkmcnt(3)
 v_mfma_f32_16x16x32_bf16 v[88:91], a[48:51], v[52:55], v[88:91]
 ds_read_b128 v[36:39], v20 offset:40960
 v_mfma_f32_16x16x32_bf16 v[92:95], a[52:55], v[52:55], v[92:95]
 s_waitcnt lgkmcnt(3)
 v_mfma_f32_16x16x32_bf16 v[80:83], a[56:59], v[56:59], v[80:83]
 ds_read_b128 v[40:43], v21 offset:32768
 v_mfma_f32_16x16x32_bf16 v[84:87], a[60:63], v[56:59], v[84:87]
 s_waitcnt lgkmcnt(3)
 v_mfma_f32_16x16x32_bf16 v[88:91], a[56:59], v[60:63], v[88:91]
 ds_read_b128 v[44:47], v21 offset:40960
 v_mfma_f32_16x16x32_bf16 v[92:95], a[60:63], v[60:63], v[92:95]
 s_waitcnt lgkmcnt(3)
 v_mfma_f32_16x16x32_bf16 v[80:83], a[64:67], v[32:35], v[80:83]
 ds_read_b128 v[48:51], v22 offset:32768
 v_mfma_f32_16x16x32_bf16 v[84:87], a[68:71], v[32:35], v[84:87]
 s_add_u32 m0, s30, 65536
 s_nop 0
 buffer_load_dwordx4 v6, s[8:11], s24 offen lds
 s_waitcnt lgkmcnt(3)
 v_mfma_f32_16x16x32_bf16 v[88:91], a[64:67], v[36:39], v[88:91]
 ds_read_b128 v[52:55], v22 offset:40960
 v_mfma_f32_16x16x32_bf16 v[92:95], a[68:71], v[36:39], v[92:95]
 s_waitcnt lgkmcnt(3)
 v_mfma_f32_16x16x32_bf16 v[80:83], a[72:75], v[40:43], v[80:83]
 ds_read_b128 v[56:59], v23 offset:32768
 v_mfma_f32_16x16x32_bf16 v[84:87], a[76:79], v[40:43], v[84:87]
 buffer_load_dwordx4 v6, s[8:11], s24 offen offset:1024 lds
 s_add_u32 s24, s24, s44
 s_waitcnt lgkmcnt(3)
 v_mfma_f32_16x16x32_bf16 v[88:91], a[72:75], v[44:47], v[88:91]
 ds_read_b128 v[60:63], v23 offset:40960
 v_mfma_f32_16x16x32_bf16 v[92:95], a[76:79], v[44:47], v[92:95]
 s_waitcnt vmcnt(10)
 s_barrier
 s_add_u32 s38, s38, 1
 s_waitcnt lgkmcnt(3)
 v_mfma_f32_16x16x32_bf16 v[80:83], a[80:83], v[48:51], v[80:83]
 ds_read_b128 v[32:35], v20 offset:49152
 v_mfma_f32_16x16x32_bf16 v[84:87], a[84:87], v[48:51], v[84:87]
 s_waitcnt lgkmcnt(3)
 v_mfma_f32_16x16x32_bf16 v[88:91], a[80:83], v[52:55], v[88:91]
 ds_read_b128 v[36:39], v20 offset:57344
 v_mfma_f32_16x16x32_bf16 v[92:95], a[84:87], v[52:55], v[92:95]
 s_waitcnt lgkmcnt(3)
 v_mfma_f32_16x16x32_bf16 v[80:83], a[88:91], v[56:59], v[80:83]
 ds_read_b128 v[40:43], v21 offset:49152
 v_mfma_f32_16x16x32_bf16 v[84:87], a[92:95], v[56:59], v[84:87]
 s_waitcnt lgkmcnt(3)
 v_mfma_f32_16x16x32_bf16 v[88:91], a[88:91], v[60:63], v[88:91]
 ds_read_b128 v[44:47], v21 offset:57344
 v_mfma_f32_16x16x32_bf16 v[92:95], a[92:95], v[60:63], v[92:95]
 s_waitcnt lgkmcnt(3)
 v_mfma_f32_16x16x32_bf16 v[80:83], a[96:99], v[32:35], v[80:83]
 ds_read_b128 v[48:51], v22 offset:49152
 v_mfma_f32_16x16x32_bf16 v[84:87], a[100:103], v[32:35], v[84:87]
 s_add_u32 m0, s30, 81920
 s_nop 0
 buffer_load_dwordx4 v6, s[8:11], s24 offen lds
 s_waitcnt lgkmcnt(3)
 v_mfma_f32_16x16x32_bf16 v[88:91], a[96:99], v[36:39], v[88:91]
 ds_read_b128 v[52:55], v22 offset:57344
 v_mfma_f32_16x16x32_bf16 v[92:95], a[100:103], v[36:39], v[92:95]
 s_waitcnt lgkmcnt(3)
 v_mfma_f32_16x16x32_bf16 v[80:83], a[104:107], v[40:43], v[80:83]
 ds_read_b128 v[56:59], v23 offset:49152
 v_mfma_f32_16x16x32_bf16 v[84:87], a[108:111], v[40:43], v[84:87]
 buffer_load_dwordx4 v6, s[8:11], s24 offen offset:1024 lds
 s_add_u32 s24, s24, s45
 s_waitcnt lgkmcnt(3)
 v_mfma_f32_16x16x32_bf16 v[88:91], a[104:107], v[44:47], v[88:91]
 ds_read_b128 v[60:63], v23 offset:57344
 v_mfma_f32_16x16x32_bf16 v[92:95], a[108:111], v[44:47], v[92:95]
 s_cmp_lt_u32 s38, 64
 s_cbranch_scc1 L_wlb
 s_waitcnt lgkmcnt(0)
 v_mfma_f32_16x16x32_bf16 v[80:83], a[112:115], v[48:51], v[80:83]
 v_mfma_f32_16x16x32_bf16 v[84:87], a[116:119], v[48:51], v[84:87]
 s_waitcnt lgkmcnt(0)
 v_mfma_f32_16x16x32_bf16 v[88:91], a[112:115], v[52:55], v[88:91]
 v_mfma_f32_16x16x32_bf16 v[92:95], a[116:119], v[52:55], v[92:95]
 s_waitcnt lgkmcnt(0)
 v_mfma_f32_16x16x32_bf16 v[80:83], a[120:123], v[56:59], v[80:83]
 v_mfma_f32_16x16x32_bf16 v[84:87], a[124:127], v[56:59], v[84:87]
 s_waitcnt lgkmcnt(0)
 v_mfma_f32_16x16x32_bf16 v[88:91], a[120:123], v[60:63], v[88:91]
 v_mfma_f32_16x16x32_bf16 v[92:95], a[124:127], v[60:63], v[92:95]
 ds_write_b128 v9, v[80:83] offset:0
 ds_write_b128 v9, v[84:87] offset:1024
 s_waitcnt lgkmcnt(0)
 s_barrier
 ds_read_b128 v[96:99], v10 offset:0
 ds_read_b128 v[100:103], v10 offset:1024
 s_waitcnt lgkmcnt(0)
 v_add_f32 v96, v96, v88
 v_add_f32 v97, v97, v89
 v_add_f32 v98, v98, v90
 v_add_f32 v99, v99, v91
 v_add_f32 v100, v100, v92
 v_add_f32 v101, v101, v93
 v_add_f32 v102, v102, v94
 v_add_f32 v103, v103, v95
 v_cvt_pk_bf16_f32 v104, v96, v97
 v_cvt_pk_bf16_f32 v105, v98, v99
 v_cvt_pk_bf16_f32 v106, v100, v101
 v_cvt_pk_bf16_f32 v107, v102, v103
 buffer_store_dwordx4 v[104:107], v15, s[4:7], s27 offen sc1
 s_add_u32 s27, s27, s28
L_wse:
 s_waitcnt vmcnt(0)
 s_barrier
 s_mov_b32 s37, 0
 s_cmp_lg_u32 s14, 7
 s_cbranch_scc1 L_next
 v_mov_b32 v1, 64
 s_mov_b64 exec, 1
 buffer_store_dword v1, off, s[4:7], s36 sc1
 s_mov_b64 exec, -1
 s_branch L_next
L_akv:
 s_load_dwordx2 s[44:45], s[0:1], 16
 s_mov_b32 s46, 65536
 s_mov_b32 s47, 0x20000
 s_load_dwordx2 s[48:49], s[0:1], 24
 s_mov_b32 s50, 65536
 s_mov_b32 s51, 0x20000
 s_load_dwordx2 s[52:53], s[0:1], 96
 s_mov_b32 s54, 2048
 s_mov_b32 s55, 0x20000
 v_lshlrev_b32 v15, 4, v0
 s_lshl_b32 s33, s14, 13
 s_mov_b32 s40, 0x3f803f80
 s_waitcnt lgkmcnt(0)
 s_add_u32 s34, s33, 0
 s_add_u32 m0, s34, 0
 s_nop 0
 buffer_load_dwordx4 v15, s[44:47], s34 offen offset:0 lds
 buffer_load_dwordx4 v15, s[44:47], s34 offen offset:1024 lds
 buffer_load_dwordx4 v15, s[44:47], s34 offen offset:2048 lds
 buffer_load_dwordx4 v15, s[44:47], s34 offen offset:3072 lds
 s_add_u32 s34, s33, 4096
 s_add_u32 m0, s34, 0
 s_nop 0
 buffer_load_dwordx4 v15, s[44:47], s34 offen offset:0 lds
 buffer_load_dwordx4 v15, s[44:47], s34 offen offset:1024 lds
 buffer_load_dwordx4 v15, s[44:47], s34 offen offset:2048 lds
 buffer_load_dwordx4 v15, s[44:47], s34 offen offset:3072 lds
 s_add_u32 s34, s33, 0
 s_add_u32 m0, s34, 65536
 s_nop 0
 buffer_load_dwordx4 v15, s[48:51], s34 offen offset:0 lds
 buffer_load_dwordx4 v15, s[48:51], s34 offen offset:1024 lds
 buffer_load_dwordx4 v15, s[48:51], s34 offen offset:2048 lds
 buffer_load_dwordx4 v15, s[48:51], s34 offen offset:3072 lds
 s_add_u32 s34, s33, 4096
 s_add_u32 m0, s34, 65536
 s_nop 0
 buffer_load_dwordx4 v15, s[48:51], s34 offen offset:0 lds
 buffer_load_dwordx4 v15, s[48:51], s34 offen offset:1024 lds
 buffer_load_dwordx4 v15, s[48:51], s34 offen offset:2048 lds
 buffer_load_dwordx4 v15, s[48:51], s34 offen offset:3072 lds
 s_mov_b32 m0, 131072
 s_nop 0
 buffer_load_dwordx4 v15, s[52:55], 0 offen offset:0 lds
 buffer_load_dwordx4 v15, s[52:55], 0 offen offset:1024 lds
 v_and_b32 v16, 31, v0
 v_lshrrev_b32 v17, 5, v0
 v_lshlrev_b32 v1, 11, v16
 v_lshl_add_u32 v1, v17, 4, v1
 s_lshl_b32 s34, s12, 3
 s_add_u32 s34, s34, s14
 s_lshl_b32 s24, s34, 16
 v_bfe_u32 v18, v0, 2, 2
 v_lshl_add_u32 v18, v17, 3, v18
 v_lshlrev_b32 v2, 6, v18
 v_bfe_u32 v18, v0, 4, 1
 v_lshl_add_u32 v2, v18, 5, v2
 v_and_b32 v18, 3, v0
 v_lshl_add_u32 v2, v18, 3, v2
 v_add_u32 v3, 65536, v2
 v_lshlrev_b32 v4, 4, v17
 v_add_u32 v4, 131072, v4
 v_mov_b32 v5, 0
 v_mov_b32 v6, 0
 v_accvgpr_write_b32 a0, 0
 v_accvgpr_write_b32 a1, 0
 v_accvgpr_write_b32 a2, 0
 v_accvgpr_write_b32 a3, 0
 v_accvgpr_write_b32 a4, 0
 v_accvgpr_write_b32 a5, 0
 v_accvgpr_write_b32 a6, 0
 v_accvgpr_write_b32 a7, 0
 v_accvgpr_write_b32 a8, 0
 v_accvgpr_write_b32 a9, 0
 v_accvgpr_write_b32 a10, 0
 v_accvgpr_write_b32 a11, 0
 v_accvgpr_write_b32 a12, 0
 v_accvgpr_write_b32 a13, 0
 v_accvgpr_write_b32 a14, 0
 v_accvgpr_write_b32 a15, 0
 v_accvgpr_write_b32 a16, 0
 v_accvgpr_write_b32 a17, 0
 v_accvgpr_write_b32 a18, 0
 v_accvgpr_write_b32 a19, 0
 v_accvgpr_write_b32 a20, 0
 v_accvgpr_write_b32 a21, 0
 v_accvgpr_write_b32 a22, 0
 v_accvgpr_write_b32 a23, 0
 v_accvgpr_write_b32 a24, 0
 v_accvgpr_write_b32 a25, 0
 v_accvgpr_write_b32 a26, 0
 v_accvgpr_write_b32 a27, 0
 v_accvgpr_write_b32 a28, 0
 v_accvgpr_write_b32 a29, 0
 v_accvgpr_write_b32 a30, 0
 v_accvgpr_write_b32 a31, 0
 buffer_load_dwordx4 v[64:67], v1, s[8:11], s24 offen offset:0
 buffer_load_dwordx4 v[68:71], v1, s[8:11], s24 offen offset:32
 buffer_load_dwordx4 v[72:75], v1, s[8:11], s24 offen offset:64
 buffer_load_dwordx4 v[76:79], v1, s[8:11], s24 offen offset:96
 buffer_load_dwordx4 v[80:83], v1, s[8:11], s24 offen offset:128
 buffer_load_dwordx4 v[84:87], v1, s[8:11], s24 offen offset:160
 buffer_load_dwordx4 v[88:91], v1, s[8:11], s24 offen offset:192
 buffer_load_dwordx4 v[92:95], v1, s[8:11], s24 offen offset:224
 buffer_load_dwordx4 v[96:99], v1, s[8:11], s24 offen offset:256
 buffer_load_dwordx4 v[100:103], v1, s[8:11], s24 offen offset:288
 buffer_load_dwordx4 v[104:107], v1, s[8:11], s24 offen offset:320
 buffer_load_dwordx4 v[108:111], v1, s[8:11], s24 offen offset:352
 buffer_load_dwordx4 v[112:115], v1, s[8:11], s24 offen offset:384
 buffer_load_dwordx4 v[116:119], v1, s[8:11], s24 offen offset:416
 buffer_load_dwordx4 v[120:123], v1, s[8:11], s24 offen offset:448
 buffer_load_dwordx4 v[124:127], v1, s[8:11], s24 offen offset:480
 s_mov_b32 s29, 0
 s_waitcnt vmcnt(16)
 s_barrier
L_akvl:
 s_add_u32 s24, s24, 512
 ds_read_b64_tr_b16 v[16:17], v2 offset:0
 ds_read_b64_tr_b16 v[20:21], v3 offset:0
 ds_read_b64_tr_b16 v[18:19], v2 offset:256
 ds_read_b64_tr_b16 v[22:23], v3 offset:256
 ds_read_b128 v[24:27], v4 offset:0
 s_waitcnt vmcnt(15) lgkmcnt(0)
 v_mfma_f32_32x32x16_bf16 a[0:15], v[16:19], v[64:67], a[0:15]
 v_mfma_f32_32x32x16_bf16 a[16:31], v[64:67], v[20:23], a[16:31]
 v_lshlrev_b32 v40, 16, v64
 v_lshlrev_b32 v41, 16, v24
 v_and_b32 v42, 0xffff0000, v64
 v_and_b32 v43, 0xffff0000, v24
 v_mul_f32 v40, v40, v41
 v_mul_f32 v42, v42, v43
 v_cvt_pk_bf16_f32 v44, v40, v42
 v_lshlrev_b32 v40, 16, v65
 v_lshlrev_b32 v41, 16, v25
 v_and_b32 v42, 0xffff0000, v65
 v_and_b32 v43, 0xffff0000, v25
 v_mul_f32 v40, v40, v41
 v_mul_f32 v42, v42, v43
 v_cvt_pk_bf16_f32 v45, v40, v42
 v_lshlrev_b32 v40, 16, v66
 v_lshlrev_b32 v41, 16, v26
 v_and_b32 v42, 0xffff0000, v66
 v_and_b32 v43, 0xffff0000, v26
 v_mul_f32 v40, v40, v41
 v_mul_f32 v42, v42, v43
 v_cvt_pk_bf16_f32 v46, v40, v42
 v_lshlrev_b32 v40, 16, v67
 v_lshlrev_b32 v41, 16, v27
 v_and_b32 v42, 0xffff0000, v67
 v_and_b32 v43, 0xffff0000, v27
 v_mul_f32 v40, v40, v41
 v_mul_f32 v42, v42, v43
 v_cvt_pk_bf16_f32 v47, v40, v42
 v_dot2c_f32_bf16 v5, s40, v44
 v_dot2c_f32_bf16 v6, s40, v45
 v_dot2c_f32_bf16 v5, s40, v46
 v_dot2c_f32_bf16 v6, s40, v47
 buffer_load_dwordx4 v[64:67], v1, s[8:11], s24 offen offset:0
 ds_read_b64_tr_b16 v[28:29], v2 offset:1024
 ds_read_b64_tr_b16 v[32:33], v3 offset:1024
 ds_read_b64_tr_b16 v[30:31], v2 offset:1280
 ds_read_b64_tr_b16 v[34:35], v3 offset:1280
 ds_read_b128 v[36:39], v4 offset:32
 s_waitcnt vmcnt(15) lgkmcnt(0)
 v_mfma_f32_32x32x16_bf16 a[0:15], v[28:31], v[68:71], a[0:15]
 v_mfma_f32_32x32x16_bf16 a[16:31], v[68:71], v[32:35], a[16:31]
 v_lshlrev_b32 v40, 16, v68
 v_lshlrev_b32 v41, 16, v36
 v_and_b32 v42, 0xffff0000, v68
 v_and_b32 v43, 0xffff0000, v36
 v_mul_f32 v40, v40, v41
 v_mul_f32 v42, v42, v43
 v_cvt_pk_bf16_f32 v44, v40, v42
 v_lshlrev_b32 v40, 16, v69
 v_lshlrev_b32 v41, 16, v37
 v_and_b32 v42, 0xffff0000, v69
 v_and_b32 v43, 0xffff0000, v37
 v_mul_f32 v40, v40, v41
 v_mul_f32 v42, v42, v43
 v_cvt_pk_bf16_f32 v45, v40, v42
 v_lshlrev_b32 v40, 16, v70
 v_lshlrev_b32 v41, 16, v38
 v_and_b32 v42, 0xffff0000, v70
 v_and_b32 v43, 0xffff0000, v38
 v_mul_f32 v40, v40, v41
 v_mul_f32 v42, v42, v43
 v_cvt_pk_bf16_f32 v46, v40, v42
 v_lshlrev_b32 v40, 16, v71
 v_lshlrev_b32 v41, 16, v39
 v_and_b32 v42, 0xffff0000, v71
 v_and_b32 v43, 0xffff0000, v39
 v_mul_f32 v40, v40, v41
 v_mul_f32 v42, v42, v43
 v_cvt_pk_bf16_f32 v47, v40, v42
 v_dot2c_f32_bf16 v5, s40, v44
 v_dot2c_f32_bf16 v6, s40, v45
 v_dot2c_f32_bf16 v5, s40, v46
 v_dot2c_f32_bf16 v6, s40, v47
 buffer_load_dwordx4 v[68:71], v1, s[8:11], s24 offen offset:32
 ds_read_b64_tr_b16 v[16:17], v2 offset:2048
 ds_read_b64_tr_b16 v[20:21], v3 offset:2048
 ds_read_b64_tr_b16 v[18:19], v2 offset:2304
 ds_read_b64_tr_b16 v[22:23], v3 offset:2304
 ds_read_b128 v[24:27], v4 offset:64
 s_waitcnt vmcnt(15) lgkmcnt(0)
 v_mfma_f32_32x32x16_bf16 a[0:15], v[16:19], v[72:75], a[0:15]
 v_mfma_f32_32x32x16_bf16 a[16:31], v[72:75], v[20:23], a[16:31]
 v_lshlrev_b32 v40, 16, v72
 v_lshlrev_b32 v41, 16, v24
 v_and_b32 v42, 0xffff0000, v72
 v_and_b32 v43, 0xffff0000, v24
 v_mul_f32 v40, v40, v41
 v_mul_f32 v42, v42, v43
 v_cvt_pk_bf16_f32 v44, v40, v42
 v_lshlrev_b32 v40, 16, v73
 v_lshlrev_b32 v41, 16, v25
 v_and_b32 v42, 0xffff0000, v73
 v_and_b32 v43, 0xffff0000, v25
 v_mul_f32 v40, v40, v41
 v_mul_f32 v42, v42, v43
 v_cvt_pk_bf16_f32 v45, v40, v42
 v_lshlrev_b32 v40, 16, v74
 v_lshlrev_b32 v41, 16, v26
 v_and_b32 v42, 0xffff0000, v74
 v_and_b32 v43, 0xffff0000, v26
 v_mul_f32 v40, v40, v41
 v_mul_f32 v42, v42, v43
 v_cvt_pk_bf16_f32 v46, v40, v42
 v_lshlrev_b32 v40, 16, v75
 v_lshlrev_b32 v41, 16, v27
 v_and_b32 v42, 0xffff0000, v75
 v_and_b32 v43, 0xffff0000, v27
 v_mul_f32 v40, v40, v41
 v_mul_f32 v42, v42, v43
 v_cvt_pk_bf16_f32 v47, v40, v42
 v_dot2c_f32_bf16 v5, s40, v44
 v_dot2c_f32_bf16 v6, s40, v45
 v_dot2c_f32_bf16 v5, s40, v46
 v_dot2c_f32_bf16 v6, s40, v47
 buffer_load_dwordx4 v[72:75], v1, s[8:11], s24 offen offset:64
 ds_read_b64_tr_b16 v[28:29], v2 offset:3072
 ds_read_b64_tr_b16 v[32:33], v3 offset:3072
 ds_read_b64_tr_b16 v[30:31], v2 offset:3328
 ds_read_b64_tr_b16 v[34:35], v3 offset:3328
 ds_read_b128 v[36:39], v4 offset:96
 s_waitcnt vmcnt(15) lgkmcnt(0)
 v_mfma_f32_32x32x16_bf16 a[0:15], v[28:31], v[76:79], a[0:15]
 v_mfma_f32_32x32x16_bf16 a[16:31], v[76:79], v[32:35], a[16:31]
 v_lshlrev_b32 v40, 16, v76
 v_lshlrev_b32 v41, 16, v36
 v_and_b32 v42, 0xffff0000, v76
 v_and_b32 v43, 0xffff0000, v36
 v_mul_f32 v40, v40, v41
 v_mul_f32 v42, v42, v43
 v_cvt_pk_bf16_f32 v44, v40, v42
 v_lshlrev_b32 v40, 16, v77
 v_lshlrev_b32 v41, 16, v37
 v_and_b32 v42, 0xffff0000, v77
 v_and_b32 v43, 0xffff0000, v37
 v_mul_f32 v40, v40, v41
 v_mul_f32 v42, v42, v43
 v_cvt_pk_bf16_f32 v45, v40, v42
 v_lshlrev_b32 v40, 16, v78
 v_lshlrev_b32 v41, 16, v38
 v_and_b32 v42, 0xffff0000, v78
 v_and_b32 v43, 0xffff0000, v38
 v_mul_f32 v40, v40, v41
 v_mul_f32 v42, v42, v43
 v_cvt_pk_bf16_f32 v46, v40, v42
 v_lshlrev_b32 v40, 16, v79
 v_lshlrev_b32 v41, 16, v39
 v_and_b32 v42, 0xffff0000, v79
 v_and_b32 v43, 0xffff0000, v39
 v_mul_f32 v40, v40, v41
 v_mul_f32 v42, v42, v43
 v_cvt_pk_bf16_f32 v47, v40, v42
 v_dot2c_f32_bf16 v5, s40, v44
 v_dot2c_f32_bf16 v6, s40, v45
 v_dot2c_f32_bf16 v5, s40, v46
 v_dot2c_f32_bf16 v6, s40, v47
 buffer_load_dwordx4 v[76:79], v1, s[8:11], s24 offen offset:96
 ds_read_b64_tr_b16 v[16:17], v2 offset:4096
 ds_read_b64_tr_b16 v[20:21], v3 offset:4096
 ds_read_b64_tr_b16 v[18:19], v2 offset:4352
 ds_read_b64_tr_b16 v[22:23], v3 offset:4352
 ds_read_b128 v[24:27], v4 offset:128
 s_waitcnt vmcnt(15) lgkmcnt(0)
 v_mfma_f32_32x32x16_bf16 a[0:15], v[16:19], v[80:83], a[0:15]
 v_mfma_f32_32x32x16_bf16 a[16:31], v[80:83], v[20:23], a[16:31]
 v_lshlrev_b32 v40, 16, v80
 v_lshlrev_b32 v41, 16, v24
 v_and_b32 v42, 0xffff0000, v80
 v_and_b32 v43, 0xffff0000, v24
 v_mul_f32 v40, v40, v41
 v_mul_f32 v42, v42, v43
 v_cvt_pk_bf16_f32 v44, v40, v42
 v_lshlrev_b32 v40, 16, v81
 v_lshlrev_b32 v41, 16, v25
 v_and_b32 v42, 0xffff0000, v81
 v_and_b32 v43, 0xffff0000, v25
 v_mul_f32 v40, v40, v41
 v_mul_f32 v42, v42, v43
 v_cvt_pk_bf16_f32 v45, v40, v42
 v_lshlrev_b32 v40, 16, v82
 v_lshlrev_b32 v41, 16, v26
 v_and_b32 v42, 0xffff0000, v82
 v_and_b32 v43, 0xffff0000, v26
 v_mul_f32 v40, v40, v41
 v_mul_f32 v42, v42, v43
 v_cvt_pk_bf16_f32 v46, v40, v42
 v_lshlrev_b32 v40, 16, v83
 v_lshlrev_b32 v41, 16, v27
 v_and_b32 v42, 0xffff0000, v83
 v_and_b32 v43, 0xffff0000, v27
 v_mul_f32 v40, v40, v41
 v_mul_f32 v42, v42, v43
 v_cvt_pk_bf16_f32 v47, v40, v42
 v_dot2c_f32_bf16 v5, s40, v44
 v_dot2c_f32_bf16 v6, s40, v45
 v_dot2c_f32_bf16 v5, s40, v46
 v_dot2c_f32_bf16 v6, s40, v47
 buffer_load_dwordx4 v[80:83], v1, s[8:11], s24 offen offset:128
 ds_read_b64_tr_b16 v[28:29], v2 offset:5120
 ds_read_b64_tr_b16 v[32:33], v3 offset:5120
 ds_read_b64_tr_b16 v[30:31], v2 offset:5376
 ds_read_b64_tr_b16 v[34:35], v3 offset:5376
 ds_read_b128 v[36:39], v4 offset:160
 s_waitcnt vmcnt(15) lgkmcnt(0)
 v_mfma_f32_32x32x16_bf16 a[0:15], v[28:31], v[84:87], a[0:15]
 v_mfma_f32_32x32x16_bf16 a[16:31], v[84:87], v[32:35], a[16:31]
 v_lshlrev_b32 v40, 16, v84
 v_lshlrev_b32 v41, 16, v36
 v_and_b32 v42, 0xffff0000, v84
 v_and_b32 v43, 0xffff0000, v36
 v_mul_f32 v40, v40, v41
 v_mul_f32 v42, v42, v43
 v_cvt_pk_bf16_f32 v44, v40, v42
 v_lshlrev_b32 v40, 16, v85
 v_lshlrev_b32 v41, 16, v37
 v_and_b32 v42, 0xffff0000, v85
 v_and_b32 v43, 0xffff0000, v37
 v_mul_f32 v40, v40, v41
 v_mul_f32 v42, v42, v43
 v_cvt_pk_bf16_f32 v45, v40, v42
 v_lshlrev_b32 v40, 16, v86
 v_lshlrev_b32 v41, 16, v38
 v_and_b32 v42, 0xffff0000, v86
 v_and_b32 v43, 0xffff0000, v38
 v_mul_f32 v40, v40, v41
 v_mul_f32 v42, v42, v43
 v_cvt_pk_bf16_f32 v46, v40, v42
 v_lshlrev_b32 v40, 16, v87
 v_lshlrev_b32 v41, 16, v39
 v_and_b32 v42, 0xffff0000, v87
 v_and_b32 v43, 0xffff0000, v39
 v_mul_f32 v40, v40, v41
 v_mul_f32 v42, v42, v43
 v_cvt_pk_bf16_f32 v47, v40, v42
 v_dot2c_f32_bf16 v5, s40, v44
 v_dot2c_f32_bf16 v6, s40, v45
 v_dot2c_f32_bf16 v5, s40, v46
 v_dot2c_f32_bf16 v6, s40, v47
 buffer_load_dwordx4 v[84:87], v1, s[8:11], s24 offen offset:160
 ds_read_b64_tr_b16 v[16:17], v2 offset:6144
 ds_read_b64_tr_b16 v[20:21], v3 offset:6144
 ds_read_b64_tr_b16 v[18:19], v2 offset:6400
 ds_read_b64_tr_b16 v[22:23], v3 offset:6400
 ds_read_b128 v[24:27], v4 offset:192
 s_waitcnt vmcnt(15) lgkmcnt(0)
 v_mfma_f32_32x32x16_bf16 a[0:15], v[16:19], v[88:91], a[0:15]
 v_mfma_f32_32x32x16_bf16 a[16:31], v[88:91], v[20:23], a[16:31]
 v_lshlrev_b32 v40, 16, v88
 v_lshlrev_b32 v41, 16, v24
 v_and_b32 v42, 0xffff0000, v88
 v_and_b32 v43, 0xffff0000, v24
 v_mul_f32 v40, v40, v41
 v_mul_f32 v42, v42, v43
 v_cvt_pk_bf16_f32 v44, v40, v42
 v_lshlrev_b32 v40, 16, v89
 v_lshlrev_b32 v41, 16, v25
 v_and_b32 v42, 0xffff0000, v89
 v_and_b32 v43, 0xffff0000, v25
 v_mul_f32 v40, v40, v41
 v_mul_f32 v42, v42, v43
 v_cvt_pk_bf16_f32 v45, v40, v42
 v_lshlrev_b32 v40, 16, v90
 v_lshlrev_b32 v41, 16, v26
 v_and_b32 v42, 0xffff0000, v90
 v_and_b32 v43, 0xffff0000, v26
 v_mul_f32 v40, v40, v41
 v_mul_f32 v42, v42, v43
 v_cvt_pk_bf16_f32 v46, v40, v42
 v_lshlrev_b32 v40, 16, v91
 v_lshlrev_b32 v41, 16, v27
 v_and_b32 v42, 0xffff0000, v91
 v_and_b32 v43, 0xffff0000, v27
 v_mul_f32 v40, v40, v41
 v_mul_f32 v42, v42, v43
 v_cvt_pk_bf16_f32 v47, v40, v42
 v_dot2c_f32_bf16 v5, s40, v44
 v_dot2c_f32_bf16 v6, s40, v45
 v_dot2c_f32_bf16 v5, s40, v46
 v_dot2c_f32_bf16 v6, s40, v47
 buffer_load_dwordx4 v[88:91], v1, s[8:11], s24 offen offset:192
 ds_read_b64_tr_b16 v[28:29], v2 offset:7168
 ds_read_b64_tr_b16 v[32:33], v3 offset:7168
 ds_read_b64_tr_b16 v[30:31], v2 offset:7424
 ds_read_b64_tr_b16 v[34:35], v3 offset:7424
 ds_read_b128 v[36:39], v4 offset:224
 s_waitcnt vmcnt(15) lgkmcnt(0)
 v_mfma_f32_32x32x16_bf16 a[0:15], v[28:31], v[92:95], a[0:15]
 v_mfma_f32_32x32x16_bf16 a[16:31], v[92:95], v[32:35], a[16:31]
 v_lshlrev_b32 v40, 16, v92
 v_lshlrev_b32 v41, 16, v36
 v_and_b32 v42, 0xffff0000, v92
 v_and_b32 v43, 0xffff0000, v36
 v_mul_f32 v40, v40, v41
 v_mul_f32 v42, v42, v43
 v_cvt_pk_bf16_f32 v44, v40, v42
 v_lshlrev_b32 v40, 16, v93
 v_lshlrev_b32 v41, 16, v37
 v_and_b32 v42, 0xffff0000, v93
 v_and_b32 v43, 0xffff0000, v37
 v_mul_f32 v40, v40, v41
 v_mul_f32 v42, v42, v43
 v_cvt_pk_bf16_f32 v45, v40, v42
 v_lshlrev_b32 v40, 16, v94
 v_lshlrev_b32 v41, 16, v38
 v_and_b32 v42, 0xffff0000, v94
 v_and_b32 v43, 0xffff0000, v38
 v_mul_f32 v40, v40, v41
 v_mul_f32 v42, v42, v43
 v_cvt_pk_bf16_f32 v46, v40, v42
 v_lshlrev_b32 v40, 16, v95
 v_lshlrev_b32 v41, 16, v39
 v_and_b32 v42, 0xffff0000, v95
 v_and_b32 v43, 0xffff0000, v39
 v_mul_f32 v40, v40, v41
 v_mul_f32 v42, v42, v43
 v_cvt_pk_bf16_f32 v47, v40, v42
 v_dot2c_f32_bf16 v5, s40, v44
 v_dot2c_f32_bf16 v6, s40, v45
 v_dot2c_f32_bf16 v5, s40, v46
 v_dot2c_f32_bf16 v6, s40, v47
 buffer_load_dwordx4 v[92:95], v1, s[8:11], s24 offen offset:224
 ds_read_b64_tr_b16 v[16:17], v2 offset:8192
 ds_read_b64_tr_b16 v[20:21], v3 offset:8192
 ds_read_b64_tr_b16 v[18:19], v2 offset:8448
 ds_read_b64_tr_b16 v[22:23], v3 offset:8448
 ds_read_b128 v[24:27], v4 offset:256
 s_waitcnt vmcnt(15) lgkmcnt(0)
 v_mfma_f32_32x32x16_bf16 a[0:15], v[16:19], v[96:99], a[0:15]
 v_mfma_f32_32x32x16_bf16 a[16:31], v[96:99], v[20:23], a[16:31]
 v_lshlrev_b32 v40, 16, v96
 v_lshlrev_b32 v41, 16, v24
 v_and_b32 v42, 0xffff0000, v96
 v_and_b32 v43, 0xffff0000, v24
 v_mul_f32 v40, v40, v41
 v_mul_f32 v42, v42, v43
 v_cvt_pk_bf16_f32 v44, v40, v42
 v_lshlrev_b32 v40, 16, v97
 v_lshlrev_b32 v41, 16, v25
 v_and_b32 v42, 0xffff0000, v97
 v_and_b32 v43, 0xffff0000, v25
 v_mul_f32 v40, v40, v41
 v_mul_f32 v42, v42, v43
 v_cvt_pk_bf16_f32 v45, v40, v42
 v_lshlrev_b32 v40, 16, v98
 v_lshlrev_b32 v41, 16, v26
 v_and_b32 v42, 0xffff0000, v98
 v_and_b32 v43, 0xffff0000, v26
 v_mul_f32 v40, v40, v41
 v_mul_f32 v42, v42, v43
 v_cvt_pk_bf16_f32 v46, v40, v42
 v_lshlrev_b32 v40, 16, v99
 v_lshlrev_b32 v41, 16, v27
 v_and_b32 v42, 0xffff0000, v99
 v_and_b32 v43, 0xffff0000, v27
 v_mul_f32 v40, v40, v41
 v_mul_f32 v42, v42, v43
 v_cvt_pk_bf16_f32 v47, v40, v42
 v_dot2c_f32_bf16 v5, s40, v44
 v_dot2c_f32_bf16 v6, s40, v45
 v_dot2c_f32_bf16 v5, s40, v46
 v_dot2c_f32_bf16 v6, s40, v47
 buffer_load_dwordx4 v[96:99], v1, s[8:11], s24 offen offset:256
 ds_read_b64_tr_b16 v[28:29], v2 offset:9216
 ds_read_b64_tr_b16 v[32:33], v3 offset:9216
 ds_read_b64_tr_b16 v[30:31], v2 offset:9472
 ds_read_b64_tr_b16 v[34:35], v3 offset:9472
 ds_read_b128 v[36:39], v4 offset:288
 s_waitcnt vmcnt(15) lgkmcnt(0)
 v_mfma_f32_32x32x16_bf16 a[0:15], v[28:31], v[100:103], a[0:15]
 v_mfma_f32_32x32x16_bf16 a[16:31], v[100:103], v[32:35], a[16:31]
 v_lshlrev_b32 v40, 16, v100
 v_lshlrev_b32 v41, 16, v36
 v_and_b32 v42, 0xffff0000, v100
 v_and_b32 v43, 0xffff0000, v36
 v_mul_f32 v40, v40, v41
 v_mul_f32 v42, v42, v43
 v_cvt_pk_bf16_f32 v44, v40, v42
 v_lshlrev_b32 v40, 16, v101
 v_lshlrev_b32 v41, 16, v37
 v_and_b32 v42, 0xffff0000, v101
 v_and_b32 v43, 0xffff0000, v37
 v_mul_f32 v40, v40, v41
 v_mul_f32 v42, v42, v43
 v_cvt_pk_bf16_f32 v45, v40, v42
 v_lshlrev_b32 v40, 16, v102
 v_lshlrev_b32 v41, 16, v38
 v_and_b32 v42, 0xffff0000, v102
 v_and_b32 v43, 0xffff0000, v38
 v_mul_f32 v40, v40, v41
 v_mul_f32 v42, v42, v43
 v_cvt_pk_bf16_f32 v46, v40, v42
 v_lshlrev_b32 v40, 16, v103
 v_lshlrev_b32 v41, 16, v39
 v_and_b32 v42, 0xffff0000, v103
 v_and_b32 v43, 0xffff0000, v39
 v_mul_f32 v40, v40, v41
 v_mul_f32 v42, v42, v43
 v_cvt_pk_bf16_f32 v47, v40, v42
 v_dot2c_f32_bf16 v5, s40, v44
 v_dot2c_f32_bf16 v6, s40, v45
 v_dot2c_f32_bf16 v5, s40, v46
 v_dot2c_f32_bf16 v6, s40, v47
 buffer_load_dwordx4 v[100:103], v1, s[8:11], s24 offen offset:288
 ds_read_b64_tr_b16 v[16:17], v2 offset:10240
 ds_read_b64_tr_b16 v[20:21], v3 offset:10240
 ds_read_b64_tr_b16 v[18:19], v2 offset:10496
 ds_read_b64_tr_b16 v[22:23], v3 offset:10496
 ds_read_b128 v[24:27], v4 offset:320
 s_waitcnt vmcnt(15) lgkmcnt(0)
 v_mfma_f32_32x32x16_bf16 a[0:15], v[16:19], v[104:107], a[0:15]
 v_mfma_f32_32x32x16_bf16 a[16:31], v[104:107], v[20:23], a[16:31]
 v_lshlrev_b32 v40, 16, v104
 v_lshlrev_b32 v41, 16, v24
 v_and_b32 v42, 0xffff0000, v104
 v_and_b32 v43, 0xffff0000, v24
 v_mul_f32 v40, v40, v41
 v_mul_f32 v42, v42, v43
 v_cvt_pk_bf16_f32 v44, v40, v42
 v_lshlrev_b32 v40, 16, v105
 v_lshlrev_b32 v41, 16, v25
 v_and_b32 v42, 0xffff0000, v105
 v_and_b32 v43, 0xffff0000, v25
 v_mul_f32 v40, v40, v41
 v_mul_f32 v42, v42, v43
 v_cvt_pk_bf16_f32 v45, v40, v42
 v_lshlrev_b32 v40, 16, v106
 v_lshlrev_b32 v41, 16, v26
 v_and_b32 v42, 0xffff0000, v106
 v_and_b32 v43, 0xffff0000, v26
 v_mul_f32 v40, v40, v41
 v_mul_f32 v42, v42, v43
 v_cvt_pk_bf16_f32 v46, v40, v42
 v_lshlrev_b32 v40, 16, v107
 v_lshlrev_b32 v41, 16, v27
 v_and_b32 v42, 0xffff0000, v107
 v_and_b32 v43, 0xffff0000, v27
 v_mul_f32 v40, v40, v41
 v_mul_f32 v42, v42, v43
 v_cvt_pk_bf16_f32 v47, v40, v42
 v_dot2c_f32_bf16 v5, s40, v44
 v_dot2c_f32_bf16 v6, s40, v45
 v_dot2c_f32_bf16 v5, s40, v46
 v_dot2c_f32_bf16 v6, s40, v47
 buffer_load_dwordx4 v[104:107], v1, s[8:11], s24 offen offset:320
 ds_read_b64_tr_b16 v[28:29], v2 offset:11264
 ds_read_b64_tr_b16 v[32:33], v3 offset:11264
 ds_read_b64_tr_b16 v[30:31], v2 offset:11520
 ds_read_b64_tr_b16 v[34:35], v3 offset:11520
 ds_read_b128 v[36:39], v4 offset:352
 s_waitcnt vmcnt(15) lgkmcnt(0)
 v_mfma_f32_32x32x16_bf16 a[0:15], v[28:31], v[108:111], a[0:15]
 v_mfma_f32_32x32x16_bf16 a[16:31], v[108:111], v[32:35], a[16:31]
 v_lshlrev_b32 v40, 16, v108
 v_lshlrev_b32 v41, 16, v36
 v_and_b32 v42, 0xffff0000, v108
 v_and_b32 v43, 0xffff0000, v36
 v_mul_f32 v40, v40, v41
 v_mul_f32 v42, v42, v43
 v_cvt_pk_bf16_f32 v44, v40, v42
 v_lshlrev_b32 v40, 16, v109
 v_lshlrev_b32 v41, 16, v37
 v_and_b32 v42, 0xffff0000, v109
 v_and_b32 v43, 0xffff0000, v37
 v_mul_f32 v40, v40, v41
 v_mul_f32 v42, v42, v43
 v_cvt_pk_bf16_f32 v45, v40, v42
 v_lshlrev_b32 v40, 16, v110
 v_lshlrev_b32 v41, 16, v38
 v_and_b32 v42, 0xffff0000, v110
 v_and_b32 v43, 0xffff0000, v38
 v_mul_f32 v40, v40, v41
 v_mul_f32 v42, v42, v43
 v_cvt_pk_bf16_f32 v46, v40, v42
 v_lshlrev_b32 v40, 16, v111
 v_lshlrev_b32 v41, 16, v39
 v_and_b32 v42, 0xffff0000, v111
 v_and_b32 v43, 0xffff0000, v39
 v_mul_f32 v40, v40, v41
 v_mul_f32 v42, v42, v43
 v_cvt_pk_bf16_f32 v47, v40, v42
 v_dot2c_f32_bf16 v5, s40, v44
 v_dot2c_f32_bf16 v6, s40, v45
 v_dot2c_f32_bf16 v5, s40, v46
 v_dot2c_f32_bf16 v6, s40, v47
 buffer_load_dwordx4 v[108:111], v1, s[8:11], s24 offen offset:352
 ds_read_b64_tr_b16 v[16:17], v2 offset:12288
 ds_read_b64_tr_b16 v[20:21], v3 offset:12288
 ds_read_b64_tr_b16 v[18:19], v2 offset:12544
 ds_read_b64_tr_b16 v[22:23], v3 offset:12544
 ds_read_b128 v[24:27], v4 offset:384
 s_waitcnt vmcnt(15) lgkmcnt(0)
 v_mfma_f32_32x32x16_bf16 a[0:15], v[16:19], v[112:115], a[0:15]
 v_mfma_f32_32x32x16_bf16 a[16:31], v[112:115], v[20:23], a[16:31]
 v_lshlrev_b32 v40, 16, v112
 v_lshlrev_b32 v41, 16, v24
 v_and_b32 v42, 0xffff0000, v112
 v_and_b32 v43, 0xffff0000, v24
 v_mul_f32 v40, v40, v41
 v_mul_f32 v42, v42, v43
 v_cvt_pk_bf16_f32 v44, v40, v42
 v_lshlrev_b32 v40, 16, v113
 v_lshlrev_b32 v41, 16, v25
 v_and_b32 v42, 0xffff0000, v113
 v_and_b32 v43, 0xffff0000, v25
 v_mul_f32 v40, v40, v41
 v_mul_f32 v42, v42, v43
 v_cvt_pk_bf16_f32 v45, v40, v42
 v_lshlrev_b32 v40, 16, v114
 v_lshlrev_b32 v41, 16, v26
 v_and_b32 v42, 0xffff0000, v114
 v_and_b32 v43, 0xffff0000, v26
 v_mul_f32 v40, v40, v41
 v_mul_f32 v42, v42, v43
 v_cvt_pk_bf16_f32 v46, v40, v42
 v_lshlrev_b32 v40, 16, v115
 v_lshlrev_b32 v41, 16, v27
 v_and_b32 v42, 0xffff0000, v115
 v_and_b32 v43, 0xffff0000, v27
 v_mul_f32 v40, v40, v41
 v_mul_f32 v42, v42, v43
 v_cvt_pk_bf16_f32 v47, v40, v42
 v_dot2c_f32_bf16 v5, s40, v44
 v_dot2c_f32_bf16 v6, s40, v45
 v_dot2c_f32_bf16 v5, s40, v46
 v_dot2c_f32_bf16 v6, s40, v47
 buffer_load_dwordx4 v[112:115], v1, s[8:11], s24 offen offset:384
 ds_read_b64_tr_b16 v[28:29], v2 offset:13312
 ds_read_b64_tr_b16 v[32:33], v3 offset:13312
 ds_read_b64_tr_b16 v[30:31], v2 offset:13568
 ds_read_b64_tr_b16 v[34:35], v3 offset:13568
 ds_read_b128 v[36:39], v4 offset:416
 s_waitcnt vmcnt(15) lgkmcnt(0)
 v_mfma_f32_32x32x16_bf16 a[0:15], v[28:31], v[116:119], a[0:15]
 v_mfma_f32_32x32x16_bf16 a[16:31], v[116:119], v[32:35], a[16:31]
 v_lshlrev_b32 v40, 16, v116
 v_lshlrev_b32 v41, 16, v36
 v_and_b32 v42, 0xffff0000, v116
 v_and_b32 v43, 0xffff0000, v36
 v_mul_f32 v40, v40, v41
 v_mul_f32 v42, v42, v43
 v_cvt_pk_bf16_f32 v44, v40, v42
 v_lshlrev_b32 v40, 16, v117
 v_lshlrev_b32 v41, 16, v37
 v_and_b32 v42, 0xffff0000, v117
 v_and_b32 v43, 0xffff0000, v37
 v_mul_f32 v40, v40, v41
 v_mul_f32 v42, v42, v43
 v_cvt_pk_bf16_f32 v45, v40, v42
 v_lshlrev_b32 v40, 16, v118
 v_lshlrev_b32 v41, 16, v38
 v_and_b32 v42, 0xffff0000, v118
 v_and_b32 v43, 0xffff0000, v38
 v_mul_f32 v40, v40, v41
 v_mul_f32 v42, v42, v43
 v_cvt_pk_bf16_f32 v46, v40, v42
 v_lshlrev_b32 v40, 16, v119
 v_lshlrev_b32 v41, 16, v39
 v_and_b32 v42, 0xffff0000, v119
 v_and_b32 v43, 0xffff0000, v39
 v_mul_f32 v40, v40, v41
 v_mul_f32 v42, v42, v43
 v_cvt_pk_bf16_f32 v47, v40, v42
 v_dot2c_f32_bf16 v5, s40, v44
 v_dot2c_f32_bf16 v6, s40, v45
 v_dot2c_f32_bf16 v5, s40, v46
 v_dot2c_f32_bf16 v6, s40, v47
 buffer_load_dwordx4 v[116:119], v1, s[8:11], s24 offen offset:416
 ds_read_b64_tr_b16 v[16:17], v2 offset:14336
 ds_read_b64_tr_b16 v[20:21], v3 offset:14336
 ds_read_b64_tr_b16 v[18:19], v2 offset:14592
 ds_read_b64_tr_b16 v[22:23], v3 offset:14592
 ds_read_b128 v[24:27], v4 offset:448
 s_waitcnt vmcnt(15) lgkmcnt(0)
 v_mfma_f32_32x32x16_bf16 a[0:15], v[16:19], v[120:123], a[0:15]
 v_mfma_f32_32x32x16_bf16 a[16:31], v[120:123], v[20:23], a[16:31]
 v_lshlrev_b32 v40, 16, v120
 v_lshlrev_b32 v41, 16, v24
 v_and_b32 v42, 0xffff0000, v120
 v_and_b32 v43, 0xffff0000, v24
 v_mul_f32 v40, v40, v41
 v_mul_f32 v42, v42, v43
 v_cvt_pk_bf16_f32 v44, v40, v42
 v_lshlrev_b32 v40, 16, v121
 v_lshlrev_b32 v41, 16, v25
 v_and_b32 v42, 0xffff0000, v121
 v_and_b32 v43, 0xffff0000, v25
 v_mul_f32 v40, v40, v41
 v_mul_f32 v42, v42, v43
 v_cvt_pk_bf16_f32 v45, v40, v42
 v_lshlrev_b32 v40, 16, v122
 v_lshlrev_b32 v41, 16, v26
 v_and_b32 v42, 0xffff0000, v122
 v_and_b32 v43, 0xffff0000, v26
 v_mul_f32 v40, v40, v41
 v_mul_f32 v42, v42, v43
 v_cvt_pk_bf16_f32 v46, v40, v42
 v_lshlrev_b32 v40, 16, v123
 v_lshlrev_b32 v41, 16, v27
 v_and_b32 v42, 0xffff0000, v123
 v_and_b32 v43, 0xffff0000, v27
 v_mul_f32 v40, v40, v41
 v_mul_f32 v42, v42, v43
 v_cvt_pk_bf16_f32 v47, v40, v42
 v_dot2c_f32_bf16 v5, s40, v44
 v_dot2c_f32_bf16 v6, s40, v45
 v_dot2c_f32_bf16 v5, s40, v46
 v_dot2c_f32_bf16 v6, s40, v47
 buffer_load_dwordx4 v[120:123], v1, s[8:11], s24 offen offset:448
 ds_read_b64_tr_b16 v[28:29], v2 offset:15360
 ds_read_b64_tr_b16 v[32:33], v3 offset:15360
 ds_read_b64_tr_b16 v[30:31], v2 offset:15616
 ds_read_b64_tr_b16 v[34:35], v3 offset:15616
 ds_read_b128 v[36:39], v4 offset:480
 s_waitcnt vmcnt(15) lgkmcnt(0)
 v_mfma_f32_32x32x16_bf16 a[0:15], v[28:31], v[124:127], a[0:15]
 v_mfma_f32_32x32x16_bf16 a[16:31], v[124:127], v[32:35], a[16:31]
 v_lshlrev_b32 v40, 16, v124
 v_lshlrev_b32 v41, 16, v36
 v_and_b32 v42, 0xffff0000, v124
 v_and_b32 v43, 0xffff0000, v36
 v_mul_f32 v40, v40, v41
 v_mul_f32 v42, v42, v43
 v_cvt_pk_bf16_f32 v44, v40, v42
 v_lshlrev_b32 v40, 16, v125
 v_lshlrev_b32 v41, 16, v37
 v_and_b32 v42, 0xffff0000, v125
 v_and_b32 v43, 0xffff0000, v37
 v_mul_f32 v40, v40, v41
 v_mul_f32 v42, v42, v43
 v_cvt_pk_bf16_f32 v45, v40, v42
 v_lshlrev_b32 v40, 16, v126
 v_lshlrev_b32 v41, 16, v38
 v_and_b32 v42, 0xffff0000, v126
 v_and_b32 v43, 0xffff0000, v38
 v_mul_f32 v40, v40, v41
 v_mul_f32 v42, v42, v43
 v_cvt_pk_bf16_f32 v46, v40, v42
 v_lshlrev_b32 v40, 16, v127
 v_lshlrev_b32 v41, 16, v39
 v_and_b32 v42, 0xffff0000, v127
 v_and_b32 v43, 0xffff0000, v39
 v_mul_f32 v40, v40, v41
 v_mul_f32 v42, v42, v43
 v_cvt_pk_bf16_f32 v47, v40, v42
 v_dot2c_f32_bf16 v5, s40, v44
 v_dot2c_f32_bf16 v6, s40, v45
 v_dot2c_f32_bf16 v5, s40, v46
 v_dot2c_f32_bf16 v6, s40, v47
 buffer_load_dwordx4 v[124:127], v1, s[8:11], s24 offen offset:480
 v_add_u32 v2, 16384, v2
 v_add_u32 v3, 16384, v3
 v_add_u32 v4, 512, v4
 s_add_u32 s29, s29, 1
 s_cmp_lt_u32 s29, 4
 s_cbranch_scc1 L_akvl
 s_waitcnt vmcnt(0)
 s_mov_b32 s35, 1048744942
 s_lshl_b32 s27, s34, 12
 s_add_u32 s27, s27, 104857600
 v_accvgpr_read_b32 v64, a0
 v_accvgpr_read_b32 v65, a1
 v_accvgpr_read_b32 v66, a2
 v_accvgpr_read_b32 v67, a3
 v_accvgpr_read_b32 v68, a4
 v_accvgpr_read_b32 v69, a5
 v_accvgpr_read_b32 v70, a6
 v_accvgpr_read_b32 v71, a7
 v_accvgpr_read_b32 v72, a8
 v_accvgpr_read_b32 v73, a9
 v_accvgpr_read_b32 v74, a10
 v_accvgpr_read_b32 v75, a11
 v_accvgpr_read_b32 v76, a12
 v_accvgpr_read_b32 v77, a13
 v_accvgpr_read_b32 v78, a14
 v_accvgpr_read_b32 v79, a15
 v_accvgpr_read_b32 v80, a16
 v_accvgpr_read_b32 v81, a17
 v_accvgpr_read_b32 v82, a18
 v_accvgpr_read_b32 v83, a19
 v_accvgpr_read_b32 v84, a20
 v_accvgpr_read_b32 v85, a21
 v_accvgpr_read_b32 v86, a22
 v_accvgpr_read_b32 v87, a23
 v_accvgpr_read_b32 v88, a24
 v_accvgpr_read_b32 v89, a25
 v_accvgpr_read_b32 v90, a26
 v_accvgpr_read_b32 v91, a27
 v_accvgpr_read_b32 v92, a28
 v_accvgpr_read_b32 v93, a29
 v_accvgpr_read_b32 v94, a30
 v_accvgpr_read_b32 v95, a31
 v_mul_f32 v64, s35, v64
 v_mul_f32 v65, s35, v65
 v_mul_f32 v66, s35, v66
 v_mul_f32 v67, s35, v67
 v_mul_f32 v68, s35, v68
 v_mul_f32 v69, s35, v69
 v_mul_f32 v70, s35, v70
 v_mul_f32 v71, s35, v71
 v_mul_f32 v72, s35, v72
 v_mul_f32 v73, s35, v73
 v_mul_f32 v74, s35, v74
 v_mul_f32 v75, s35, v75
 v_mul_f32 v76, s35, v76
 v_mul_f32 v77, s35, v77
 v_mul_f32 v78, s35, v78
 v_mul_f32 v79, s35, v79
 v_cvt_pk_bf16_f32 v96, v64, v65
 v_cvt_pk_bf16_f32 v97, v66, v67
 v_cvt_pk_bf16_f32 v98, v68, v69
 v_cvt_pk_bf16_f32 v99, v70, v71
 v_cvt_pk_bf16_f32 v100, v72, v73
 v_cvt_pk_bf16_f32 v101, v74, v75
 v_cvt_pk_bf16_f32 v102, v76, v77
 v_cvt_pk_bf16_f32 v103, v78, v79
 v_cvt_pk_bf16_f32 v104, v80, v81
 v_cvt_pk_bf16_f32 v105, v82, v83
 v_cvt_pk_bf16_f32 v106, v84, v85
 v_cvt_pk_bf16_f32 v107, v86, v87
 v_cvt_pk_bf16_f32 v108, v88, v89
 v_cvt_pk_bf16_f32 v109, v90, v91
 v_cvt_pk_bf16_f32 v110, v92, v93
 v_cvt_pk_bf16_f32 v111, v94, v95
 v_permlane32_swap_b32 v96, v98
 v_permlane32_swap_b32 v97, v99
 v_permlane32_swap_b32 v100, v102
 v_permlane32_swap_b32 v101, v103
 v_permlane32_swap_b32 v104, v106
 v_permlane32_swap_b32 v105, v107
 v_permlane32_swap_b32 v108, v110
 v_permlane32_swap_b32 v109, v111
 buffer_store_dwordx4 v[96:99], v15, s[4:7], s27 offen offset:0 sc1
 buffer_store_dwordx4 v[100:103], v15, s[4:7], s27 offen offset:1024 sc1
 buffer_store_dwordx4 v[104:107], v15, s[4:7], s27 offen offset:2048 sc1
 buffer_store_dwordx4 v[108:111], v15, s[4:7], s27 offen offset:3072 sc1
 v_add_f32 v5, v5, v6
 v_mov_b32 v6, v5
 s_nop 1
 v_permlane32_swap_b32 v5, v6
 v_add_f32 v5, v5, v6
 v_cvt_pk_bf16_f32 v5, v5, v5
 v_lshlrev_b32 v5, 16, v5
 v_mul_f32 v5, 3216550459, v5
 v_exp_f32 v5, v5
 s_nop 0
 v_add_f32 v5, 1.0, v5
 v_rcp_f32 v5, v5
 s_nop 0
 v_cvt_pk_bf16_f32 v5, v5, v5
 v_lshlrev_b32 v8, 16, v5
 v_sub_f32 v9, 1.0, v8
 v_cvt_pk_bf16_f32 v9, v9, v9
 v_lshlrev_b32 v9, 16, v9
 v_lshlrev_b32 v7, 3, v0
 s_lshl_b32 s27, s34, 8
 s_add_u32 s27, s27, 105381888
 s_mov_b32 exec_hi, 0
 buffer_store_dwordx2 v[8:9], v7, s[4:7], s27 offen sc1
 s_mov_b64 exec, -1
 s_mov_b32 s36, 2244608
 s_branch L_next
L_attA:
 s_lshl_b32 s33, s25, 4
 s_add_u32 s33, s33, 2301952
 s_add_u32 s34, s24, 1
 v_lshl_add_u32 v2, v0, 2, s33
 v_mov_b32 v3, s34
 s_mov_b32 s33, 2244608
 v_writelane_b32 v2, s33, 4
 v_writelane_b32 v3, 8, 4
 s_cmp_lg_u32 s14, 0
 s_cbranch_scc1 L_wf2A
 s_mov_b64 exec, 31
L_wfA:
 buffer_load_dword v1, v2, s[4:7], 0 offen sc1
 s_waitcnt vmcnt(0)
 v_cmp_lt_u32 vcc, v1, v3
 s_cbranch_vccz L_wf1A
 s_add_u32 s61, s61, 1
 s_cmp_gt_u32 s61, 2000000
 s_cbranch_scc1 L_wf1A
 s_sleep 4
 s_branch L_wfA
L_wf1A:
 s_mov_b64 exec, -1
L_wf2A:
 s_barrier
 v_lshlrev_b32 v15, 4, v0
 s_lshl_b32 s26, s25, 3
 s_add_u32 s26, s26, s14
 s_lshl_b32 s33, s24, 16
 s_lshl_b32 s34, s26, 12
 s_add_u32 s33, s33, s34
 s_add_u32 s33, s33, 100663296
 s_lshl_b32 s30, s14, 12
 s_mov_b32 s38, 0
 v_and_b32 v4, 31, v0
 v_lshlrev_b32 v4, 3, v4
 s_lshl_b32 s34, s24, 8
 s_add_u32 s34, s34, 105381888
 buffer_load_dword v5, v4, s[4:7], s34 offen sc1
 buffer_load_dwordx4 a[64:67], v15, s[4:7], s33 offen offset:0 sc1
 buffer_load_dwordx4 a[68:71], v15, s[4:7], s33 offen offset:1024 sc1
 buffer_load_dwordx4 a[72:75], v15, s[4:7], s33 offen offset:2048 sc1
 buffer_load_dwordx4 a[76:79], v15, s[4:7], s33 offen offset:3072 sc1
 v_mov_b32 v6, 0x3f803f80
 v_and_b32 v7, 4, v0
 v_cmp_eq_u32 vcc, 0, v7
 s_nop 1
 v_cndmask_b32 v7, 0, v6, vcc
 v_xor_b32 v8, v6, v7
 v_mov_b32 v6, 0xdddd
 v_accvgpr_write_b32 a80, v7
 v_accvgpr_write_b32 a81, v7
 v_accvgpr_write_b32 a82, v8
 v_accvgpr_write_b32 a83, v8
L_amain:
 s_mov_b32 s31, 0
 s_and_b32 s33, s31, 0x1ffff
 s_add_u32 m0, s33, s30
 s_add_u32 s33, s31, s30
 s_add_u32 s33, s33, 104857600
 s_add_u32 s31, s31, 32768
 buffer_load_dwordx4 v15, s[4:7], s33 offen offset:0 sc1 lds
 buffer_load_dwordx4 v15, s[4:7], s33 offen offset:1024 sc1 lds
 buffer_load_dwordx4 v15, s[4:7], s33 offen offset:2048 sc1 lds
 buffer_load_dwordx4 v15, s[4:7], s33 offen offset:3072 sc1 lds
 s_and_b32 s33, s31, 0x1ffff
 s_add_u32 m0, s33, s30
 s_add_u32 s33, s31, s30
 s_add_u32 s33, s33, 104857600
 s_add_u32 s31, s31, 32768
 buffer_load_dwordx4 v15, s[4:7], s33 offen offset:0 sc1 lds
 buffer_load_dwordx4 v15, s[4:7], s33 offen offset:1024 sc1 lds
 buffer_load_dwordx4 v15, s[4:7], s33 offen offset:2048 sc1 lds
 buffer_load_dwordx4 v15, s[4:7], s33 offen offset:3072 sc1 lds
 s_and_b32 s33, s31, 0x1ffff
 s_add_u32 m0, s33, s30
 s_add_u32 s33, s31, s30
 s_add_u32 s33, s33, 104857600
 s_add_u32 s31, s31, 32768
 buffer_load_dwordx4 v15, s[4:7], s33 offen offset:0 sc1 lds
 buffer_load_dwordx4 v15, s[4:7], s33 offen offset:1024 sc1 lds
 buffer_load_dwordx4 v15, s[4:7], s33 offen offset:2048 sc1 lds
 buffer_load_dwordx4 v15, s[4:7], s33 offen offset:3072 sc1 lds
 s_mov_b32 s29, 0
 v_mov_b32 v1, v15
 v_accvgpr_write_b32 a0, 0
 v_accvgpr_write_b32 a1, 0
 v_accvgpr_write_b32 a2, 0
 v_accvgpr_write_b32 a3, 0
 v_accvgpr_write_b32 a4, 0
 v_accvgpr_write_b32 a5, 0
 v_accvgpr_write_b32 a6, 0
 v_accvgpr_write_b32 a7, 0
 v_accvgpr_write_b32 a8, 0
 v_accvgpr_write_b32 a9, 0
 v_accvgpr_write_b32 a10, 0
 v_accvgpr_write_b32 a11, 0
 v_accvgpr_write_b32 a12, 0
 v_accvgpr_write_b32 a13, 0
 v_accvgpr_write_b32 a14, 0
 v_accvgpr_write_b32 a15, 0
 v_accvgpr_write_b32 a16, 0
 v_accvgpr_write_b32 a17, 0
 v_accvgpr_write_b32 a18, 0
 v_accvgpr_write_b32 a19, 0
 v_accvgpr_write_b32 a20, 0
 v_accvgpr_write_b32 a21, 0
 v_accvgpr_write_b32 a22, 0
 v_accvgpr_write_b32 a23, 0
 v_accvgpr_write_b32 a24, 0
 v_accvgpr_write_b32 a25, 0
 v_accvgpr_write_b32 a26, 0
 v_accvgpr_write_b32 a27, 0
 v_accvgpr_write_b32 a28, 0
 v_accvgpr_write_b32 a29, 0
 v_accvgpr_write_b32 a30, 0
 v_accvgpr_write_b32 a31, 0
 v_accvgpr_write_b32 a32, 0
 v_accvgpr_write_b32 a33, 0
 v_accvgpr_write_b32 a34, 0
 v_accvgpr_write_b32 a35, 0
 v_accvgpr_write_b32 a36, 0
 v_accvgpr_write_b32 a37, 0
 v_accvgpr_write_b32 a38, 0
 v_accvgpr_write_b32 a39, 0
 v_mov_b64 v[64:65], 0
 v_accvgpr_write_b32 a112, 0
 v_mov_b64 v[66:67], 0
 v_accvgpr_write_b32 a113, 0
 v_mov_b64 v[68:69], 0
 v_accvgpr_write_b32 a114, 0
 v_mov_b64 v[70:71], 0
 v_accvgpr_write_b32 a115, 0
 v_mov_b64 v[72:73], 0
 v_accvgpr_write_b32 a116, 0
 v_mov_b64 v[74:75], 0
 v_accvgpr_write_b32 a117, 0
 v_mov_b64 v[76:77], 0
 v_accvgpr_write_b32 a118, 0
 v_mov_b64 v[78:79], 0
 v_accvgpr_write_b32 a119, 0
 s_waitcnt vmcnt(8)
 s_barrier
 ds_read_b128 a[88:91], v1
 ds_read_b128 a[92:95], v1 offset:1024
 s_waitcnt lgkmcnt(0)
 s_cmp_lg_u32 s38, 0
 s_cbranch_scc1 L_am1
 v_mfma_f32_32x32x16_bf16 v[16:31], a[88:91], a[64:67], 0
 v_mfma_f32_32x32x16_bf16 v[32:47], a[88:91], a[72:75], 0
 v_mfma_f32_32x32x16_bf16 v[16:31], a[92:95], a[68:71], v[16:31]
 v_mfma_f32_32x32x16_bf16 v[32:47], a[92:95], a[76:79], v[32:47]
 s_nop 3
 v_max3_f32 v7, v16, v17, v17
 v_max3_f32 v7, v18, v19, v7
 v_max3_f32 v7, v20, v21, v7
 v_max3_f32 v7, v22, v23, v7
 v_max3_f32 v7, v24, v25, v7
 v_max3_f32 v7, v26, v27, v7
 v_max3_f32 v7, v28, v29, v7
 v_max3_f32 v7, v30, v31, v7
 v_max3_f32 v8, v32, v33, v33
 v_max3_f32 v8, v34, v35, v8
 v_max3_f32 v8, v36, v37, v8
 v_max3_f32 v8, v38, v39, v8
 v_max3_f32 v8, v40, v41, v8
 v_max3_f32 v8, v42, v43, v8
 v_max3_f32 v8, v44, v45, v8
 v_max3_f32 v8, v46, v47, v8
 v_mov_b32 v9, v7
 s_nop 1
 v_permlane32_swap_b32 v7, v9
 v_max_f32 v7, v7, v9
 v_sub_f32 v96, 0, v7
 v_sub_f32 v97, 0, v7
 v_sub_f32 v98, 0, v7
 v_sub_f32 v99, 0, v7
 v_sub_f32 v100, 0, v7
 v_sub_f32 v101, 0, v7
 v_sub_f32 v102, 0, v7
 v_sub_f32 v103, 0, v7
 v_sub_f32 v104, 0, v7
 v_sub_f32 v105, 0, v7
 v_sub_f32 v106, 0, v7
 v_sub_f32 v107, 0, v7
 v_sub_f32 v108, 0, v7
 v_sub_f32 v109, 0, v7
 v_sub_f32 v110, 0, v7
 v_sub_f32 v111, 0, v7
 v_mov_b32 v9, v8
 s_nop 1
 v_permlane32_swap_b32 v8, v9
 v_max_f32 v8, v8, v9
 v_sub_f32 v112, 0, v8
 v_sub_f32 v113, 0, v8
 v_sub_f32 v114, 0, v8
 v_sub_f32 v115, 0, v8
 v_sub_f32 v116, 0, v8
 v_sub_f32 v117, 0, v8
 v_sub_f32 v118, 0, v8
 v_sub_f32 v119, 0, v8
 v_sub_f32 v120, 0, v8
 v_sub_f32 v121, 0, v8
 v_sub_f32 v122, 0, v8
 v_sub_f32 v123, 0, v8
 v_sub_f32 v124, 0, v8
 v_sub_f32 v125, 0, v8
 v_sub_f32 v126, 0, v8
 v_sub_f32 v127, 0, v8
L_am1:
 v_mfma_f32_32x32x16_bf16 v[16:31], a[88:91], a[64:67], v[96:111]
 v_mfma_f32_32x32x16_bf16 v[16:31], a[92:95], a[68:71], v[16:31]
L_aloop:
 s_cmp_ge_u32 s31, 0x40000
 s_cbranch_scc1 L_ac1m
 s_waitcnt vmcnt(4) lgkmcnt(0)
 s_barrier
 s_and_b32 s33, s31, 0x1ffff
 s_add_u32 m0, s33, s30
 s_add_u32 s33, s31, s30
 s_add_u32 s33, s33, 104857600
 s_add_u32 s31, s31, 32768
 buffer_load_dwordx4 v15, s[4:7], s33 offen offset:0 sc1 lds
 buffer_load_dwordx4 v15, s[4:7], s33 offen offset:1024 sc1 lds
 buffer_load_dwordx4 v15, s[4:7], s33 offen offset:2048 sc1 lds
 buffer_load_dwordx4 v15, s[4:7], s33 offen offset:3072 sc1 lds
 s_branch L_ac2m
L_ac1m:
 s_waitcnt vmcnt(0) lgkmcnt(0)
 s_barrier
L_ac2m:
 v_mfma_f32_32x32x16_bf16 v[32:47], a[88:91], a[72:75], v[112:127]
 s_nop 3
 v_exp_f32 v48, v16
 v_exp_f32 v49, v17
 v_exp_f32 v50, v18
 ds_read_b128 a[104:107], v1 offset:2048
 ds_read_b128 a[108:111], v1 offset:3072
 ds_read_b128 a[96:99], v1 offset:4096
 ds_read_b128 a[100:103], v1 offset:5120
 v_mfma_f32_32x32x16_bf16 v[32:47], a[92:95], a[76:79], v[32:47]
 v_exp_f32 v51, v19
 v_exp_f32 v52, v20
 v_exp_f32 v53, v21
 v_smfmac_f32_32x32x32_bf16 a[16:31], a[112:115], v[64:71], v6
 v_exp_f32 v54, v22
 v_exp_f32 v55, v23
 v_exp_f32 v56, v24
 v_smfmac_f32_16x16x64_bf16 a[36:39], a[80:83], v[64:71], v6
 v_exp_f32 v57, v25
 v_exp_f32 v58, v26
 v_smfmac_f32_32x32x32_bf16 a[16:31], a[116:119], v[72:79], v6
 v_exp_f32 v59, v27
 v_exp_f32 v60, v28
 v_exp_f32 v61, v29
 v_smfmac_f32_16x16x64_bf16 a[36:39], a[80:83], v[72:79], v6
 v_exp_f32 v62, v30
 v_exp_f32 v63, v31
 s_waitcnt lgkmcnt(0)
 v_mfma_f32_32x32x16_bf16 v[16:31], a[96:99], a[64:67], v[96:111]
 v_exp_f32 v64, v32
 v_exp_f32 v65, v33
 v_exp_f32 v66, v34
 v_mfma_f32_32x32x16_bf16 v[16:31], a[100:103], a[68:71], v[16:31]
 v_exp_f32 v67, v35
 v_exp_f32 v68, v36
 v_exp_f32 v69, v37
 v_smfmac_f32_32x32x32_bf16 a[0:15], a[104:107], v[48:55], v6
 v_exp_f32 v70, v38
 v_exp_f32 v71, v39
 v_exp_f32 v72, v40
 v_smfmac_f32_16x16x64_bf16 a[32:35], a[80:83], v[48:55], v6
 v_exp_f32 v73, v41
 v_exp_f32 v74, v42
 v_smfmac_f32_32x32x32_bf16 a[0:15], a[108:111], v[56:63], v6
 v_exp_f32 v75, v43
 v_exp_f32 v76, v44
 v_exp_f32 v77, v45
 v_smfmac_f32_16x16x64_bf16 a[32:35], a[80:83], v[56:63], v6
 v_exp_f32 v78, v46
 v_exp_f32 v79, v47
 v_mfma_f32_32x32x16_bf16 v[32:47], a[96:99], a[72:75], v[112:127]
 v_exp_f32 v48, v16
 v_exp_f32 v49, v17
 v_exp_f32 v50, v18
 ds_read_b128 a[112:115], v1 offset:6144
 ds_read_b128 a[116:119], v1 offset:7168
 ds_read_b128 a[88:91], v1 offset:8192
 ds_read_b128 a[92:95], v1 offset:9216
 v_mfma_f32_32x32x16_bf16 v[32:47], a[100:103], a[76:79], v[32:47]
 v_exp_f32 v51, v19
 v_exp_f32 v52, v20
 v_exp_f32 v53, v21
 v_smfmac_f32_32x32x32_bf16 a[16:31], a[104:107], v[64:71], v6
 v_exp_f32 v54, v22
 v_exp_f32 v55, v23
 v_exp_f32 v56, v24
 v_smfmac_f32_16x16x64_bf16 a[36:39], a[80:83], v[64:71], v6
 v_exp_f32 v57, v25
 v_exp_f32 v58, v26
 v_smfmac_f32_32x32x32_bf16 a[16:31], a[108:111], v[72:79], v6
 v_exp_f32 v59, v27
 v_exp_f32 v60, v28
 v_exp_f32 v61, v29
 v_smfmac_f32_16x16x64_bf16 a[36:39], a[80:83], v[72:79], v6
 v_exp_f32 v62, v30
 v_exp_f32 v63, v31
 s_waitcnt lgkmcnt(0)
 v_mfma_f32_32x32x16_bf16 v[16:31], a[88:91], a[64:67], v[96:111]
 v_exp_f32 v64, v32
 v_exp_f32 v65, v33
 v_exp_f32 v66, v34
 v_mfma_f32_32x32x16_bf16 v[16:31], a[92:95], a[68:71], v[16:31]
 v_exp_f32 v67, v35
 v_exp_f32 v68, v36
 v_exp_f32 v69, v37
 v_smfmac_f32_32x32x32_bf16 a[0:15], a[112:115], v[48:55], v6
 v_exp_f32 v70, v38
 v_exp_f32 v71, v39
 v_exp_f32 v72, v40
 v_smfmac_f32_16x16x64_bf16 a[32:35], a[80:83], v[48:55], v6
 v_exp_f32 v73, v41
 v_exp_f32 v74, v42
 v_smfmac_f32_32x32x32_bf16 a[0:15], a[116:119], v[56:63], v6
 v_exp_f32 v75, v43
 v_exp_f32 v76, v44
 v_exp_f32 v77, v45
 v_smfmac_f32_16x16x64_bf16 a[32:35], a[80:83], v[56:63], v6
 v_exp_f32 v78, v46
 v_exp_f32 v79, v47
 v_mfma_f32_32x32x16_bf16 v[32:47], a[88:91], a[72:75], v[112:127]
 v_exp_f32 v48, v16
 v_exp_f32 v49, v17
 v_exp_f32 v50, v18
 ds_read_b128 a[104:107], v1 offset:10240
 ds_read_b128 a[108:111], v1 offset:11264
 ds_read_b128 a[96:99], v1 offset:12288
 ds_read_b128 a[100:103], v1 offset:13312
 v_mfma_f32_32x32x16_bf16 v[32:47], a[92:95], a[76:79], v[32:47]
 v_exp_f32 v51, v19
 v_exp_f32 v52, v20
 v_exp_f32 v53, v21
 v_smfmac_f32_32x32x32_bf16 a[16:31], a[112:115], v[64:71], v6
 v_exp_f32 v54, v22
 v_exp_f32 v55, v23
 v_exp_f32 v56, v24
 v_smfmac_f32_16x16x64_bf16 a[36:39], a[80:83], v[64:71], v6
 v_exp_f32 v57, v25
 v_exp_f32 v58, v26
 v_smfmac_f32_32x32x32_bf16 a[16:31], a[116:119], v[72:79], v6
 v_exp_f32 v59, v27
 v_exp_f32 v60, v28
 v_exp_f32 v61, v29
 v_smfmac_f32_16x16x64_bf16 a[36:39], a[80:83], v[72:79], v6
 v_exp_f32 v62, v30
 v_exp_f32 v63, v31
 s_waitcnt lgkmcnt(0)
 v_mfma_f32_32x32x16_bf16 v[16:31], a[96:99], a[64:67], v[96:111]
 v_exp_f32 v64, v32
 v_exp_f32 v65, v33
 v_exp_f32 v66, v34
 v_mfma_f32_32x32x16_bf16 v[16:31], a[100:103], a[68:71], v[16:31]
 v_exp_f32 v67, v35
 v_exp_f32 v68, v36
 v_exp_f32 v69, v37
 v_smfmac_f32_32x32x32_bf16 a[0:15], a[104:107], v[48:55], v6
 v_exp_f32 v70, v38
 v_exp_f32 v71, v39
 v_exp_f32 v72, v40
 v_smfmac_f32_16x16x64_bf16 a[32:35], a[80:83], v[48:55], v6
 v_exp_f32 v73, v41
 v_exp_f32 v74, v42
 v_smfmac_f32_32x32x32_bf16 a[0:15], a[108:111], v[56:63], v6
 v_exp_f32 v75, v43
 v_exp_f32 v76, v44
 v_exp_f32 v77, v45
 v_smfmac_f32_16x16x64_bf16 a[32:35], a[80:83], v[56:63], v6
 v_exp_f32 v78, v46
 v_exp_f32 v79, v47
 v_mfma_f32_32x32x16_bf16 v[32:47], a[96:99], a[72:75], v[112:127]
 v_exp_f32 v48, v16
 v_exp_f32 v49, v17
 v_exp_f32 v50, v18
 ds_read_b128 a[112:115], v1 offset:14336
 ds_read_b128 a[116:119], v1 offset:15360
 ds_read_b128 a[88:91], v1 offset:16384
 ds_read_b128 a[92:95], v1 offset:17408
 v_mfma_f32_32x32x16_bf16 v[32:47], a[100:103], a[76:79], v[32:47]
 v_exp_f32 v51, v19
 v_exp_f32 v52, v20
 v_exp_f32 v53, v21
 v_smfmac_f32_32x32x32_bf16 a[16:31], a[104:107], v[64:71], v6
 v_exp_f32 v54, v22
 v_exp_f32 v55, v23
 v_exp_f32 v56, v24
 v_smfmac_f32_16x16x64_bf16 a[36:39], a[80:83], v[64:71], v6
 v_exp_f32 v57, v25
 v_exp_f32 v58, v26
 v_smfmac_f32_32x32x32_bf16 a[16:31], a[108:111], v[72:79], v6
 v_exp_f32 v59, v27
 v_exp_f32 v60, v28
 v_exp_f32 v61, v29
 v_smfmac_f32_16x16x64_bf16 a[36:39], a[80:83], v[72:79], v6
 v_exp_f32 v62, v30
 v_exp_f32 v63, v31
 s_waitcnt lgkmcnt(0)
 v_mfma_f32_32x32x16_bf16 v[16:31], a[88:91], a[64:67], v[96:111]
 v_exp_f32 v64, v32
 v_exp_f32 v65, v33
 v_exp_f32 v66, v34
 v_mfma_f32_32x32x16_bf16 v[16:31], a[92:95], a[68:71], v[16:31]
 v_exp_f32 v67, v35
 v_exp_f32 v68, v36
 v_exp_f32 v69, v37
 v_smfmac_f32_32x32x32_bf16 a[0:15], a[112:115], v[48:55], v6
 v_exp_f32 v70, v38
 v_exp_f32 v71, v39
 v_exp_f32 v72, v40
 v_smfmac_f32_16x16x64_bf16 a[32:35], a[80:83], v[48:55], v6
 v_exp_f32 v73, v41
 v_exp_f32 v74, v42
 v_smfmac_f32_32x32x32_bf16 a[0:15], a[116:119], v[56:63], v6
 v_exp_f32 v75, v43
 v_exp_f32 v76, v44
 v_exp_f32 v77, v45
 v_smfmac_f32_16x16x64_bf16 a[32:35], a[80:83], v[56:63], v6
 v_exp_f32 v78, v46
 v_exp_f32 v79, v47
 v_mfma_f32_32x32x16_bf16 v[32:47], a[88:91], a[72:75], v[112:127]
 v_exp_f32 v48, v16
 v_exp_f32 v49, v17
 v_exp_f32 v50, v18
 ds_read_b128 a[104:107], v1 offset:18432
 ds_read_b128 a[108:111], v1 offset:19456
 ds_read_b128 a[96:99], v1 offset:20480
 ds_read_b128 a[100:103], v1 offset:21504
 v_mfma_f32_32x32x16_bf16 v[32:47], a[92:95], a[76:79], v[32:47]
 v_exp_f32 v51, v19
 v_exp_f32 v52, v20
 v_exp_f32 v53, v21
 v_smfmac_f32_32x32x32_bf16 a[16:31], a[112:115], v[64:71], v6
 v_exp_f32 v54, v22
 v_exp_f32 v55, v23
 v_exp_f32 v56, v24
 v_smfmac_f32_16x16x64_bf16 a[36:39], a[80:83], v[64:71], v6
 v_exp_f32 v57, v25
 v_exp_f32 v58, v26
 v_smfmac_f32_32x32x32_bf16 a[16:31], a[116:119], v[72:79], v6
 v_exp_f32 v59, v27
 v_exp_f32 v60, v28
 v_exp_f32 v61, v29
 v_smfmac_f32_16x16x64_bf16 a[36:39], a[80:83], v[72:79], v6
 v_exp_f32 v62, v30
 v_exp_f32 v63, v31
 s_waitcnt lgkmcnt(0)
 v_mfma_f32_32x32x16_bf16 v[16:31], a[96:99], a[64:67], v[96:111]
 v_exp_f32 v64, v32
 v_exp_f32 v65, v33
 v_exp_f32 v66, v34
 v_mfma_f32_32x32x16_bf16 v[16:31], a[100:103], a[68:71], v[16:31]
 v_exp_f32 v67, v35
 v_exp_f32 v68, v36
 v_exp_f32 v69, v37
 v_smfmac_f32_32x32x32_bf16 a[0:15], a[104:107], v[48:55], v6
 v_exp_f32 v70, v38
 v_exp_f32 v71, v39
 v_exp_f32 v72, v40
 v_smfmac_f32_16x16x64_bf16 a[32:35], a[80:83], v[48:55], v6
 v_exp_f32 v73, v41
 v_exp_f32 v74, v42
 v_smfmac_f32_32x32x32_bf16 a[0:15], a[108:111], v[56:63], v6
 v_exp_f32 v75, v43
 v_exp_f32 v76, v44
 v_exp_f32 v77, v45
 v_smfmac_f32_16x16x64_bf16 a[32:35], a[80:83], v[56:63], v6
 v_exp_f32 v78, v46
 v_exp_f32 v79, v47
 v_mfma_f32_32x32x16_bf16 v[32:47], a[96:99], a[72:75], v[112:127]
 v_exp_f32 v48, v16
 v_exp_f32 v49, v17
 v_exp_f32 v50, v18
 ds_read_b128 a[112:115], v1 offset:22528
 ds_read_b128 a[116:119], v1 offset:23552
 ds_read_b128 a[88:91], v1 offset:24576
 ds_read_b128 a[92:95], v1 offset:25600
 v_mfma_f32_32x32x16_bf16 v[32:47], a[100:103], a[76:79], v[32:47]
 v_exp_f32 v51, v19
 v_exp_f32 v52, v20
 v_exp_f32 v53, v21
 v_smfmac_f32_32x32x32_bf16 a[16:31], a[104:107], v[64:71], v6
 v_exp_f32 v54, v22
 v_exp_f32 v55, v23
 v_exp_f32 v56, v24
 v_smfmac_f32_16x16x64_bf16 a[36:39], a[80:83], v[64:71], v6
 v_exp_f32 v57, v25
 v_exp_f32 v58, v26
 v_smfmac_f32_32x32x32_bf16 a[16:31], a[108:111], v[72:79], v6
 v_exp_f32 v59, v27
 v_exp_f32 v60, v28
 v_exp_f32 v61, v29
 v_smfmac_f32_16x16x64_bf16 a[36:39], a[80:83], v[72:79], v6
 v_exp_f32 v62, v30
 v_exp_f32 v63, v31
 s_waitcnt lgkmcnt(0)
 v_mfma_f32_32x32x16_bf16 v[16:31], a[88:91], a[64:67], v[96:111]
 v_exp_f32 v64, v32
 v_exp_f32 v65, v33
 v_exp_f32 v66, v34
 v_mfma_f32_32x32x16_bf16 v[16:31], a[92:95], a[68:71], v[16:31]
 v_exp_f32 v67, v35
 v_exp_f32 v68, v36
 v_exp_f32 v69, v37
 v_smfmac_f32_32x32x32_bf16 a[0:15], a[112:115], v[48:55], v6
 v_exp_f32 v70, v38
 v_exp_f32 v71, v39
 v_exp_f32 v72, v40
 v_smfmac_f32_16x16x64_bf16 a[32:35], a[80:83], v[48:55], v6
 v_exp_f32 v73, v41
 v_exp_f32 v74, v42
 v_smfmac_f32_32x32x32_bf16 a[0:15], a[116:119], v[56:63], v6
 v_exp_f32 v75, v43
 v_exp_f32 v76, v44
 v_exp_f32 v77, v45
 v_smfmac_f32_16x16x64_bf16 a[32:35], a[80:83], v[56:63], v6
 v_exp_f32 v78, v46
 v_exp_f32 v79, v47
 v_mfma_f32_32x32x16_bf16 v[32:47], a[88:91], a[72:75], v[112:127]
 v_exp_f32 v48, v16
 v_exp_f32 v49, v17
 v_exp_f32 v50, v18
 ds_read_b128 a[104:107], v1 offset:26624
 ds_read_b128 a[108:111], v1 offset:27648
 ds_read_b128 a[96:99], v1 offset:28672
 ds_read_b128 a[100:103], v1 offset:29696
 v_add_u32 v10, 32768, v1
 v_and_b32 v10, 0x1ffff, v10
 v_mfma_f32_32x32x16_bf16 v[32:47], a[92:95], a[76:79], v[32:47]
 v_exp_f32 v51, v19
 v_exp_f32 v52, v20
 v_exp_f32 v53, v21
 v_smfmac_f32_32x32x32_bf16 a[16:31], a[112:115], v[64:71], v6
 v_exp_f32 v54, v22
 v_exp_f32 v55, v23
 v_exp_f32 v56, v24
 v_smfmac_f32_16x16x64_bf16 a[36:39], a[80:83], v[64:71], v6
 v_exp_f32 v57, v25
 v_exp_f32 v58, v26
 v_smfmac_f32_32x32x32_bf16 a[16:31], a[116:119], v[72:79], v6
 v_exp_f32 v59, v27
 v_exp_f32 v60, v28
 v_exp_f32 v61, v29
 v_smfmac_f32_16x16x64_bf16 a[36:39], a[80:83], v[72:79], v6
 v_exp_f32 v62, v30
 v_exp_f32 v63, v31
 s_waitcnt lgkmcnt(0)
 v_mfma_f32_32x32x16_bf16 v[16:31], a[96:99], a[64:67], v[96:111]
 v_exp_f32 v64, v32
 v_exp_f32 v65, v33
 v_exp_f32 v66, v34
 v_mfma_f32_32x32x16_bf16 v[16:31], a[100:103], a[68:71], v[16:31]
 v_exp_f32 v67, v35
 v_exp_f32 v68, v36
 v_exp_f32 v69, v37
 v_smfmac_f32_32x32x32_bf16 a[0:15], a[104:107], v[48:55], v6
 v_exp_f32 v70, v38
 v_exp_f32 v71, v39
 v_exp_f32 v72, v40
 v_smfmac_f32_16x16x64_bf16 a[32:35], a[80:83], v[48:55], v6
 v_exp_f32 v73, v41
 v_exp_f32 v74, v42
 v_smfmac_f32_32x32x32_bf16 a[0:15], a[108:111], v[56:63], v6
 v_exp_f32 v75, v43
 v_exp_f32 v76, v44
 v_exp_f32 v77, v45
 v_smfmac_f32_16x16x64_bf16 a[32:35], a[80:83], v[56:63], v6
 v_exp_f32 v78, v46
 v_exp_f32 v79, v47
 v_mfma_f32_32x32x16_bf16 v[32:47], a[96:99], a[72:75], v[112:127]
 v_exp_f32 v48, v16
 v_exp_f32 v49, v17
 v_exp_f32 v50, v18
 ds_read_b128 a[112:115], v1 offset:30720
 ds_read_b128 a[116:119], v1 offset:31744
 ds_read_b128 a[88:91], v10 offset:0
 ds_read_b128 a[92:95], v10 offset:1024
 v_mov_b32 v1, v10
 v_mfma_f32_32x32x16_bf16 v[32:47], a[100:103], a[76:79], v[32:47]
 v_exp_f32 v51, v19
 v_exp_f32 v52, v20
 v_exp_f32 v53, v21
 v_smfmac_f32_32x32x32_bf16 a[16:31], a[104:107], v[64:71], v6
 v_exp_f32 v54, v22
 v_exp_f32 v55, v23
 v_exp_f32 v56, v24
 v_smfmac_f32_16x16x64_bf16 a[36:39], a[80:83], v[64:71], v6
 v_exp_f32 v57, v25
 v_exp_f32 v58, v26
 v_smfmac_f32_32x32x32_bf16 a[16:31], a[108:111], v[72:79], v6
 v_exp_f32 v59, v27
 v_exp_f32 v60, v28
 v_exp_f32 v61, v29
 v_smfmac_f32_16x16x64_bf16 a[36:39], a[80:83], v[72:79], v6
 v_exp_f32 v62, v30
 v_exp_f32 v63, v31
 s_waitcnt lgkmcnt(0)
 v_mfma_f32_32x32x16_bf16 v[16:31], a[88:91], a[64:67], v[96:111]
 v_exp_f32 v64, v32
 v_exp_f32 v65, v33
 v_exp_f32 v66, v34
 v_mfma_f32_32x32x16_bf16 v[16:31], a[92:95], a[68:71], v[16:31]
 v_exp_f32 v67, v35
 v_exp_f32 v68, v36
 v_exp_f32 v69, v37
 v_smfmac_f32_32x32x32_bf16 a[0:15], a[112:115], v[48:55], v6
 v_exp_f32 v70, v38
 v_exp_f32 v71, v39
 v_exp_f32 v72, v40
 v_smfmac_f32_16x16x64_bf16 a[32:35], a[80:83], v[48:55], v6
 v_exp_f32 v73, v41
 v_exp_f32 v74, v42
 v_smfmac_f32_32x32x32_bf16 a[0:15], a[116:119], v[56:63], v6
 v_exp_f32 v75, v43
 v_exp_f32 v76, v44
 v_exp_f32 v77, v45
 v_smfmac_f32_16x16x64_bf16 a[32:35], a[80:83], v[56:63], v6
 v_exp_f32 v78, v46
 v_exp_f32 v79, v47
 s_add_u32 s29, s29, 1
 s_cmp_lt_u32 s29, 8
 s_cbranch_scc1 L_aloop
 v_smfmac_f32_32x32x32_bf16 a[16:31], a[112:115], v[64:71], v6
 v_smfmac_f32_16x16x64_bf16 a[36:39], a[80:83], v[64:71], v6
 v_smfmac_f32_32x32x32_bf16 a[16:31], a[116:119], v[72:79], v6
 v_smfmac_f32_16x16x64_bf16 a[36:39], a[80:83], v[72:79], v6
 v_accvgpr_read_b32 v7, a32
 s_nop 6
 v_accvgpr_read_b32 v8, a36
 s_cmp_lg_u32 s38, 0
 s_cbranch_scc1 L_afin
 v_add_f32 v10, v7, v8
 v_cmp_nge_f32 vcc, 1400897536, v10
 v_mov_b32 v11, 163792
 v_mov_b32 v12, 1
 s_cmp_lg_u32 s14, 0
 s_cbranch_scc1 L_af0
 v_mov_b32 v13, 0
 ds_write_b32 v11, v13
 s_waitcnt lgkmcnt(0)
L_af0:
 s_barrier
 s_cbranch_vccz L_af1
 ds_write_b32 v11, v12
 s_waitcnt lgkmcnt(0)
L_af1:
 s_barrier
 ds_read_b32 v12, v11
 s_waitcnt lgkmcnt(0)
 v_readfirstlane_b32 s33, v12
 s_cmp_eq_u32 s33, 0
 s_cbranch_scc1 L_afin
 s_mov_b32 s31, 0
 s_and_b32 s33, s31, 0x1ffff
 s_add_u32 m0, s33, s30
 s_add_u32 s33, s31, s30
 s_add_u32 s33, s33, 104857600
 s_add_u32 s31, s31, 32768
 buffer_load_dwordx4 v15, s[4:7], s33 offen offset:0 sc1 lds
 buffer_load_dwordx4 v15, s[4:7], s33 offen offset:1024 sc1 lds
 buffer_load_dwordx4 v15, s[4:7], s33 offen offset:2048 sc1 lds
 buffer_load_dwordx4 v15, s[4:7], s33 offen offset:3072 sc1 lds
 s_and_b32 s33, s31, 0x1ffff
 s_add_u32 m0, s33, s30
 s_add_u32 s33, s31, s30
 s_add_u32 s33, s33, 104857600
 s_add_u32 s31, s31, 32768
 buffer_load_dwordx4 v15, s[4:7], s33 offen offset:0 sc1 lds
 buffer_load_dwordx4 v15, s[4:7], s33 offen offset:1024 sc1 lds
 buffer_load_dwordx4 v15, s[4:7], s33 offen offset:2048 sc1 lds
 buffer_load_dwordx4 v15, s[4:7], s33 offen offset:3072 sc1 lds
 s_and_b32 s33, s31, 0x1ffff
 s_add_u32 m0, s33, s30
 s_add_u32 s33, s31, s30
 s_add_u32 s33, s33, 104857600
 s_add_u32 s31, s31, 32768
 buffer_load_dwordx4 v15, s[4:7], s33 offen offset:0 sc1 lds
 buffer_load_dwordx4 v15, s[4:7], s33 offen offset:1024 sc1 lds
 buffer_load_dwordx4 v15, s[4:7], s33 offen offset:2048 sc1 lds
 buffer_load_dwordx4 v15, s[4:7], s33 offen offset:3072 sc1 lds
 s_mov_b32 s29, 0
 v_mov_b32 v1, v15
 v_mov_b32 v7, 0xff800000
 v_mov_b32 v8, 0xff800000
L_axl:
 s_cmp_ge_u32 s31, 0x40000
 s_cbranch_scc1 L_ac1x
 s_waitcnt vmcnt(4) lgkmcnt(0)
 s_barrier
 s_and_b32 s33, s31, 0x1ffff
 s_add_u32 m0, s33, s30
 s_add_u32 s33, s31, s30
 s_add_u32 s33, s33, 104857600
 s_add_u32 s31, s31, 32768
 buffer_load_dwordx4 v15, s[4:7], s33 offen offset:0 sc1 lds
 buffer_load_dwordx4 v15, s[4:7], s33 offen offset:1024 sc1 lds
 buffer_load_dwordx4 v15, s[4:7], s33 offen offset:2048 sc1 lds
 buffer_load_dwordx4 v15, s[4:7], s33 offen offset:3072 sc1 lds
 s_branch L_ac2x
L_ac1x:
 s_waitcnt vmcnt(0) lgkmcnt(0)
 s_barrier
L_ac2x:
 s_mov_b32 s28, 0
L_axi:
 ds_read_b128 a[88:91], v1
 ds_read_b128 a[92:95], v1 offset:1024
 v_add_u32 v1, 4096, v1
 v_and_b32 v1, 0x1ffff, v1
 s_waitcnt lgkmcnt(0)
 v_mfma_f32_32x32x16_bf16 v[16:31], a[88:91], a[64:67], 0
 v_mfma_f32_32x32x16_bf16 v[32:47], a[88:91], a[72:75], 0
 v_mfma_f32_32x32x16_bf16 v[16:31], a[92:95], a[68:71], v[16:31]
 v_mfma_f32_32x32x16_bf16 v[32:47], a[92:95], a[76:79], v[32:47]
 s_nop 3
 v_max3_f32 v7, v16, v17, v7
 v_max3_f32 v7, v18, v19, v7
 v_max3_f32 v7, v20, v21, v7
 v_max3_f32 v7, v22, v23, v7
 v_max3_f32 v7, v24, v25, v7
 v_max3_f32 v7, v26, v27, v7
 v_max3_f32 v7, v28, v29, v7
 v_max3_f32 v7, v30, v31, v7
 v_max3_f32 v8, v32, v33, v8
 v_max3_f32 v8, v34, v35, v8
 v_max3_f32 v8, v36, v37, v8
 v_max3_f32 v8, v38, v39, v8
 v_max3_f32 v8, v40, v41, v8
 v_max3_f32 v8, v42, v43, v8
 v_max3_f32 v8, v44, v45, v8
 v_max3_f32 v8, v46, v47, v8
 s_add_u32 s28, s28, 1
 s_cmp_lt_u32 s28, 8
 s_cbranch_scc1 L_axi
 s_add_u32 s29, s29, 1
 s_cmp_lt_u32 s29, 8
 s_cbranch_scc1 L_axl
 v_mov_b32 v9, v7
 s_nop 1
 v_permlane32_swap_b32 v7, v9
 v_max_f32 v7, v7, v9
 v_sub_f32 v96, 0, v7
 v_sub_f32 v97, 0, v7
 v_sub_f32 v98, 0, v7
 v_sub_f32 v99, 0, v7
 v_sub_f32 v100, 0, v7
 v_sub_f32 v101, 0, v7
 v_sub_f32 v102, 0, v7
 v_sub_f32 v103, 0, v7
 v_sub_f32 v104, 0, v7
 v_sub_f32 v105, 0, v7
 v_sub_f32 v106, 0, v7
 v_sub_f32 v107, 0, v7
 v_sub_f32 v108, 0, v7
 v_sub_f32 v109, 0, v7
 v_sub_f32 v110, 0, v7
 v_sub_f32 v111, 0, v7
 v_mov_b32 v9, v8
 s_nop 1
 v_permlane32_swap_b32 v8, v9
 v_max_f32 v8, v8, v9
 v_sub_f32 v112, 0, v8
 v_sub_f32 v113, 0, v8
 v_sub_f32 v114, 0, v8
 v_sub_f32 v115, 0, v8
 v_sub_f32 v116, 0, v8
 v_sub_f32 v117, 0, v8
 v_sub_f32 v118, 0, v8
 v_sub_f32 v119, 0, v8
 v_sub_f32 v120, 0, v8
 v_sub_f32 v121, 0, v8
 v_sub_f32 v122, 0, v8
 v_sub_f32 v123, 0, v8
 v_sub_f32 v124, 0, v8
 v_sub_f32 v125, 0, v8
 v_sub_f32 v126, 0, v8
 v_sub_f32 v127, 0, v8
 s_mov_b32 s38, 1
 s_barrier
 s_branch L_amain
L_afin:
 v_rcp_f32 v7, v7
 v_rcp_f32 v8, v8
 s_mul_i32 s27, s24, 65536
 s_lshl_b32 s33, s26, 12
 s_add_u32 s27, s27, s33
 s_add_u32 s27, s27, 117440512
 v_mul_f32 v7, v7, v5
 v_mul_f32 v8, v8, v5
 v_accvgpr_read_b32 v16, a0
 v_accvgpr_read_b32 v17, a1
 v_accvgpr_read_b32 v18, a2
 v_accvgpr_read_b32 v19, a3
 v_accvgpr_read_b32 v20, a4
 v_accvgpr_read_b32 v21, a5
 v_accvgpr_read_b32 v22, a6
 v_accvgpr_read_b32 v23, a7
 v_accvgpr_read_b32 v24, a8
 v_accvgpr_read_b32 v25, a9
 v_accvgpr_read_b32 v26, a10
 v_accvgpr_read_b32 v27, a11
 v_accvgpr_read_b32 v28, a12
 v_accvgpr_read_b32 v29, a13
 v_accvgpr_read_b32 v30, a14
 v_accvgpr_read_b32 v31, a15
 v_accvgpr_read_b32 v32, a16
 v_accvgpr_read_b32 v33, a17
 v_accvgpr_read_b32 v34, a18
 v_accvgpr_read_b32 v35, a19
 v_accvgpr_read_b32 v36, a20
 v_accvgpr_read_b32 v37, a21
 v_accvgpr_read_b32 v38, a22
 v_accvgpr_read_b32 v39, a23
 v_accvgpr_read_b32 v40, a24
 v_accvgpr_read_b32 v41, a25
 v_accvgpr_read_b32 v42, a26
 v_accvgpr_read_b32 v43, a27
 v_accvgpr_read_b32 v44, a28
 v_accvgpr_read_b32 v45, a29
 v_accvgpr_read_b32 v46, a30
 v_accvgpr_read_b32 v47, a31
 v_mul_f32 v16, v16, v7
 v_mul_f32 v17, v17, v7
 v_mul_f32 v18, v18, v7
 v_mul_f32 v19, v19, v7
 v_mul_f32 v20, v20, v7
 v_mul_f32 v21, v21, v7
 v_mul_f32 v22, v22, v7
 v_mul_f32 v23, v23, v7
 v_mul_f32 v24, v24, v7
 v_mul_f32 v25, v25, v7
 v_mul_f32 v26, v26, v7
 v_mul_f32 v27, v27, v7
 v_mul_f32 v28, v28, v7
 v_mul_f32 v29, v29, v7
 v_mul_f32 v30, v30, v7
 v_mul_f32 v31, v31, v7
 v_mul_f32 v32, v32, v8
 v_mul_f32 v33, v33, v8
 v_mul_f32 v34, v34, v8
 v_mul_f32 v35, v35, v8
 v_mul_f32 v36, v36, v8
 v_mul_f32 v37, v37, v8
 v_mul_f32 v38, v38, v8
 v_mul_f32 v39, v39, v8
 v_mul_f32 v40, v40, v8
 v_mul_f32 v41, v41, v8
 v_mul_f32 v42, v42, v8
 v_mul_f32 v43, v43, v8
 v_mul_f32 v44, v44, v8
 v_mul_f32 v45, v45, v8
 v_mul_f32 v46, v46, v8
 v_mul_f32 v47, v47, v8
 v_cvt_pk_bf16_f32 v48, v16, v17
 v_cvt_pk_bf16_f32 v49, v18, v19
 v_cvt_pk_bf16_f32 v50, v20, v21
 v_cvt_pk_bf16_f32 v51, v22, v23
 v_cvt_pk_bf16_f32 v52, v24, v25
 v_cvt_pk_bf16_f32 v53, v26, v27
 v_cvt_pk_bf16_f32 v54, v28, v29
 v_cvt_pk_bf16_f32 v55, v30, v31
 v_cvt_pk_bf16_f32 v56, v32, v33
 v_cvt_pk_bf16_f32 v57, v34, v35
 v_cvt_pk_bf16_f32 v58, v36, v37
 v_cvt_pk_bf16_f32 v59, v38, v39
 v_cvt_pk_bf16_f32 v60, v40, v41
 v_cvt_pk_bf16_f32 v61, v42, v43
 v_cvt_pk_bf16_f32 v62, v44, v45
 v_cvt_pk_bf16_f32 v63, v46, v47
 buffer_store_dwordx4 v[48:51], v15, s[4:7], s27 offen offset:0 sc1
 buffer_store_dwordx4 v[52:55], v15, s[4:7], s27 offen offset:1024 sc1
 buffer_store_dwordx4 v[56:59], v15, s[4:7], s27 offen offset:2048 sc1
 buffer_store_dwordx4 v[60:63], v15, s[4:7], s27 offen offset:3072 sc1
 s_lshl_b32 s36, s12, 7
 s_add_u32 s36, s36, 2252800
 s_branch L_next
L_sx:
 v_lshlrev_b32 v15, 4, v0
 s_lshl_b32 s34, s24, 3
 s_add_u32 s34, s34, s14
 s_lshr_b32 s25, s34, 2
 s_and_b32 s33, s14, 3
 s_lshl_b32 s26, s12, 2
 s_add_u32 s26, s26, s33
 s_lshl_b32 s33, s26, 8
 s_add_u32 s33, s33, 2293760
 v_lshl_add_u32 v2, v0, 2, s33
 s_lshl_b32 s36, s25, 2
 s_add_u32 s36, s36, s33
 v_add_u32 v6, s25, 1
 s_mov_b64 exec, 1
 buffer_store_dword v6, off, s[4:7], s36 offset:128 sc1
 s_mov_b64 exec, -1
 s_lshl_b32 s27, s25, 18
 s_lshl_b32 s33, s26, 13
 s_add_u32 s27, s27, s33
 v_lshrrev_b32 v5, 5, v0
 v_and_b32 v7, 31, v0
 v_lshlrev_b32 v9, 3, v7
 v_lshlrev_b32 v8, 2, v5
 v_sub_u32 v7, v7, v8
 v_and_b32 v10, 15, v0
 v_lshlrev_b32 v10, 4, v10
 v_lshl_add_u32 v10, v5, 8, v10
 v_bfe_u32 v11, v0, 4, 1
 v_lshl_add_u32 v10, v11, 10, v10
 s_lshl_b32 s33, s12, 4
 s_add_u32 s33, s33, s34
 s_lshl_b32 s33, s33, 10
 s_waitcnt lgkmcnt(0)
 buffer_load_dwordx4 v[16:19], v15, s[8:11], s33 offen
 s_add_u32 s33, s33, 131072
 buffer_load_dwordx4 v[16:19], v15, s[8:11], s33 offen
 s_add_u32 s33, s33, 131072
 buffer_load_dwordx4 v[16:19], v15, s[8:11], s33 offen
 s_add_u32 s33, s33, 131072
 buffer_load_dwordx4 v[16:19], v15, s[8:11], s33 offen
 s_add_u32 s33, s33, 131072
 buffer_load_dwordx4 v[16:19], v15, s[8:11], s33 offen
 s_add_u32 s33, s33, 131072
 buffer_load_dwordx4 v[16:19], v15, s[8:11], s33 offen
 s_add_u32 s33, s33, 131072
 buffer_load_dwordx4 v[16:19], v15, s[8:11], s33 offen
 s_add_u32 s33, s33, 131072
 buffer_load_dwordx4 v[16:19], v15, s[8:11], s33 offen
 s_add_u32 s33, s33, 131072
 buffer_load_dwordx4 v[16:19], v15, s[8:11], s33 offen
 s_add_u32 s33, s33, 131072
 buffer_load_dwordx4 v[16:19], v15, s[8:11], s33 offen
 s_add_u32 s33, s33, 131072
 buffer_load_dwordx4 v[16:19], v15, s[8:11], s33 offen
 s_add_u32 s33, s33, 131072
 buffer_load_dwordx4 v[16:19], v15, s[8:11], s33 offen
 s_add_u32 s33, s33, 131072
 buffer_load_dwordx4 v[16:19], v15, s[8:11], s33 offen
 s_add_u32 s33, s33, 131072
 buffer_load_dwordx4 v[16:19], v15, s[8:11], s33 offen
 s_add_u32 s33, s33, 131072
 buffer_load_dwordx4 v[16:19], v15, s[8:11], s33 offen
 s_add_u32 s33, s33, 131072
 buffer_load_dwordx4 v[16:19], v15, s[8:11], s33 offen
 s_add_u32 s33, s33, 131072
 buffer_load_dwordx4 v[16:19], v15, s[8:11], s33 offen
 s_add_u32 s33, s33, 131072
 buffer_load_dwordx4 v[16:19], v15, s[8:11], s33 offen
 s_add_u32 s33, s33, 131072
 buffer_load_dwordx4 v[16:19], v15, s[8:11], s33 offen
 s_add_u32 s33, s33, 131072
 buffer_load_dwordx4 v[16:19], v15, s[8:11], s33 offen
 s_add_u32 s33, s33, 131072
 buffer_load_dwordx4 v[16:19], v15, s[8:11], s33 offen
 s_add_u32 s33, s33, 131072
 buffer_load_dwordx4 v[16:19], v15, s[8:11], s33 offen
 s_add_u32 s33, s33, 131072
 buffer_load_dwordx4 v[16:19], v15, s[8:11], s33 offen
 s_add_u32 s33, s33, 131072
 buffer_load_dwordx4 v[16:19], v15, s[8:11], s33 offen
 s_add_u32 s33, s33, 131072
 buffer_load_dwordx4 v[16:19], v15, s[8:11], s33 offen
 s_add_u32 s33, s33, 131072
 buffer_load_dwordx4 v[16:19], v15, s[8:11], s33 offen
 s_add_u32 s33, s33, 131072
 buffer_load_dwordx4 v[16:19], v15, s[8:11], s33 offen
 s_add_u32 s33, s33, 131072
 buffer_load_dwordx4 v[16:19], v15, s[8:11], s33 offen
 s_add_u32 s33, s33, 131072
 buffer_load_dwordx4 v[16:19], v15, s[8:11], s33 offen
 s_add_u32 s33, s33, 131072
 buffer_load_dwordx4 v[16:19], v15, s[8:11], s33 offen
 s_add_u32 s33, s33, 131072
 buffer_load_dwordx4 v[16:19], v15, s[8:11], s33 offen
 s_add_u32 s33, s33, 131072
 buffer_load_dwordx4 v[16:19], v15, s[8:11], s33 offen
 s_add_u32 s33, s33, 131072
 v_mov_b32 v12, 0xff800000
 s_mov_b32 s35, 1040356334
 s_waitcnt vmcnt(32)
 s_barrier
 s_cmp_lg_u32 s14, 0
 s_cbranch_scc1 L_sx1
 v_mov_b32 v4, 128
 v_mov_b32 v1, 1
 s_mov_b64 exec, 1
 global_atomic_add v4, v1, s[16:17] sc1
L_sx0:
 s_sleep 40
 global_load_dword v1, v4, s[16:17] sc1
 s_waitcnt vmcnt(0)
 s_add_u32 s61, s61, 1
 s_cmp_gt_u32 s61, 2000000
 s_cbranch_scc1 L_sx1
 v_cmp_ne_u32 vcc, 248, v1
 s_cbranch_vccnz L_sx0
L_sx1:
 s_barrier
L_sx2:
 s_mov_b64 exec, 3
L_sx3:
 buffer_load_dword v1, v2, s[4:7], 0 offen sc1
 s_waitcnt vmcnt(0)
 v_cmp_ge_u32 vcc, s25, v1
 s_cbranch_vccz L_sx4
 s_add_u32 s61, s61, 1
 s_cmp_gt_u32 s61, 2000000
 s_cbranch_scc1 L_sx4
 v_cmp_gt_u32 vcc, s25, v1
 s_sleep 4
 s_cbranch_vccz L_sx3
 s_sleep 24
 s_branch L_sx3
L_sx4:
 s_mov_b64 exec, -1
 s_add_u32 s33, s27, 16777216
 s_add_u32 s34, s27, 50331648
 buffer_load_dwordx4 v[64:67], v15, s[4:7], s33 offen offset:0 sc1
 buffer_load_dwordx4 a[0:3], v15, s[4:7], s34 offen offset:0 sc1
 buffer_load_dwordx4 v[68:71], v15, s[4:7], s33 offen offset:1024 sc1
 buffer_load_dwordx4 a[4:7], v15, s[4:7], s34 offen offset:1024 sc1
 buffer_load_dwordx4 v[72:75], v15, s[4:7], s33 offen offset:2048 sc1
 buffer_load_dwordx4 a[8:11], v15, s[4:7], s34 offen offset:2048 sc1
 buffer_load_dwordx4 v[76:79], v15, s[4:7], s33 offen offset:3072 sc1
 buffer_load_dwordx4 a[12:15], v15, s[4:7], s34 offen offset:3072 sc1
 s_add_u32 s33, s27, 16781312
 s_add_u32 s34, s27, 50335744
 buffer_load_dwordx4 v[80:83], v15, s[4:7], s33 offen offset:0 sc1
 buffer_load_dwordx4 a[16:19], v15, s[4:7], s34 offen offset:0 sc1
 buffer_load_dwordx4 v[84:87], v15, s[4:7], s33 offen offset:1024 sc1
 buffer_load_dwordx4 a[20:23], v15, s[4:7], s34 offen offset:1024 sc1
 buffer_load_dwordx4 v[88:91], v15, s[4:7], s33 offen offset:2048 sc1
 buffer_load_dwordx4 a[24:27], v15, s[4:7], s34 offen offset:2048 sc1
 buffer_load_dwordx4 v[92:95], v15, s[4:7], s33 offen offset:3072 sc1
 buffer_load_dwordx4 a[28:31], v15, s[4:7], s34 offen offset:3072 sc1
 s_add_u32 s28, s27, 67108864
 s_waitcnt vmcnt(14)
 v_mfma_f32_32x32x16_bf16 v[16:31], v[64:67], a[0:3], 0
 s_waitcnt vmcnt(12)
 v_mfma_f32_32x32x16_bf16 v[16:31], v[68:71], a[4:7], v[16:31]
 s_waitcnt vmcnt(10)
 v_mfma_f32_32x32x16_bf16 v[16:31], v[72:75], a[8:11], v[16:31]
 s_waitcnt vmcnt(8)
 v_mfma_f32_32x32x16_bf16 v[16:31], v[76:79], a[12:15], v[16:31]
 s_waitcnt vmcnt(6)
 v_mfma_f32_32x32x16_bf16 v[16:31], v[80:83], a[16:19], v[16:31]
 s_waitcnt vmcnt(4)
 v_mfma_f32_32x32x16_bf16 v[16:31], v[84:87], a[20:23], v[16:31]
 s_waitcnt vmcnt(2)
 v_mfma_f32_32x32x16_bf16 v[16:31], v[88:91], a[24:27], v[16:31]
 s_waitcnt vmcnt(0)
 v_mfma_f32_32x32x16_bf16 v[16:31], v[92:95], a[28:31], v[16:31]
 v_cmp_le_i32 vcc, 0, v7
 s_nop 10
 v_cndmask_b32 v16, v12, v16, vcc
 v_cmp_le_i32 vcc, 1, v7
 s_nop 1
 v_cndmask_b32 v17, v12, v17, vcc
 v_cmp_le_i32 vcc, 2, v7
 s_nop 1
 v_cndmask_b32 v18, v12, v18, vcc
 v_cmp_le_i32 vcc, 3, v7
 s_nop 1
 v_cndmask_b32 v19, v12, v19, vcc
 v_cmp_le_i32 vcc, 8, v7
 s_nop 1
 v_cndmask_b32 v20, v12, v20, vcc
 v_cmp_le_i32 vcc, 9, v7
 s_nop 1
 v_cndmask_b32 v21, v12, v21, vcc
 v_cmp_le_i32 vcc, 10, v7
 s_nop 1
 v_cndmask_b32 v22, v12, v22, vcc
 v_cmp_le_i32 vcc, 11, v7
 s_nop 1
 v_cndmask_b32 v23, v12, v23, vcc
 v_cmp_le_i32 vcc, 16, v7
 s_nop 1
 v_cndmask_b32 v24, v12, v24, vcc
 v_cmp_le_i32 vcc, 17, v7
 s_nop 1
 v_cndmask_b32 v25, v12, v25, vcc
 v_cmp_le_i32 vcc, 18, v7
 s_nop 1
 v_cndmask_b32 v26, v12, v26, vcc
 v_cmp_le_i32 vcc, 19, v7
 s_nop 1
 v_cndmask_b32 v27, v12, v27, vcc
 v_cmp_le_i32 vcc, 24, v7
 s_nop 1
 v_cndmask_b32 v28, v12, v28, vcc
 v_cmp_le_i32 vcc, 25, v7
 s_nop 1
 v_cndmask_b32 v29, v12, v29, vcc
 v_cmp_le_i32 vcc, 26, v7
 s_nop 1
 v_cndmask_b32 v30, v12, v30, vcc
 v_cmp_le_i32 vcc, 27, v7
 s_nop 1
 v_cndmask_b32 v31, v12, v31, vcc
 v_max3_f32 v13, v16, v17, v18
 v_max3_f32 v13, v13, v19, v20
 v_max3_f32 v13, v13, v21, v22
 v_max3_f32 v13, v13, v23, v24
 v_max3_f32 v13, v13, v25, v26
 v_max3_f32 v13, v13, v27, v28
 v_max3_f32 v13, v13, v29, v30
 v_max_f32 v13, v13, v31
 v_mov_b32 v14, v13
 s_nop 1
 v_permlane32_swap_b32 v13, v14
 v_max_f32 v13, v13, v14
 v_mul_f32 v44, s35, v13
 v_fma_f32 v16, v16, s35, -v44
 v_fma_f32 v17, v17, s35, -v44
 v_fma_f32 v18, v18, s35, -v44
 v_fma_f32 v19, v19, s35, -v44
 v_fma_f32 v20, v20, s35, -v44
 v_fma_f32 v21, v21, s35, -v44
 v_fma_f32 v22, v22, s35, -v44
 v_fma_f32 v23, v23, s35, -v44
 v_fma_f32 v24, v24, s35, -v44
 v_fma_f32 v25, v25, s35, -v44
 v_fma_f32 v26, v26, s35, -v44
 v_fma_f32 v27, v27, s35, -v44
 v_fma_f32 v28, v28, s35, -v44
 v_fma_f32 v29, v29, s35, -v44
 v_fma_f32 v30, v30, s35, -v44
 v_fma_f32 v31, v31, s35, -v44
 v_exp_f32 v16, v16
 v_exp_f32 v17, v17
 v_exp_f32 v18, v18
 v_exp_f32 v19, v19
 v_exp_f32 v20, v20
 v_exp_f32 v21, v21
 v_exp_f32 v22, v22
 v_exp_f32 v23, v23
 v_exp_f32 v24, v24
 v_exp_f32 v25, v25
 v_exp_f32 v26, v26
 v_exp_f32 v27, v27
 v_exp_f32 v28, v28
 v_exp_f32 v29, v29
 v_exp_f32 v30, v30
 v_exp_f32 v31, v31
 v_cvt_pk_bf16_f32 v36, v16, v17
 v_cvt_pk_bf16_f32 v37, v18, v19
 v_cvt_pk_bf16_f32 v40, v20, v21
 v_cvt_pk_bf16_f32 v41, v22, v23
 v_cvt_pk_bf16_f32 v38, v24, v25
 v_cvt_pk_bf16_f32 v39, v26, v27
 v_cvt_pk_bf16_f32 v42, v28, v29
 v_cvt_pk_bf16_f32 v43, v30, v31
 buffer_store_dwordx4 v[36:39], v10, s[4:7], s28 offen sc1
 buffer_store_dwordx4 v[40:43], v10, s[4:7], s28 offen offset:512 sc1
 v_add_f32 v16, v16, v24
 v_add_f32 v17, v17, v25
 v_add_f32 v18, v18, v26
 v_add_f32 v19, v19, v27
 v_add_f32 v20, v20, v28
 v_add_f32 v21, v21, v29
 v_add_f32 v22, v22, v30
 v_add_f32 v23, v23, v31
 v_add_f32 v16, v16, v20
 v_add_f32 v17, v17, v21
 v_add_f32 v18, v18, v22
 v_add_f32 v19, v19, v23
 v_add_f32 v16, v16, v18
 v_add_f32 v17, v17, v19
 v_add_f32 v16, v16, v17
 v_mov_b32 v17, v16
 s_nop 1
 v_permlane32_swap_b32 v16, v17
 v_add_f32 v45, v16, v17
 s_mov_b32 exec_hi, 0
 buffer_store_dwordx2 v[44:45], v9, s[4:7], s28 offen offset:2048 sc1
 s_mov_b64 exec, -1
 s_add_u32 s27, s27, 1048576
 s_add_u32 s25, s25, 4
 v_add_u32 v6, 4, v6
 s_cmp_lt_u32 s25, 64
 s_mov_b64 exec, 1
 s_waitcnt vmcnt(0)
 buffer_store_dword v6, off, s[4:7], s36 offset:128 sc1
 s_cbranch_scc1 L_sx2
 s_mov_b64 exec, -1
 s_mov_b32 s37, 0
 s_branch L_next
L_pr:
 v_lshlrev_b32 v15, 4, v0
 s_lshl_b32 s24, s40, 3
 s_add_u32 s24, s24, s12
 s_add_u32 s35, s24, 3
 s_lshl_b32 s24, s24, 19
 s_lshl_b32 s33, s14, 13
 s_add_u32 s24, s24, s33
 s_add_u32 s24, s24, 134217728
 s_lshl_b32 s33, s14, 8
 s_add_u32 s33, s33, 2260992
 v_lshrrev_b32 v3, 1, v0
 v_and_b32 v4, 1, v0
 v_lshlrev_b32 v4, 7, v4
 v_lshl_add_u32 v3, v3, 11, v4
 v_mov_b32 v4, 0x3f80
 v_mov_b32 v5, 1.0
 s_mov_b64 exec, 0xffff
L_pr0:
 buffer_load_dword v1, v3, s[4:7], s33 offen sc1
 s_waitcnt vmcnt(0)
 v_cmp_gt_u32 vcc, s35, v1
 s_cbranch_vccz L_pr1
 s_add_u32 s61, s61, 1
 s_cmp_gt_u32 s61, 2000000
 s_cbranch_scc1 L_pr1
 s_sleep 32
 s_branch L_pr0
L_pr1:
 s_mov_b64 exec, -1
 s_add_u32 s33, s24, 0
 buffer_load_dwordx4 v[32:35], v15, s[4:7], s33 offen offset:0 sc1
 s_add_u32 s33, s24, 65536
 buffer_load_dwordx4 v[36:39], v15, s[4:7], s33 offen offset:0 sc1
 s_add_u32 s33, s24, 131072
 buffer_load_dwordx4 v[40:43], v15, s[4:7], s33 offen offset:0 sc1
 s_add_u32 s33, s24, 196608
 buffer_load_dwordx4 v[44:47], v15, s[4:7], s33 offen offset:0 sc1
 s_add_u32 s33, s24, 262144
 buffer_load_dwordx4 v[48:51], v15, s[4:7], s33 offen offset:0 sc1
 s_add_u32 s33, s24, 327680
 buffer_load_dwordx4 v[52:55], v15, s[4:7], s33 offen offset:0 sc1
 s_add_u32 s33, s24, 393216
 buffer_load_dwordx4 v[56:59], v15, s[4:7], s33 offen offset:0 sc1
 s_add_u32 s33, s24, 458752
 buffer_load_dwordx4 v[60:63], v15, s[4:7], s33 offen offset:0 sc1
 s_add_u32 s33, s24, 0
 buffer_load_dwordx4 v[64:67], v15, s[4:7], s33 offen offset:1024 sc1
 s_add_u32 s33, s24, 65536
 buffer_load_dwordx4 v[68:71], v15, s[4:7], s33 offen offset:1024 sc1
 s_add_u32 s33, s24, 131072
 buffer_load_dwordx4 v[72:75], v15, s[4:7], s33 offen offset:1024 sc1
 s_add_u32 s33, s24, 196608
 buffer_load_dwordx4 v[76:79], v15, s[4:7], s33 offen offset:1024 sc1
 s_add_u32 s33, s24, 262144
 buffer_load_dwordx4 v[80:83], v15, s[4:7], s33 offen offset:1024 sc1
 s_add_u32 s33, s24, 327680
 buffer_load_dwordx4 v[84:87], v15, s[4:7], s33 offen offset:1024 sc1
 s_add_u32 s33, s24, 393216
 buffer_load_dwordx4 v[88:91], v15, s[4:7], s33 offen offset:1024 sc1
 s_add_u32 s33, s24, 458752
 buffer_load_dwordx4 v[92:95], v15, s[4:7], s33 offen offset:1024 sc1
 s_add_u32 s33, s24, 0
 buffer_load_dwordx4 v[96:99], v15, s[4:7], s33 offen offset:2048 sc1
 s_add_u32 s33, s24, 65536
 buffer_load_dwordx4 v[100:103], v15, s[4:7], s33 offen offset:2048 sc1
 s_add_u32 s33, s24, 131072
 buffer_load_dwordx4 v[104:107], v15, s[4:7], s33 offen offset:2048 sc1
 s_add_u32 s33, s24, 196608
 buffer_load_dwordx4 v[108:111], v15, s[4:7], s33 offen offset:2048 sc1
 s_add_u32 s33, s24, 262144
 buffer_load_dwordx4 v[112:115], v15, s[4:7], s33 offen offset:2048 sc1
 s_add_u32 s33, s24, 327680
 buffer_load_dwordx4 v[116:119], v15, s[4:7], s33 offen offset:2048 sc1
 s_add_u32 s33, s24, 393216
 buffer_load_dwordx4 v[120:123], v15, s[4:7], s33 offen offset:2048 sc1
 s_add_u32 s33, s24, 458752
 buffer_load_dwordx4 v[124:127], v15, s[4:7], s33 offen offset:2048 sc1
 s_waitcnt vmcnt(23)
 v_lshlrev_b32 v16, 16, v32
 v_and_b32 v17, 0xffff0000, v32
 v_lshlrev_b32 v18, 16, v33
 v_and_b32 v19, 0xffff0000, v33
 v_lshlrev_b32 v20, 16, v34
 v_and_b32 v21, 0xffff0000, v34
 v_lshlrev_b32 v22, 16, v35
 v_and_b32 v23, 0xffff0000, v35
 s_waitcnt vmcnt(22)
 v_dot2c_f32_bf16 v16, v36, v4
 v_dot2c_f32_bf16 v17, v36, v5
 v_dot2c_f32_bf16 v18, v37, v4
 v_dot2c_f32_bf16 v19, v37, v5
 v_dot2c_f32_bf16 v20, v38, v4
 v_dot2c_f32_bf16 v21, v38, v5
 v_dot2c_f32_bf16 v22, v39, v4
 v_dot2c_f32_bf16 v23, v39, v5
 s_waitcnt vmcnt(21)
 v_dot2c_f32_bf16 v16, v40, v4
 v_dot2c_f32_bf16 v17, v40, v5
 v_dot2c_f32_bf16 v18, v41, v4
 v_dot2c_f32_bf16 v19, v41, v5
 v_dot2c_f32_bf16 v20, v42, v4
 v_dot2c_f32_bf16 v21, v42, v5
 v_dot2c_f32_bf16 v22, v43, v4
 v_dot2c_f32_bf16 v23, v43, v5
 s_waitcnt vmcnt(20)
 v_dot2c_f32_bf16 v16, v44, v4
 v_dot2c_f32_bf16 v17, v44, v5
 v_dot2c_f32_bf16 v18, v45, v4
 v_dot2c_f32_bf16 v19, v45, v5
 v_dot2c_f32_bf16 v20, v46, v4
 v_dot2c_f32_bf16 v21, v46, v5
 v_dot2c_f32_bf16 v22, v47, v4
 v_dot2c_f32_bf16 v23, v47, v5
 s_waitcnt vmcnt(19)
 v_dot2c_f32_bf16 v16, v48, v4
 v_dot2c_f32_bf16 v17, v48, v5
 v_dot2c_f32_bf16 v18, v49, v4
 v_dot2c_f32_bf16 v19, v49, v5
 v_dot2c_f32_bf16 v20, v50, v4
 v_dot2c_f32_bf16 v21, v50, v5
 v_dot2c_f32_bf16 v22, v51, v4
 v_dot2c_f32_bf16 v23, v51, v5
 s_waitcnt vmcnt(18)
 v_dot2c_f32_bf16 v16, v52, v4
 v_dot2c_f32_bf16 v17, v52, v5
 v_dot2c_f32_bf16 v18, v53, v4
 v_dot2c_f32_bf16 v19, v53, v5
 v_dot2c_f32_bf16 v20, v54, v4
 v_dot2c_f32_bf16 v21, v54, v5
 v_dot2c_f32_bf16 v22, v55, v4
 v_dot2c_f32_bf16 v23, v55, v5
 s_waitcnt vmcnt(17)
 v_dot2c_f32_bf16 v16, v56, v4
 v_dot2c_f32_bf16 v17, v56, v5
 v_dot2c_f32_bf16 v18, v57, v4
 v_dot2c_f32_bf16 v19, v57, v5
 v_dot2c_f32_bf16 v20, v58, v4
 v_dot2c_f32_bf16 v21, v58, v5
 v_dot2c_f32_bf16 v22, v59, v4
 v_dot2c_f32_bf16 v23, v59, v5
 s_waitcnt vmcnt(16)
 v_dot2c_f32_bf16 v16, v60, v4
 v_dot2c_f32_bf16 v17, v60, v5
 v_dot2c_f32_bf16 v18, v61, v4
 v_dot2c_f32_bf16 v19, v61, v5
 v_dot2c_f32_bf16 v20, v62, v4
 v_dot2c_f32_bf16 v21, v62, v5
 v_dot2c_f32_bf16 v22, v63, v4
 v_dot2c_f32_bf16 v23, v63, v5
 v_cvt_pk_bf16_f32 v24, v16, v17
 v_cvt_pk_bf16_f32 v25, v18, v19
 v_cvt_pk_bf16_f32 v26, v20, v21
 v_cvt_pk_bf16_f32 v27, v22, v23
 s_add_u32 s33, s24, 0
 buffer_load_dwordx4 v[32:35], v15, s[4:7], s33 offen offset:3072 sc1
 s_add_u32 s33, s24, 65536
 buffer_load_dwordx4 v[36:39], v15, s[4:7], s33 offen offset:3072 sc1
 s_add_u32 s33, s24, 131072
 buffer_load_dwordx4 v[40:43], v15, s[4:7], s33 offen offset:3072 sc1
 s_add_u32 s33, s24, 196608
 buffer_load_dwordx4 v[44:47], v15, s[4:7], s33 offen offset:3072 sc1
 s_add_u32 s33, s24, 262144
 buffer_load_dwordx4 v[48:51], v15, s[4:7], s33 offen offset:3072 sc1
 s_add_u32 s33, s24, 327680
 buffer_load_dwordx4 v[52:55], v15, s[4:7], s33 offen offset:3072 sc1
 s_add_u32 s33, s24, 393216
 buffer_load_dwordx4 v[56:59], v15, s[4:7], s33 offen offset:3072 sc1
 s_add_u32 s33, s24, 458752
 buffer_load_dwordx4 v[60:63], v15, s[4:7], s33 offen offset:3072 sc1
 s_add_u32 s33, s24, 0
 buffer_store_dwordx4 v[24:27], v15, s[4:7], s33 offen offset:0 sc1
 s_waitcnt vmcnt(24)
 v_lshlrev_b32 v16, 16, v64
 v_and_b32 v17, 0xffff0000, v64
 v_lshlrev_b32 v18, 16, v65
 v_and_b32 v19, 0xffff0000, v65
 v_lshlrev_b32 v20, 16, v66
 v_and_b32 v21, 0xffff0000, v66
 v_lshlrev_b32 v22, 16, v67
 v_and_b32 v23, 0xffff0000, v67
 s_waitcnt vmcnt(23)
 v_dot2c_f32_bf16 v16, v68, v4
 v_dot2c_f32_bf16 v17, v68, v5
 v_dot2c_f32_bf16 v18, v69, v4
 v_dot2c_f32_bf16 v19, v69, v5
 v_dot2c_f32_bf16 v20, v70, v4
 v_dot2c_f32_bf16 v21, v70, v5
 v_dot2c_f32_bf16 v22, v71, v4
 v_dot2c_f32_bf16 v23, v71, v5
 s_waitcnt vmcnt(22)
 v_dot2c_f32_bf16 v16, v72, v4
 v_dot2c_f32_bf16 v17, v72, v5
 v_dot2c_f32_bf16 v18, v73, v4
 v_dot2c_f32_bf16 v19, v73, v5
 v_dot2c_f32_bf16 v20, v74, v4
 v_dot2c_f32_bf16 v21, v74, v5
 v_dot2c_f32_bf16 v22, v75, v4
 v_dot2c_f32_bf16 v23, v75, v5
 s_waitcnt vmcnt(21)
 v_dot2c_f32_bf16 v16, v76, v4
 v_dot2c_f32_bf16 v17, v76, v5
 v_dot2c_f32_bf16 v18, v77, v4
 v_dot2c_f32_bf16 v19, v77, v5
 v_dot2c_f32_bf16 v20, v78, v4
 v_dot2c_f32_bf16 v21, v78, v5
 v_dot2c_f32_bf16 v22, v79, v4
 v_dot2c_f32_bf16 v23, v79, v5
 s_waitcnt vmcnt(20)
 v_dot2c_f32_bf16 v16, v80, v4
 v_dot2c_f32_bf16 v17, v80, v5
 v_dot2c_f32_bf16 v18, v81, v4
 v_dot2c_f32_bf16 v19, v81, v5
 v_dot2c_f32_bf16 v20, v82, v4
 v_dot2c_f32_bf16 v21, v82, v5
 v_dot2c_f32_bf16 v22, v83, v4
 v_dot2c_f32_bf16 v23, v83, v5
 s_waitcnt vmcnt(19)
 v_dot2c_f32_bf16 v16, v84, v4
 v_dot2c_f32_bf16 v17, v84, v5
 v_dot2c_f32_bf16 v18, v85, v4
 v_dot2c_f32_bf16 v19, v85, v5
 v_dot2c_f32_bf16 v20, v86, v4
 v_dot2c_f32_bf16 v21, v86, v5
 v_dot2c_f32_bf16 v22, v87, v4
 v_dot2c_f32_bf16 v23, v87, v5
 s_waitcnt vmcnt(18)
 v_dot2c_f32_bf16 v16, v88, v4
 v_dot2c_f32_bf16 v17, v88, v5
 v_dot2c_f32_bf16 v18, v89, v4
 v_dot2c_f32_bf16 v19, v89, v5
 v_dot2c_f32_bf16 v20, v90, v4
 v_dot2c_f32_bf16 v21, v90, v5
 v_dot2c_f32_bf16 v22, v91, v4
 v_dot2c_f32_bf16 v23, v91, v5
 s_waitcnt vmcnt(17)
 v_dot2c_f32_bf16 v16, v92, v4
 v_dot2c_f32_bf16 v17, v92, v5
 v_dot2c_f32_bf16 v18, v93, v4
 v_dot2c_f32_bf16 v19, v93, v5
 v_dot2c_f32_bf16 v20, v94, v4
 v_dot2c_f32_bf16 v21, v94, v5
 v_dot2c_f32_bf16 v22, v95, v4
 v_dot2c_f32_bf16 v23, v95, v5
 v_cvt_pk_bf16_f32 v28, v16, v17
 v_cvt_pk_bf16_f32 v29, v18, v19
 v_cvt_pk_bf16_f32 v30, v20, v21
 v_cvt_pk_bf16_f32 v31, v22, v23
 s_add_u32 s33, s24, 4096
 buffer_load_dwordx4 v[64:67], v15, s[4:7], s33 offen offset:0 sc1
 s_add_u32 s33, s24, 69632
 buffer_load_dwordx4 v[68:71], v15, s[4:7], s33 offen offset:0 sc1
 s_add_u32 s33, s24, 135168
 buffer_load_dwordx4 v[72:75], v15, s[4:7], s33 offen offset:0 sc1
 s_add_u32 s33, s24, 200704
 buffer_load_dwordx4 v[76:79], v15, s[4:7], s33 offen offset:0 sc1
 s_add_u32 s33, s24, 266240
 buffer_load_dwordx4 v[80:83], v15, s[4:7], s33 offen offset:0 sc1
 s_add_u32 s33, s24, 331776
 buffer_load_dwordx4 v[84:87], v15, s[4:7], s33 offen offset:0 sc1
 s_add_u32 s33, s24, 397312
 buffer_load_dwordx4 v[88:91], v15, s[4:7], s33 offen offset:0 sc1
 s_add_u32 s33, s24, 462848
 buffer_load_dwordx4 v[92:95], v15, s[4:7], s33 offen offset:0 sc1
 s_add_u32 s33, s24, 0
 buffer_store_dwordx4 v[28:31], v15, s[4:7], s33 offen offset:1024 sc1
 s_waitcnt vmcnt(25)
 v_lshlrev_b32 v16, 16, v96
 v_and_b32 v17, 0xffff0000, v96
 v_lshlrev_b32 v18, 16, v97
 v_and_b32 v19, 0xffff0000, v97
 v_lshlrev_b32 v20, 16, v98
 v_and_b32 v21, 0xffff0000, v98
 v_lshlrev_b32 v22, 16, v99
 v_and_b32 v23, 0xffff0000, v99
 s_waitcnt vmcnt(24)
 v_dot2c_f32_bf16 v16, v100, v4
 v_dot2c_f32_bf16 v17, v100, v5
 v_dot2c_f32_bf16 v18, v101, v4
 v_dot2c_f32_bf16 v19, v101, v5
 v_dot2c_f32_bf16 v20, v102, v4
 v_dot2c_f32_bf16 v21, v102, v5
 v_dot2c_f32_bf16 v22, v103, v4
 v_dot2c_f32_bf16 v23, v103, v5
 s_waitcnt vmcnt(23)
 v_dot2c_f32_bf16 v16, v104, v4
 v_dot2c_f32_bf16 v17, v104, v5
 v_dot2c_f32_bf16 v18, v105, v4
 v_dot2c_f32_bf16 v19, v105, v5
 v_dot2c_f32_bf16 v20, v106, v4
 v_dot2c_f32_bf16 v21, v106, v5
 v_dot2c_f32_bf16 v22, v107, v4
 v_dot2c_f32_bf16 v23, v107, v5
 s_waitcnt vmcnt(22)
 v_dot2c_f32_bf16 v16, v108, v4
 v_dot2c_f32_bf16 v17, v108, v5
 v_dot2c_f32_bf16 v18, v109, v4
 v_dot2c_f32_bf16 v19, v109, v5
 v_dot2c_f32_bf16 v20, v110, v4
 v_dot2c_f32_bf16 v21, v110, v5
 v_dot2c_f32_bf16 v22, v111, v4
 v_dot2c_f32_bf16 v23, v111, v5
 s_waitcnt vmcnt(21)
 v_dot2c_f32_bf16 v16, v112, v4
 v_dot2c_f32_bf16 v17, v112, v5
 v_dot2c_f32_bf16 v18, v113, v4
 v_dot2c_f32_bf16 v19, v113, v5
 v_dot2c_f32_bf16 v20, v114, v4
 v_dot2c_f32_bf16 v21, v114, v5
 v_dot2c_f32_bf16 v22, v115, v4
 v_dot2c_f32_bf16 v23, v115, v5
 s_waitcnt vmcnt(20)
 v_dot2c_f32_bf16 v16, v116, v4
 v_dot2c_f32_bf16 v17, v116, v5
 v_dot2c_f32_bf16 v18, v117, v4
 v_dot2c_f32_bf16 v19, v117, v5
 v_dot2c_f32_bf16 v20, v118, v4
 v_dot2c_f32_bf16 v21, v118, v5
 v_dot2c_f32_bf16 v22, v119, v4
 v_dot2c_f32_bf16 v23, v119, v5
 s_waitcnt vmcnt(19)
 v_dot2c_f32_bf16 v16, v120, v4
 v_dot2c_f32_bf16 v17, v120, v5
 v_dot2c_f32_bf16 v18, v121, v4
 v_dot2c_f32_bf16 v19, v121, v5
 v_dot2c_f32_bf16 v20, v122, v4
 v_dot2c_f32_bf16 v21, v122, v5
 v_dot2c_f32_bf16 v22, v123, v4
 v_dot2c_f32_bf16 v23, v123, v5
 s_waitcnt vmcnt(18)
 v_dot2c_f32_bf16 v16, v124, v4
 v_dot2c_f32_bf16 v17, v124, v5
 v_dot2c_f32_bf16 v18, v125, v4
 v_dot2c_f32_bf16 v19, v125, v5
 v_dot2c_f32_bf16 v20, v126, v4
 v_dot2c_f32_bf16 v21, v126, v5
 v_dot2c_f32_bf16 v22, v127, v4
 v_dot2c_f32_bf16 v23, v127, v5
 v_cvt_pk_bf16_f32 v24, v16, v17
 v_cvt_pk_bf16_f32 v25, v18, v19
 v_cvt_pk_bf16_f32 v26, v20, v21
 v_cvt_pk_bf16_f32 v27, v22, v23
 s_add_u32 s33, s24, 4096
 buffer_load_dwordx4 v[96:99], v15, s[4:7], s33 offen offset:1024 sc1
 s_add_u32 s33, s24, 69632
 buffer_load_dwordx4 v[100:103], v15, s[4:7], s33 offen offset:1024 sc1
 s_add_u32 s33, s24, 135168
 buffer_load_dwordx4 v[104:107], v15, s[4:7], s33 offen offset:1024 sc1
 s_add_u32 s33, s24, 200704
 buffer_load_dwordx4 v[108:111], v15, s[4:7], s33 offen offset:1024 sc1
 s_add_u32 s33, s24, 266240
 buffer_load_dwordx4 v[112:115], v15, s[4:7], s33 offen offset:1024 sc1
 s_add_u32 s33, s24, 331776
 buffer_load_dwordx4 v[116:119], v15, s[4:7], s33 offen offset:1024 sc1
 s_add_u32 s33, s24, 397312
 buffer_load_dwordx4 v[120:123], v15, s[4:7], s33 offen offset:1024 sc1
 s_add_u32 s33, s24, 462848
 buffer_load_dwordx4 v[124:127], v15, s[4:7], s33 offen offset:1024 sc1
 s_add_u32 s33, s24, 0
 buffer_store_dwordx4 v[24:27], v15, s[4:7], s33 offen offset:2048 sc1
 s_waitcnt vmcnt(26)
 v_lshlrev_b32 v16, 16, v32
 v_and_b32 v17, 0xffff0000, v32
 v_lshlrev_b32 v18, 16, v33
 v_and_b32 v19, 0xffff0000, v33
 v_lshlrev_b32 v20, 16, v34
 v_and_b32 v21, 0xffff0000, v34
 v_lshlrev_b32 v22, 16, v35
 v_and_b32 v23, 0xffff0000, v35
 s_waitcnt vmcnt(25)
 v_dot2c_f32_bf16 v16, v36, v4
 v_dot2c_f32_bf16 v17, v36, v5
 v_dot2c_f32_bf16 v18, v37, v4
 v_dot2c_f32_bf16 v19, v37, v5
 v_dot2c_f32_bf16 v20, v38, v4
 v_dot2c_f32_bf16 v21, v38, v5
 v_dot2c_f32_bf16 v22, v39, v4
 v_dot2c_f32_bf16 v23, v39, v5
 s_waitcnt vmcnt(24)
 v_dot2c_f32_bf16 v16, v40, v4
 v_dot2c_f32_bf16 v17, v40, v5
 v_dot2c_f32_bf16 v18, v41, v4
 v_dot2c_f32_bf16 v19, v41, v5
 v_dot2c_f32_bf16 v20, v42, v4
 v_dot2c_f32_bf16 v21, v42, v5
 v_dot2c_f32_bf16 v22, v43, v4
 v_dot2c_f32_bf16 v23, v43, v5
 s_waitcnt vmcnt(23)
 v_dot2c_f32_bf16 v16, v44, v4
 v_dot2c_f32_bf16 v17, v44, v5
 v_dot2c_f32_bf16 v18, v45, v4
 v_dot2c_f32_bf16 v19, v45, v5
 v_dot2c_f32_bf16 v20, v46, v4
 v_dot2c_f32_bf16 v21, v46, v5
 v_dot2c_f32_bf16 v22, v47, v4
 v_dot2c_f32_bf16 v23, v47, v5
 s_waitcnt vmcnt(22)
 v_dot2c_f32_bf16 v16, v48, v4
 v_dot2c_f32_bf16 v17, v48, v5
 v_dot2c_f32_bf16 v18, v49, v4
 v_dot2c_f32_bf16 v19, v49, v5
 v_dot2c_f32_bf16 v20, v50, v4
 v_dot2c_f32_bf16 v21, v50, v5
 v_dot2c_f32_bf16 v22, v51, v4
 v_dot2c_f32_bf16 v23, v51, v5
 s_waitcnt vmcnt(21)
 v_dot2c_f32_bf16 v16, v52, v4
 v_dot2c_f32_bf16 v17, v52, v5
 v_dot2c_f32_bf16 v18, v53, v4
 v_dot2c_f32_bf16 v19, v53, v5
 v_dot2c_f32_bf16 v20, v54, v4
 v_dot2c_f32_bf16 v21, v54, v5
 v_dot2c_f32_bf16 v22, v55, v4
 v_dot2c_f32_bf16 v23, v55, v5
 s_waitcnt vmcnt(20)
 v_dot2c_f32_bf16 v16, v56, v4
 v_dot2c_f32_bf16 v17, v56, v5
 v_dot2c_f32_bf16 v18, v57, v4
 v_dot2c_f32_bf16 v19, v57, v5
 v_dot2c_f32_bf16 v20, v58, v4
 v_dot2c_f32_bf16 v21, v58, v5
 v_dot2c_f32_bf16 v22, v59, v4
 v_dot2c_f32_bf16 v23, v59, v5
 s_waitcnt vmcnt(19)
 v_dot2c_f32_bf16 v16, v60, v4
 v_dot2c_f32_bf16 v17, v60, v5
 v_dot2c_f32_bf16 v18, v61, v4
 v_dot2c_f32_bf16 v19, v61, v5
 v_dot2c_f32_bf16 v20, v62, v4
 v_dot2c_f32_bf16 v21, v62, v5
 v_dot2c_f32_bf16 v22, v63, v4
 v_dot2c_f32_bf16 v23, v63, v5
 v_cvt_pk_bf16_f32 v28, v16, v17
 v_cvt_pk_bf16_f32 v29, v18, v19
 v_cvt_pk_bf16_f32 v30, v20, v21
 v_cvt_pk_bf16_f32 v31, v22, v23
 s_add_u32 s33, s24, 4096
 buffer_load_dwordx4 v[32:35], v15, s[4:7], s33 offen offset:2048 sc1
 s_add_u32 s33, s24, 69632
 buffer_load_dwordx4 v[36:39], v15, s[4:7], s33 offen offset:2048 sc1
 s_add_u32 s33, s24, 135168
 buffer_load_dwordx4 v[40:43], v15, s[4:7], s33 offen offset:2048 sc1
 s_add_u32 s33, s24, 200704
 buffer_load_dwordx4 v[44:47], v15, s[4:7], s33 offen offset:2048 sc1
 s_add_u32 s33, s24, 266240
 buffer_load_dwordx4 v[48:51], v15, s[4:7], s33 offen offset:2048 sc1
 s_add_u32 s33, s24, 331776
 buffer_load_dwordx4 v[52:55], v15, s[4:7], s33 offen offset:2048 sc1
 s_add_u32 s33, s24, 397312
 buffer_load_dwordx4 v[56:59], v15, s[4:7], s33 offen offset:2048 sc1
 s_add_u32 s33, s24, 462848
 buffer_load_dwordx4 v[60:63], v15, s[4:7], s33 offen offset:2048 sc1
 s_add_u32 s33, s24, 0
 buffer_store_dwordx4 v[28:31], v15, s[4:7], s33 offen offset:3072 sc1
 s_waitcnt vmcnt(26)
 v_lshlrev_b32 v16, 16, v64
 v_and_b32 v17, 0xffff0000, v64
 v_lshlrev_b32 v18, 16, v65
 v_and_b32 v19, 0xffff0000, v65
 v_lshlrev_b32 v20, 16, v66
 v_and_b32 v21, 0xffff0000, v66
 v_lshlrev_b32 v22, 16, v67
 v_and_b32 v23, 0xffff0000, v67
 s_waitcnt vmcnt(25)
 v_dot2c_f32_bf16 v16, v68, v4
 v_dot2c_f32_bf16 v17, v68, v5
 v_dot2c_f32_bf16 v18, v69, v4
 v_dot2c_f32_bf16 v19, v69, v5
 v_dot2c_f32_bf16 v20, v70, v4
 v_dot2c_f32_bf16 v21, v70, v5
 v_dot2c_f32_bf16 v22, v71, v4
 v_dot2c_f32_bf16 v23, v71, v5
 s_waitcnt vmcnt(24)
 v_dot2c_f32_bf16 v16, v72, v4
 v_dot2c_f32_bf16 v17, v72, v5
 v_dot2c_f32_bf16 v18, v73, v4
 v_dot2c_f32_bf16 v19, v73, v5
 v_dot2c_f32_bf16 v20, v74, v4
 v_dot2c_f32_bf16 v21, v74, v5
 v_dot2c_f32_bf16 v22, v75, v4
 v_dot2c_f32_bf16 v23, v75, v5
 s_waitcnt vmcnt(23)
 v_dot2c_f32_bf16 v16, v76, v4
 v_dot2c_f32_bf16 v17, v76, v5
 v_dot2c_f32_bf16 v18, v77, v4
 v_dot2c_f32_bf16 v19, v77, v5
 v_dot2c_f32_bf16 v20, v78, v4
 v_dot2c_f32_bf16 v21, v78, v5
 v_dot2c_f32_bf16 v22, v79, v4
 v_dot2c_f32_bf16 v23, v79, v5
 s_waitcnt vmcnt(22)
 v_dot2c_f32_bf16 v16, v80, v4
 v_dot2c_f32_bf16 v17, v80, v5
 v_dot2c_f32_bf16 v18, v81, v4
 v_dot2c_f32_bf16 v19, v81, v5
 v_dot2c_f32_bf16 v20, v82, v4
 v_dot2c_f32_bf16 v21, v82, v5
 v_dot2c_f32_bf16 v22, v83, v4
 v_dot2c_f32_bf16 v23, v83, v5
 s_waitcnt vmcnt(21)
 v_dot2c_f32_bf16 v16, v84, v4
 v_dot2c_f32_bf16 v17, v84, v5
 v_dot2c_f32_bf16 v18, v85, v4
 v_dot2c_f32_bf16 v19, v85, v5
 v_dot2c_f32_bf16 v20, v86, v4
 v_dot2c_f32_bf16 v21, v86, v5
 v_dot2c_f32_bf16 v22, v87, v4
 v_dot2c_f32_bf16 v23, v87, v5
 s_waitcnt vmcnt(20)
 v_dot2c_f32_bf16 v16, v88, v4
 v_dot2c_f32_bf16 v17, v88, v5
 v_dot2c_f32_bf16 v18, v89, v4
 v_dot2c_f32_bf16 v19, v89, v5
 v_dot2c_f32_bf16 v20, v90, v4
 v_dot2c_f32_bf16 v21, v90, v5
 v_dot2c_f32_bf16 v22, v91, v4
 v_dot2c_f32_bf16 v23, v91, v5
 s_waitcnt vmcnt(19)
 v_dot2c_f32_bf16 v16, v92, v4
 v_dot2c_f32_bf16 v17, v92, v5
 v_dot2c_f32_bf16 v18, v93, v4
 v_dot2c_f32_bf16 v19, v93, v5
 v_dot2c_f32_bf16 v20, v94, v4
 v_dot2c_f32_bf16 v21, v94, v5
 v_dot2c_f32_bf16 v22, v95, v4
 v_dot2c_f32_bf16 v23, v95, v5
 v_cvt_pk_bf16_f32 v24, v16, v17
 v_cvt_pk_bf16_f32 v25, v18, v19
 v_cvt_pk_bf16_f32 v26, v20, v21
 v_cvt_pk_bf16_f32 v27, v22, v23
 s_add_u32 s33, s24, 4096
 buffer_load_dwordx4 v[64:67], v15, s[4:7], s33 offen offset:3072 sc1
 s_add_u32 s33, s24, 69632
 buffer_load_dwordx4 v[68:71], v15, s[4:7], s33 offen offset:3072 sc1
 s_add_u32 s33, s24, 135168
 buffer_load_dwordx4 v[72:75], v15, s[4:7], s33 offen offset:3072 sc1
 s_add_u32 s33, s24, 200704
 buffer_load_dwordx4 v[76:79], v15, s[4:7], s33 offen offset:3072 sc1
 s_add_u32 s33, s24, 266240
 buffer_load_dwordx4 v[80:83], v15, s[4:7], s33 offen offset:3072 sc1
 s_add_u32 s33, s24, 331776
 buffer_load_dwordx4 v[84:87], v15, s[4:7], s33 offen offset:3072 sc1
 s_add_u32 s33, s24, 397312
 buffer_load_dwordx4 v[88:91], v15, s[4:7], s33 offen offset:3072 sc1
 s_add_u32 s33, s24, 462848
 buffer_load_dwordx4 v[92:95], v15, s[4:7], s33 offen offset:3072 sc1
 s_add_u32 s33, s24, 4096
 buffer_store_dwordx4 v[24:27], v15, s[4:7], s33 offen offset:0 sc1
 s_waitcnt vmcnt(26)
 v_lshlrev_b32 v16, 16, v96
 v_and_b32 v17, 0xffff0000, v96
 v_lshlrev_b32 v18, 16, v97
 v_and_b32 v19, 0xffff0000, v97
 v_lshlrev_b32 v20, 16, v98
 v_and_b32 v21, 0xffff0000, v98
 v_lshlrev_b32 v22, 16, v99
 v_and_b32 v23, 0xffff0000, v99
 s_waitcnt vmcnt(25)
 v_dot2c_f32_bf16 v16, v100, v4
 v_dot2c_f32_bf16 v17, v100, v5
 v_dot2c_f32_bf16 v18, v101, v4
 v_dot2c_f32_bf16 v19, v101, v5
 v_dot2c_f32_bf16 v20, v102, v4
 v_dot2c_f32_bf16 v21, v102, v5
 v_dot2c_f32_bf16 v22, v103, v4
 v_dot2c_f32_bf16 v23, v103, v5
 s_waitcnt vmcnt(24)
 v_dot2c_f32_bf16 v16, v104, v4
 v_dot2c_f32_bf16 v17, v104, v5
 v_dot2c_f32_bf16 v18, v105, v4
 v_dot2c_f32_bf16 v19, v105, v5
 v_dot2c_f32_bf16 v20, v106, v4
 v_dot2c_f32_bf16 v21, v106, v5
 v_dot2c_f32_bf16 v22, v107, v4
 v_dot2c_f32_bf16 v23, v107, v5
 s_waitcnt vmcnt(23)
 v_dot2c_f32_bf16 v16, v108, v4
 v_dot2c_f32_bf16 v17, v108, v5
 v_dot2c_f32_bf16 v18, v109, v4
 v_dot2c_f32_bf16 v19, v109, v5
 v_dot2c_f32_bf16 v20, v110, v4
 v_dot2c_f32_bf16 v21, v110, v5
 v_dot2c_f32_bf16 v22, v111, v4
 v_dot2c_f32_bf16 v23, v111, v5
 s_waitcnt vmcnt(22)
 v_dot2c_f32_bf16 v16, v112, v4
 v_dot2c_f32_bf16 v17, v112, v5
 v_dot2c_f32_bf16 v18, v113, v4
 v_dot2c_f32_bf16 v19, v113, v5
 v_dot2c_f32_bf16 v20, v114, v4
 v_dot2c_f32_bf16 v21, v114, v5
 v_dot2c_f32_bf16 v22, v115, v4
 v_dot2c_f32_bf16 v23, v115, v5
 s_waitcnt vmcnt(21)
 v_dot2c_f32_bf16 v16, v116, v4
 v_dot2c_f32_bf16 v17, v116, v5
 v_dot2c_f32_bf16 v18, v117, v4
 v_dot2c_f32_bf16 v19, v117, v5
 v_dot2c_f32_bf16 v20, v118, v4
 v_dot2c_f32_bf16 v21, v118, v5
 v_dot2c_f32_bf16 v22, v119, v4
 v_dot2c_f32_bf16 v23, v119, v5
 s_waitcnt vmcnt(20)
 v_dot2c_f32_bf16 v16, v120, v4
 v_dot2c_f32_bf16 v17, v120, v5
 v_dot2c_f32_bf16 v18, v121, v4
 v_dot2c_f32_bf16 v19, v121, v5
 v_dot2c_f32_bf16 v20, v122, v4
 v_dot2c_f32_bf16 v21, v122, v5
 v_dot2c_f32_bf16 v22, v123, v4
 v_dot2c_f32_bf16 v23, v123, v5
 s_waitcnt vmcnt(19)
 v_dot2c_f32_bf16 v16, v124, v4
 v_dot2c_f32_bf16 v17, v124, v5
 v_dot2c_f32_bf16 v18, v125, v4
 v_dot2c_f32_bf16 v19, v125, v5
 v_dot2c_f32_bf16 v20, v126, v4
 v_dot2c_f32_bf16 v21, v126, v5
 v_dot2c_f32_bf16 v22, v127, v4
 v_dot2c_f32_bf16 v23, v127, v5
 v_cvt_pk_bf16_f32 v28, v16, v17
 v_cvt_pk_bf16_f32 v29, v18, v19
 v_cvt_pk_bf16_f32 v30, v20, v21
 v_cvt_pk_bf16_f32 v31, v22, v23
 s_add_u32 s33, s24, 4096
 buffer_store_dwordx4 v[28:31], v15, s[4:7], s33 offen offset:1024 sc1
 s_waitcnt vmcnt(18)
 v_lshlrev_b32 v16, 16, v32
 v_and_b32 v17, 0xffff0000, v32
 v_lshlrev_b32 v18, 16, v33
 v_and_b32 v19, 0xffff0000, v33
 v_lshlrev_b32 v20, 16, v34
 v_and_b32 v21, 0xffff0000, v34
 v_lshlrev_b32 v22, 16, v35
 v_and_b32 v23, 0xffff0000, v35
 s_waitcnt vmcnt(17)
 v_dot2c_f32_bf16 v16, v36, v4
 v_dot2c_f32_bf16 v17, v36, v5
 v_dot2c_f32_bf16 v18, v37, v4
 v_dot2c_f32_bf16 v19, v37, v5
 v_dot2c_f32_bf16 v20, v38, v4
 v_dot2c_f32_bf16 v21, v38, v5
 v_dot2c_f32_bf16 v22, v39, v4
 v_dot2c_f32_bf16 v23, v39, v5
 s_waitcnt vmcnt(16)
 v_dot2c_f32_bf16 v16, v40, v4
 v_dot2c_f32_bf16 v17, v40, v5
 v_dot2c_f32_bf16 v18, v41, v4
 v_dot2c_f32_bf16 v19, v41, v5
 v_dot2c_f32_bf16 v20, v42, v4
 v_dot2c_f32_bf16 v21, v42, v5
 v_dot2c_f32_bf16 v22, v43, v4
 v_dot2c_f32_bf16 v23, v43, v5
 s_waitcnt vmcnt(15)
 v_dot2c_f32_bf16 v16, v44, v4
 v_dot2c_f32_bf16 v17, v44, v5
 v_dot2c_f32_bf16 v18, v45, v4
 v_dot2c_f32_bf16 v19, v45, v5
 v_dot2c_f32_bf16 v20, v46, v4
 v_dot2c_f32_bf16 v21, v46, v5
 v_dot2c_f32_bf16 v22, v47, v4
 v_dot2c_f32_bf16 v23, v47, v5
 s_waitcnt vmcnt(14)
 v_dot2c_f32_bf16 v16, v48, v4
 v_dot2c_f32_bf16 v17, v48, v5
 v_dot2c_f32_bf16 v18, v49, v4
 v_dot2c_f32_bf16 v19, v49, v5
 v_dot2c_f32_bf16 v20, v50, v4
 v_dot2c_f32_bf16 v21, v50, v5
 v_dot2c_f32_bf16 v22, v51, v4
 v_dot2c_f32_bf16 v23, v51, v5
 s_waitcnt vmcnt(13)
 v_dot2c_f32_bf16 v16, v52, v4
 v_dot2c_f32_bf16 v17, v52, v5
 v_dot2c_f32_bf16 v18, v53, v4
 v_dot2c_f32_bf16 v19, v53, v5
 v_dot2c_f32_bf16 v20, v54, v4
 v_dot2c_f32_bf16 v21, v54, v5
 v_dot2c_f32_bf16 v22, v55, v4
 v_dot2c_f32_bf16 v23, v55, v5
 s_waitcnt vmcnt(12)
 v_dot2c_f32_bf16 v16, v56, v4
 v_dot2c_f32_bf16 v17, v56, v5
 v_dot2c_f32_bf16 v18, v57, v4
 v_dot2c_f32_bf16 v19, v57, v5
 v_dot2c_f32_bf16 v20, v58, v4
 v_dot2c_f32_bf16 v21, v58, v5
 v_dot2c_f32_bf16 v22, v59, v4
 v_dot2c_f32_bf16 v23, v59, v5
 s_waitcnt vmcnt(11)
 v_dot2c_f32_bf16 v16, v60, v4
 v_dot2c_f32_bf16 v17, v60, v5
 v_dot2c_f32_bf16 v18, v61, v4
 v_dot2c_f32_bf16 v19, v61, v5
 v_dot2c_f32_bf16 v20, v62, v4
 v_dot2c_f32_bf16 v21, v62, v5
 v_dot2c_f32_bf16 v22, v63, v4
 v_dot2c_f32_bf16 v23, v63, v5
 v_cvt_pk_bf16_f32 v24, v16, v17
 v_cvt_pk_bf16_f32 v25, v18, v19
 v_cvt_pk_bf16_f32 v26, v20, v21
 v_cvt_pk_bf16_f32 v27, v22, v23
 s_add_u32 s33, s24, 4096
 buffer_store_dwordx4 v[24:27], v15, s[4:7], s33 offen offset:2048 sc1
 s_waitcnt vmcnt(10)
 v_lshlrev_b32 v16, 16, v64
 v_and_b32 v17, 0xffff0000, v64
 v_lshlrev_b32 v18, 16, v65
 v_and_b32 v19, 0xffff0000, v65
 v_lshlrev_b32 v20, 16, v66
 v_and_b32 v21, 0xffff0000, v66
 v_lshlrev_b32 v22, 16, v67
 v_and_b32 v23, 0xffff0000, v67
 s_waitcnt vmcnt(9)
 v_dot2c_f32_bf16 v16, v68, v4
 v_dot2c_f32_bf16 v17, v68, v5
 v_dot2c_f32_bf16 v18, v69, v4
 v_dot2c_f32_bf16 v19, v69, v5
 v_dot2c_f32_bf16 v20, v70, v4
 v_dot2c_f32_bf16 v21, v70, v5
 v_dot2c_f32_bf16 v22, v71, v4
 v_dot2c_f32_bf16 v23, v71, v5
 s_waitcnt vmcnt(8)
 v_dot2c_f32_bf16 v16, v72, v4
 v_dot2c_f32_bf16 v17, v72, v5
 v_dot2c_f32_bf16 v18, v73, v4
 v_dot2c_f32_bf16 v19, v73, v5
 v_dot2c_f32_bf16 v20, v74, v4
 v_dot2c_f32_bf16 v21, v74, v5
 v_dot2c_f32_bf16 v22, v75, v4
 v_dot2c_f32_bf16 v23, v75, v5
 s_waitcnt vmcnt(7)
 v_dot2c_f32_bf16 v16, v76, v4
 v_dot2c_f32_bf16 v17, v76, v5
 v_dot2c_f32_bf16 v18, v77, v4
 v_dot2c_f32_bf16 v19, v77, v5
 v_dot2c_f32_bf16 v20, v78, v4
 v_dot2c_f32_bf16 v21, v78, v5
 v_dot2c_f32_bf16 v22, v79, v4
 v_dot2c_f32_bf16 v23, v79, v5
 s_waitcnt vmcnt(6)
 v_dot2c_f32_bf16 v16, v80, v4
 v_dot2c_f32_bf16 v17, v80, v5
 v_dot2c_f32_bf16 v18, v81, v4
 v_dot2c_f32_bf16 v19, v81, v5
 v_dot2c_f32_bf16 v20, v82, v4
 v_dot2c_f32_bf16 v21, v82, v5
 v_dot2c_f32_bf16 v22, v83, v4
 v_dot2c_f32_bf16 v23, v83, v5
 s_waitcnt vmcnt(5)
 v_dot2c_f32_bf16 v16, v84, v4
 v_dot2c_f32_bf16 v17, v84, v5
 v_dot2c_f32_bf16 v18, v85, v4
 v_dot2c_f32_bf16 v19, v85, v5
 v_dot2c_f32_bf16 v20, v86, v4
 v_dot2c_f32_bf16 v21, v86, v5
 v_dot2c_f32_bf16 v22, v87, v4
 v_dot2c_f32_bf16 v23, v87, v5
 s_waitcnt vmcnt(4)
 v_dot2c_f32_bf16 v16, v88, v4
 v_dot2c_f32_bf16 v17, v88, v5
 v_dot2c_f32_bf16 v18, v89, v4
 v_dot2c_f32_bf16 v19, v89, v5
 v_dot2c_f32_bf16 v20, v90, v4
 v_dot2c_f32_bf16 v21, v90, v5
 v_dot2c_f32_bf16 v22, v91, v4
 v_dot2c_f32_bf16 v23, v91, v5
 s_waitcnt vmcnt(3)
 v_dot2c_f32_bf16 v16, v92, v4
 v_dot2c_f32_bf16 v17, v92, v5
 v_dot2c_f32_bf16 v18, v93, v4
 v_dot2c_f32_bf16 v19, v93, v5
 v_dot2c_f32_bf16 v20, v94, v4
 v_dot2c_f32_bf16 v21, v94, v5
 v_dot2c_f32_bf16 v22, v95, v4
 v_dot2c_f32_bf16 v23, v95, v5
 v_cvt_pk_bf16_f32 v28, v16, v17
 v_cvt_pk_bf16_f32 v29, v18, v19
 v_cvt_pk_bf16_f32 v30, v20, v21
 v_cvt_pk_bf16_f32 v31, v22, v23
 s_add_u32 s33, s24, 4096
 buffer_store_dwordx4 v[28:31], v15, s[4:7], s33 offen offset:3072 sc1
 s_lshl_b32 s36, s12, 7
 s_add_u32 s36, s36, 2252800
 s_branch L_next
L_op:
 s_lshl_b32 s33, s12, 7
 s_add_u32 s33, s33, 2252800
 v_lshlrev_b32 v15, 4, v0
 v_lshrrev_b32 v4, 3, v0
 v_and_b32 v5, 7, v0
 v_bfe_u32 v6, v0, 4, 1
 v_lshlrev_b32 v6, 2, v6
 v_xor_b32 v5, v5, v6
 v_lshlrev_b32 v7, 11, v4
 v_lshl_add_u32 v7, v5, 4, v7
 v_add_u32 v8, 15360, v7
 v_mov_b32 v2, s33
 v_mov_b32 v3, 22
 s_load_dwordx2 s[20:21], s[0:1], 32
 s_mov_b32 s22, 2097152
 s_mov_b32 s23, 0x20000
 s_load_dwordx2 s[44:45], s[0:1], 104
 s_mov_b32 s46, 4194304
 s_mov_b32 s47, 0x20000
 s_lshl_b32 s30, s14, 14
 s_lshl_b32 s26, s14, 18
 s_add_u32 s26, s26, s25
 s_waitcnt lgkmcnt(0)
 s_add_u32 m0, s30, 0
 s_nop 0
 buffer_load_dwordx4 v7, s[20:23], s26 offen lds
 buffer_load_dwordx4 v8, s[20:23], s26 offen offset:1024 lds
 s_add_u32 s26, s26, 32768
 s_add_u32 m0, s30, 2048
 s_nop 0
 buffer_load_dwordx4 v7, s[20:23], s26 offen lds
 buffer_load_dwordx4 v8, s[20:23], s26 offen offset:1024 lds
 s_add_u32 s26, s26, 32768
 s_add_u32 m0, s30, 4096
 s_nop 0
 buffer_load_dwordx4 v7, s[20:23], s26 offen lds
 buffer_load_dwordx4 v8, s[20:23], s26 offen offset:1024 lds
 s_add_u32 s26, s26, 32768
 s_add_u32 m0, s30, 6144
 s_nop 0
 buffer_load_dwordx4 v7, s[20:23], s26 offen lds
 buffer_load_dwordx4 v8, s[20:23], s26 offen offset:1024 lds
 s_add_u32 s26, s26, 32768
 s_add_u32 m0, s30, 8192
 s_nop 0
 buffer_load_dwordx4 v7, s[20:23], s26 offen lds
 buffer_load_dwordx4 v8, s[20:23], s26 offen offset:1024 lds
 s_add_u32 s26, s26, 32768
 s_add_u32 m0, s30, 10240
 s_nop 0
 buffer_load_dwordx4 v7, s[20:23], s26 offen lds
 buffer_load_dwordx4 v8, s[20:23], s26 offen offset:1024 lds
 s_add_u32 s26, s26, 32768
 s_add_u32 m0, s30, 12288
 s_nop 0
 buffer_load_dwordx4 v7, s[20:23], s26 offen lds
 buffer_load_dwordx4 v8, s[20:23], s26 offen offset:1024 lds
 s_add_u32 s26, s26, 32768
 s_add_u32 m0, s30, 14336
 s_nop 0
 buffer_load_dwordx4 v7, s[20:23], s26 offen lds
 buffer_load_dwordx4 v8, s[20:23], s26 offen offset:1024 lds
 s_add_u32 s26, s26, 32768
 v_bfe_u32 v4, v0, 2, 2
 v_lshrrev_b32 v5, 5, v0
 v_lshl_add_u32 v5, v5, 2, v4
 v_lshlrev_b32 v5, 7, v5
 v_and_b32 v6, 1, v0
 v_lshl_add_u32 v5, v6, 3, v5
 v_bfe_u32 v6, v0, 4, 1
 v_bfe_u32 v7, v0, 1, 1
 v_lshl_add_u32 v6, v6, 1, v7
 v_lshrrev_b32 v4, 1, v4
 v_lshl_add_u32 v6, v4, 2, v6
 v_lshl_add_u32 v4, v6, 4, v5
 v_xor_b32 v5, 64, v4
 v_add_u32 v6, 65536, v4
 v_add_u32 v7, 65536, v5
 s_lshl_b32 s34, s14, 3
 s_add_u32 s34, s34, s12
 s_lshl_b32 s34, s34, 16
 s_add_u32 s34, s34, 117440512
 s_cmp_ge_u32 s40, 2
 s_cbranch_scc1 L_pf1
 s_and_b32 s33, s12, 1
 s_lshl_b32 s33, s33, 1
 s_add_u32 s33, s33, s40
 s_lshl_b32 s33, s33, 3
 s_add_u32 s33, s33, s14
 s_lshl_b32 s33, s33, 16
 s_mov_b32 s26, 16
L_pf0:
 buffer_load_dwordx4 v[32:35], v15, s[20:23], s33 offen
 buffer_load_dwordx4 v[32:35], v15, s[20:23], s33 offen offset:1024
 buffer_load_dwordx4 v[32:35], v15, s[20:23], s33 offen offset:2048
 buffer_load_dwordx4 v[32:35], v15, s[20:23], s33 offen offset:3072
 s_add_u32 s33, s33, 4096
 s_sub_u32 s26, s26, 1
 s_cmp_lg_u32 s26, 0
 s_waitcnt vmcnt(16)
 s_cbranch_scc1 L_pf0
L_pf1:
 s_cmp_lg_u32 s14, 0
 s_cbranch_scc1 L_wf2O
 s_mov_b64 exec, 1
L_wfO:
 buffer_load_dword v1, v2, s[4:7], 0 offen sc1
 s_waitcnt vmcnt(0)
 v_cmp_lt_u32 vcc, v1, v3
 s_cbranch_vccz L_wf1O
 s_add_u32 s61, s61, 1
 s_cmp_gt_u32 s61, 2000000
 s_cbranch_scc1 L_wf1O
 s_sleep 4
 s_branch L_wfO
L_wf1O:
 s_mov_b64 exec, -1
L_wf2O:
 s_barrier
 buffer_load_dwordx4 v[32:35], v15, s[4:7], s34 offen offset:0 sc1
 buffer_load_dwordx4 v[36:39], v15, s[4:7], s34 offen offset:1024 sc1
 buffer_load_dwordx4 v[40:43], v15, s[4:7], s34 offen offset:2048 sc1
 buffer_load_dwordx4 v[44:47], v15, s[4:7], s34 offen offset:3072 sc1
 s_add_u32 s34, s34, 4096
 buffer_load_dwordx4 v[48:51], v15, s[4:7], s34 offen offset:0 sc1
 buffer_load_dwordx4 v[52:55], v15, s[4:7], s34 offen offset:1024 sc1
 buffer_load_dwordx4 v[56:59], v15, s[4:7], s34 offen offset:2048 sc1
 buffer_load_dwordx4 v[60:63], v15, s[4:7], s34 offen offset:3072 sc1
 s_add_u32 s34, s34, 4096
 buffer_load_dwordx4 v[64:67], v15, s[4:7], s34 offen offset:0 sc1
 buffer_load_dwordx4 v[68:71], v15, s[4:7], s34 offen offset:1024 sc1
 s_waitcnt vmcnt(10)
 s_barrier
 ds_read_b64_tr_b16 v[16:17], v4 offset:0
 ds_read_b64_tr_b16 v[18:19], v4 offset:1024
 ds_read_b64_tr_b16 v[20:21], v5 offset:0
 ds_read_b64_tr_b16 v[22:23], v5 offset:1024
 s_waitcnt vmcnt(9) lgkmcnt(2)
 v_mfma_f32_32x32x16_bf16 a[0:15], v[16:19], v[32:35], 0
 ds_read_b64_tr_b16 v[24:25], v4 offset:2048
 ds_read_b64_tr_b16 v[26:27], v4 offset:3072
 s_waitcnt lgkmcnt(2)
 v_mfma_f32_32x32x16_bf16 a[16:31], v[20:23], v[32:35], 0
 ds_read_b64_tr_b16 v[28:29], v5 offset:2048
 ds_read_b64_tr_b16 v[30:31], v5 offset:3072
 buffer_load_dwordx4 v[72:75], v15, s[4:7], s34 offen offset:2048 sc1
 s_waitcnt vmcnt(9) lgkmcnt(2)
 v_mfma_f32_32x32x16_bf16 a[0:15], v[24:27], v[36:39], a[0:15]
 ds_read_b64_tr_b16 v[16:17], v4 offset:4096
 ds_read_b64_tr_b16 v[18:19], v4 offset:5120
 s_waitcnt lgkmcnt(2)
 v_mfma_f32_32x32x16_bf16 a[16:31], v[28:31], v[36:39], a[16:31]
 ds_read_b64_tr_b16 v[20:21], v5 offset:4096
 ds_read_b64_tr_b16 v[22:23], v5 offset:5120
 buffer_load_dwordx4 v[76:79], v15, s[4:7], s34 offen offset:3072 sc1
 s_add_u32 s34, s34, 4096
 s_waitcnt vmcnt(9) lgkmcnt(2)
 v_mfma_f32_32x32x16_bf16 a[0:15], v[16:19], v[40:43], a[0:15]
 ds_read_b64_tr_b16 v[24:25], v4 offset:6144
 ds_read_b64_tr_b16 v[26:27], v4 offset:7168
 s_waitcnt lgkmcnt(2)
 v_mfma_f32_32x32x16_bf16 a[16:31], v[20:23], v[40:43], a[16:31]
 ds_read_b64_tr_b16 v[28:29], v5 offset:6144
 ds_read_b64_tr_b16 v[30:31], v5 offset:7168
 buffer_load_dwordx4 v[80:83], v15, s[4:7], s34 offen offset:0 sc1
 s_waitcnt vmcnt(9) lgkmcnt(2)
 v_mfma_f32_32x32x16_bf16 a[0:15], v[24:27], v[44:47], a[0:15]
 ds_read_b64_tr_b16 v[16:17], v4 offset:8192
 ds_read_b64_tr_b16 v[18:19], v4 offset:9216
 s_waitcnt lgkmcnt(2)
 v_mfma_f32_32x32x16_bf16 a[16:31], v[28:31], v[44:47], a[16:31]
 ds_read_b64_tr_b16 v[20:21], v5 offset:8192
 ds_read_b64_tr_b16 v[22:23], v5 offset:9216
 buffer_load_dwordx4 v[84:87], v15, s[4:7], s34 offen offset:1024 sc1
 s_waitcnt vmcnt(9) lgkmcnt(2)
 v_mfma_f32_32x32x16_bf16 a[0:15], v[16:19], v[48:51], a[0:15]
 ds_read_b64_tr_b16 v[24:25], v4 offset:10240
 ds_read_b64_tr_b16 v[26:27], v4 offset:11264
 s_waitcnt lgkmcnt(2)
 v_mfma_f32_32x32x16_bf16 a[16:31], v[20:23], v[48:51], a[16:31]
 ds_read_b64_tr_b16 v[28:29], v5 offset:10240
 ds_read_b64_tr_b16 v[30:31], v5 offset:11264
 buffer_load_dwordx4 v[88:91], v15, s[4:7], s34 offen offset:2048 sc1
 s_waitcnt vmcnt(9) lgkmcnt(2)
 v_mfma_f32_32x32x16_bf16 a[0:15], v[24:27], v[52:55], a[0:15]
 ds_read_b64_tr_b16 v[16:17], v4 offset:12288
 ds_read_b64_tr_b16 v[18:19], v4 offset:13312
 s_waitcnt lgkmcnt(2)
 v_mfma_f32_32x32x16_bf16 a[16:31], v[28:31], v[52:55], a[16:31]
 ds_read_b64_tr_b16 v[20:21], v5 offset:12288
 ds_read_b64_tr_b16 v[22:23], v5 offset:13312
 buffer_load_dwordx4 v[92:95], v15, s[4:7], s34 offen offset:3072 sc1
 s_add_u32 s34, s34, 4096
 s_waitcnt vmcnt(9) lgkmcnt(2)
 v_mfma_f32_32x32x16_bf16 a[0:15], v[16:19], v[56:59], a[0:15]
 ds_read_b64_tr_b16 v[24:25], v4 offset:14336
 ds_read_b64_tr_b16 v[26:27], v4 offset:15360
 s_waitcnt lgkmcnt(2)
 v_mfma_f32_32x32x16_bf16 a[16:31], v[20:23], v[56:59], a[16:31]
 ds_read_b64_tr_b16 v[28:29], v5 offset:14336
 ds_read_b64_tr_b16 v[30:31], v5 offset:15360
 buffer_load_dwordx4 v[96:99], v15, s[4:7], s34 offen offset:0 sc1
 s_waitcnt vmcnt(9) lgkmcnt(2)
 v_mfma_f32_32x32x16_bf16 a[0:15], v[24:27], v[60:63], a[0:15]
 ds_read_b64_tr_b16 v[16:17], v4 offset:16384
 ds_read_b64_tr_b16 v[18:19], v4 offset:17408
 s_waitcnt lgkmcnt(2)
 v_mfma_f32_32x32x16_bf16 a[16:31], v[28:31], v[60:63], a[16:31]
 ds_read_b64_tr_b16 v[20:21], v5 offset:16384
 ds_read_b64_tr_b16 v[22:23], v5 offset:17408
 buffer_load_dwordx4 v[100:103], v15, s[4:7], s34 offen offset:1024 sc1
 s_waitcnt vmcnt(9) lgkmcnt(2)
 v_mfma_f32_32x32x16_bf16 a[0:15], v[16:19], v[64:67], a[0:15]
 ds_read_b64_tr_b16 v[24:25], v4 offset:18432
 ds_read_b64_tr_b16 v[26:27], v4 offset:19456
 s_waitcnt lgkmcnt(2)
 v_mfma_f32_32x32x16_bf16 a[16:31], v[20:23], v[64:67], a[16:31]
 ds_read_b64_tr_b16 v[28:29], v5 offset:18432
 ds_read_b64_tr_b16 v[30:31], v5 offset:19456
 buffer_load_dwordx4 v[104:107], v15, s[4:7], s34 offen offset:2048 sc1
 s_waitcnt vmcnt(9) lgkmcnt(2)
 v_mfma_f32_32x32x16_bf16 a[0:15], v[24:27], v[68:71], a[0:15]
 ds_read_b64_tr_b16 v[16:17], v4 offset:20480
 ds_read_b64_tr_b16 v[18:19], v4 offset:21504
 s_waitcnt lgkmcnt(2)
 v_mfma_f32_32x32x16_bf16 a[16:31], v[28:31], v[68:71], a[16:31]
 ds_read_b64_tr_b16 v[20:21], v5 offset:20480
 ds_read_b64_tr_b16 v[22:23], v5 offset:21504
 buffer_load_dwordx4 v[108:111], v15, s[4:7], s34 offen offset:3072 sc1
 s_add_u32 s34, s34, 4096
 s_waitcnt vmcnt(9) lgkmcnt(2)
 v_mfma_f32_32x32x16_bf16 a[0:15], v[16:19], v[72:75], a[0:15]
 ds_read_b64_tr_b16 v[24:25], v4 offset:22528
 ds_read_b64_tr_b16 v[26:27], v4 offset:23552
 s_waitcnt lgkmcnt(2)
 v_mfma_f32_32x32x16_bf16 a[16:31], v[20:23], v[72:75], a[16:31]
 ds_read_b64_tr_b16 v[28:29], v5 offset:22528
 ds_read_b64_tr_b16 v[30:31], v5 offset:23552
 buffer_load_dwordx4 v[112:115], v15, s[4:7], s34 offen offset:0 sc1
 s_waitcnt vmcnt(9) lgkmcnt(2)
 v_mfma_f32_32x32x16_bf16 a[0:15], v[24:27], v[76:79], a[0:15]
 ds_read_b64_tr_b16 v[16:17], v4 offset:24576
 ds_read_b64_tr_b16 v[18:19], v4 offset:25600
 s_waitcnt lgkmcnt(2)
 v_mfma_f32_32x32x16_bf16 a[16:31], v[28:31], v[76:79], a[16:31]
 ds_read_b64_tr_b16 v[20:21], v5 offset:24576
 ds_read_b64_tr_b16 v[22:23], v5 offset:25600
 buffer_load_dwordx4 v[116:119], v15, s[4:7], s34 offen offset:1024 sc1
 s_waitcnt vmcnt(9) lgkmcnt(2)
 v_mfma_f32_32x32x16_bf16 a[0:15], v[16:19], v[80:83], a[0:15]
 ds_read_b64_tr_b16 v[24:25], v4 offset:26624
 ds_read_b64_tr_b16 v[26:27], v4 offset:27648
 s_waitcnt lgkmcnt(2)
 v_mfma_f32_32x32x16_bf16 a[16:31], v[20:23], v[80:83], a[16:31]
 ds_read_b64_tr_b16 v[28:29], v5 offset:26624
 ds_read_b64_tr_b16 v[30:31], v5 offset:27648
 buffer_load_dwordx4 v[120:123], v15, s[4:7], s34 offen offset:2048 sc1
 s_waitcnt vmcnt(9) lgkmcnt(2)
 v_mfma_f32_32x32x16_bf16 a[0:15], v[24:27], v[84:87], a[0:15]
 ds_read_b64_tr_b16 v[16:17], v4 offset:28672
 ds_read_b64_tr_b16 v[18:19], v4 offset:29696
 s_waitcnt lgkmcnt(2)
 v_mfma_f32_32x32x16_bf16 a[16:31], v[28:31], v[84:87], a[16:31]
 ds_read_b64_tr_b16 v[20:21], v5 offset:28672
 ds_read_b64_tr_b16 v[22:23], v5 offset:29696
 buffer_load_dwordx4 v[124:127], v15, s[4:7], s34 offen offset:3072 sc1
 s_add_u32 s34, s34, 4096
 s_waitcnt vmcnt(9) lgkmcnt(2)
 v_mfma_f32_32x32x16_bf16 a[0:15], v[16:19], v[88:91], a[0:15]
 ds_read_b64_tr_b16 v[24:25], v4 offset:30720
 ds_read_b64_tr_b16 v[26:27], v4 offset:31744
 s_waitcnt lgkmcnt(2)
 v_mfma_f32_32x32x16_bf16 a[16:31], v[20:23], v[88:91], a[16:31]
 ds_read_b64_tr_b16 v[28:29], v5 offset:30720
 ds_read_b64_tr_b16 v[30:31], v5 offset:31744
 buffer_load_dwordx4 v[32:35], v15, s[4:7], s34 offen offset:0 sc1
 s_waitcnt vmcnt(9) lgkmcnt(2)
 v_mfma_f32_32x32x16_bf16 a[0:15], v[24:27], v[92:95], a[0:15]
 ds_read_b64_tr_b16 v[16:17], v4 offset:32768
 ds_read_b64_tr_b16 v[18:19], v4 offset:33792
 s_waitcnt lgkmcnt(2)
 v_mfma_f32_32x32x16_bf16 a[16:31], v[28:31], v[92:95], a[16:31]
 ds_read_b64_tr_b16 v[20:21], v5 offset:32768
 ds_read_b64_tr_b16 v[22:23], v5 offset:33792
 buffer_load_dwordx4 v[36:39], v15, s[4:7], s34 offen offset:1024 sc1
 s_waitcnt vmcnt(9) lgkmcnt(2)
 v_mfma_f32_32x32x16_bf16 a[0:15], v[16:19], v[96:99], a[0:15]
 ds_read_b64_tr_b16 v[24:25], v4 offset:34816
 ds_read_b64_tr_b16 v[26:27], v4 offset:35840
 s_waitcnt lgkmcnt(2)
 v_mfma_f32_32x32x16_bf16 a[16:31], v[20:23], v[96:99], a[16:31]
 ds_read_b64_tr_b16 v[28:29], v5 offset:34816
 ds_read_b64_tr_b16 v[30:31], v5 offset:35840
 buffer_load_dwordx4 v[40:43], v15, s[4:7], s34 offen offset:2048 sc1
 s_waitcnt vmcnt(9) lgkmcnt(2)
 v_mfma_f32_32x32x16_bf16 a[0:15], v[24:27], v[100:103], a[0:15]
 ds_read_b64_tr_b16 v[16:17], v4 offset:36864
 ds_read_b64_tr_b16 v[18:19], v4 offset:37888
 s_waitcnt lgkmcnt(2)
 v_mfma_f32_32x32x16_bf16 a[16:31], v[28:31], v[100:103], a[16:31]
 ds_read_b64_tr_b16 v[20:21], v5 offset:36864
 ds_read_b64_tr_b16 v[22:23], v5 offset:37888
 buffer_load_dwordx4 v[44:47], v15, s[4:7], s34 offen offset:3072 sc1
 s_add_u32 s34, s34, 4096
 s_waitcnt vmcnt(9) lgkmcnt(2)
 v_mfma_f32_32x32x16_bf16 a[0:15], v[16:19], v[104:107], a[0:15]
 ds_read_b64_tr_b16 v[24:25], v4 offset:38912
 ds_read_b64_tr_b16 v[26:27], v4 offset:39936
 s_waitcnt lgkmcnt(2)
 v_mfma_f32_32x32x16_bf16 a[16:31], v[20:23], v[104:107], a[16:31]
 ds_read_b64_tr_b16 v[28:29], v5 offset:38912
 ds_read_b64_tr_b16 v[30:31], v5 offset:39936
 buffer_load_dwordx4 v[48:51], v15, s[4:7], s34 offen offset:0 sc1
 s_waitcnt vmcnt(9) lgkmcnt(2)
 v_mfma_f32_32x32x16_bf16 a[0:15], v[24:27], v[108:111], a[0:15]
 ds_read_b64_tr_b16 v[16:17], v4 offset:40960
 ds_read_b64_tr_b16 v[18:19], v4 offset:41984
 s_waitcnt lgkmcnt(2)
 v_mfma_f32_32x32x16_bf16 a[16:31], v[28:31], v[108:111], a[16:31]
 ds_read_b64_tr_b16 v[20:21], v5 offset:40960
 ds_read_b64_tr_b16 v[22:23], v5 offset:41984
 buffer_load_dwordx4 v[52:55], v15, s[4:7], s34 offen offset:1024 sc1
 s_waitcnt vmcnt(9) lgkmcnt(2)
 v_mfma_f32_32x32x16_bf16 a[0:15], v[16:19], v[112:115], a[0:15]
 ds_read_b64_tr_b16 v[24:25], v4 offset:43008
 ds_read_b64_tr_b16 v[26:27], v4 offset:44032
 s_waitcnt lgkmcnt(2)
 v_mfma_f32_32x32x16_bf16 a[16:31], v[20:23], v[112:115], a[16:31]
 ds_read_b64_tr_b16 v[28:29], v5 offset:43008
 ds_read_b64_tr_b16 v[30:31], v5 offset:44032
 buffer_load_dwordx4 v[56:59], v15, s[4:7], s34 offen offset:2048 sc1
 s_waitcnt vmcnt(9) lgkmcnt(2)
 v_mfma_f32_32x32x16_bf16 a[0:15], v[24:27], v[116:119], a[0:15]
 ds_read_b64_tr_b16 v[16:17], v4 offset:45056
 ds_read_b64_tr_b16 v[18:19], v4 offset:46080
 s_waitcnt lgkmcnt(2)
 v_mfma_f32_32x32x16_bf16 a[16:31], v[28:31], v[116:119], a[16:31]
 ds_read_b64_tr_b16 v[20:21], v5 offset:45056
 ds_read_b64_tr_b16 v[22:23], v5 offset:46080
 buffer_load_dwordx4 v[60:63], v15, s[4:7], s34 offen offset:3072 sc1
 s_add_u32 s34, s34, 4096
 s_waitcnt vmcnt(9) lgkmcnt(2)
 v_mfma_f32_32x32x16_bf16 a[0:15], v[16:19], v[120:123], a[0:15]
 ds_read_b64_tr_b16 v[24:25], v4 offset:47104
 ds_read_b64_tr_b16 v[26:27], v4 offset:48128
 s_waitcnt lgkmcnt(2)
 v_mfma_f32_32x32x16_bf16 a[16:31], v[20:23], v[120:123], a[16:31]
 ds_read_b64_tr_b16 v[28:29], v5 offset:47104
 ds_read_b64_tr_b16 v[30:31], v5 offset:48128
 buffer_load_dwordx4 v[64:67], v15, s[4:7], s34 offen offset:0 sc1
 s_waitcnt vmcnt(9) lgkmcnt(2)
 v_mfma_f32_32x32x16_bf16 a[0:15], v[24:27], v[124:127], a[0:15]
 ds_read_b64_tr_b16 v[16:17], v4 offset:49152
 ds_read_b64_tr_b16 v[18:19], v4 offset:50176
 s_waitcnt lgkmcnt(2)
 v_mfma_f32_32x32x16_bf16 a[16:31], v[28:31], v[124:127], a[16:31]
 ds_read_b64_tr_b16 v[20:21], v5 offset:49152
 ds_read_b64_tr_b16 v[22:23], v5 offset:50176
 buffer_load_dwordx4 v[68:71], v15, s[4:7], s34 offen offset:1024 sc1
 s_waitcnt vmcnt(9) lgkmcnt(2)
 v_mfma_f32_32x32x16_bf16 a[0:15], v[16:19], v[32:35], a[0:15]
 ds_read_b64_tr_b16 v[24:25], v4 offset:51200
 ds_read_b64_tr_b16 v[26:27], v4 offset:52224
 s_waitcnt lgkmcnt(2)
 v_mfma_f32_32x32x16_bf16 a[16:31], v[20:23], v[32:35], a[16:31]
 ds_read_b64_tr_b16 v[28:29], v5 offset:51200
 ds_read_b64_tr_b16 v[30:31], v5 offset:52224
 buffer_load_dwordx4 v[72:75], v15, s[4:7], s34 offen offset:2048 sc1
 s_waitcnt vmcnt(9) lgkmcnt(2)
 v_mfma_f32_32x32x16_bf16 a[0:15], v[24:27], v[36:39], a[0:15]
 ds_read_b64_tr_b16 v[16:17], v4 offset:53248
 ds_read_b64_tr_b16 v[18:19], v4 offset:54272
 s_waitcnt lgkmcnt(2)
 v_mfma_f32_32x32x16_bf16 a[16:31], v[28:31], v[36:39], a[16:31]
 ds_read_b64_tr_b16 v[20:21], v5 offset:53248
 ds_read_b64_tr_b16 v[22:23], v5 offset:54272
 buffer_load_dwordx4 v[76:79], v15, s[4:7], s34 offen offset:3072 sc1
 s_add_u32 s34, s34, 4096
 s_waitcnt vmcnt(9) lgkmcnt(2)
 v_mfma_f32_32x32x16_bf16 a[0:15], v[16:19], v[40:43], a[0:15]
 ds_read_b64_tr_b16 v[24:25], v4 offset:55296
 ds_read_b64_tr_b16 v[26:27], v4 offset:56320
 s_waitcnt lgkmcnt(2)
 v_mfma_f32_32x32x16_bf16 a[16:31], v[20:23], v[40:43], a[16:31]
 ds_read_b64_tr_b16 v[28:29], v5 offset:55296
 ds_read_b64_tr_b16 v[30:31], v5 offset:56320
 buffer_load_dwordx4 v[80:83], v15, s[4:7], s34 offen offset:0 sc1
 s_waitcnt vmcnt(9) lgkmcnt(2)
 v_mfma_f32_32x32x16_bf16 a[0:15], v[24:27], v[44:47], a[0:15]
 ds_read_b64_tr_b16 v[16:17], v4 offset:57344
 ds_read_b64_tr_b16 v[18:19], v4 offset:58368
 s_waitcnt lgkmcnt(2)
 v_mfma_f32_32x32x16_bf16 a[16:31], v[28:31], v[44:47], a[16:31]
 ds_read_b64_tr_b16 v[20:21], v5 offset:57344
 ds_read_b64_tr_b16 v[22:23], v5 offset:58368
 buffer_load_dwordx4 v[84:87], v15, s[4:7], s34 offen offset:1024 sc1
 s_waitcnt vmcnt(9) lgkmcnt(2)
 v_mfma_f32_32x32x16_bf16 a[0:15], v[16:19], v[48:51], a[0:15]
 ds_read_b64_tr_b16 v[24:25], v4 offset:59392
 ds_read_b64_tr_b16 v[26:27], v4 offset:60416
 s_waitcnt lgkmcnt(2)
 v_mfma_f32_32x32x16_bf16 a[16:31], v[20:23], v[48:51], a[16:31]
 ds_read_b64_tr_b16 v[28:29], v5 offset:59392
 ds_read_b64_tr_b16 v[30:31], v5 offset:60416
 buffer_load_dwordx4 v[88:91], v15, s[4:7], s34 offen offset:2048 sc1
 s_waitcnt vmcnt(9) lgkmcnt(2)
 v_mfma_f32_32x32x16_bf16 a[0:15], v[24:27], v[52:55], a[0:15]
 ds_read_b64_tr_b16 v[16:17], v4 offset:61440
 ds_read_b64_tr_b16 v[18:19], v4 offset:62464
 s_waitcnt lgkmcnt(2)
 v_mfma_f32_32x32x16_bf16 a[16:31], v[28:31], v[52:55], a[16:31]
 ds_read_b64_tr_b16 v[20:21], v5 offset:61440
 ds_read_b64_tr_b16 v[22:23], v5 offset:62464
 buffer_load_dwordx4 v[92:95], v15, s[4:7], s34 offen offset:3072 sc1
 s_add_u32 s34, s34, 4096
 s_waitcnt vmcnt(9) lgkmcnt(2)
 v_mfma_f32_32x32x16_bf16 a[0:15], v[16:19], v[56:59], a[0:15]
 ds_read_b64_tr_b16 v[24:25], v4 offset:63488
 ds_read_b64_tr_b16 v[26:27], v4 offset:64512
 s_waitcnt lgkmcnt(2)
 v_mfma_f32_32x32x16_bf16 a[16:31], v[20:23], v[56:59], a[16:31]
 ds_read_b64_tr_b16 v[28:29], v5 offset:63488
 ds_read_b64_tr_b16 v[30:31], v5 offset:64512
 buffer_load_dwordx4 v[96:99], v15, s[4:7], s34 offen offset:0 sc1
 s_waitcnt vmcnt(9) lgkmcnt(2)
 v_mfma_f32_32x32x16_bf16 a[0:15], v[24:27], v[60:63], a[0:15]
 ds_read_b64_tr_b16 v[16:17], v6 offset:0
 ds_read_b64_tr_b16 v[18:19], v6 offset:1024
 s_waitcnt lgkmcnt(2)
 v_mfma_f32_32x32x16_bf16 a[16:31], v[28:31], v[60:63], a[16:31]
 ds_read_b64_tr_b16 v[20:21], v7 offset:0
 ds_read_b64_tr_b16 v[22:23], v7 offset:1024
 buffer_load_dwordx4 v[100:103], v15, s[4:7], s34 offen offset:1024 sc1
 s_waitcnt vmcnt(9) lgkmcnt(2)
 v_mfma_f32_32x32x16_bf16 a[0:15], v[16:19], v[64:67], a[0:15]
 ds_read_b64_tr_b16 v[24:25], v6 offset:2048
 ds_read_b64_tr_b16 v[26:27], v6 offset:3072
 s_waitcnt lgkmcnt(2)
 v_mfma_f32_32x32x16_bf16 a[16:31], v[20:23], v[64:67], a[16:31]
 ds_read_b64_tr_b16 v[28:29], v7 offset:2048
 ds_read_b64_tr_b16 v[30:31], v7 offset:3072
 buffer_load_dwordx4 v[104:107], v15, s[4:7], s34 offen offset:2048 sc1
 s_waitcnt vmcnt(9) lgkmcnt(2)
 v_mfma_f32_32x32x16_bf16 a[0:15], v[24:27], v[68:71], a[0:15]
 ds_read_b64_tr_b16 v[16:17], v6 offset:4096
 ds_read_b64_tr_b16 v[18:19], v6 offset:5120
 s_waitcnt lgkmcnt(2)
 v_mfma_f32_32x32x16_bf16 a[16:31], v[28:31], v[68:71], a[16:31]
 ds_read_b64_tr_b16 v[20:21], v7 offset:4096
 ds_read_b64_tr_b16 v[22:23], v7 offset:5120
 buffer_load_dwordx4 v[108:111], v15, s[4:7], s34 offen offset:3072 sc1
 s_add_u32 s34, s34, 4096
 s_waitcnt vmcnt(9) lgkmcnt(2)
 v_mfma_f32_32x32x16_bf16 a[0:15], v[16:19], v[72:75], a[0:15]
 ds_read_b64_tr_b16 v[24:25], v6 offset:6144
 ds_read_b64_tr_b16 v[26:27], v6 offset:7168
 s_waitcnt lgkmcnt(2)
 v_mfma_f32_32x32x16_bf16 a[16:31], v[20:23], v[72:75], a[16:31]
 ds_read_b64_tr_b16 v[28:29], v7 offset:6144
 ds_read_b64_tr_b16 v[30:31], v7 offset:7168
 buffer_load_dwordx4 v[112:115], v15, s[4:7], s34 offen offset:0 sc1
 s_waitcnt vmcnt(9) lgkmcnt(2)
 v_mfma_f32_32x32x16_bf16 a[0:15], v[24:27], v[76:79], a[0:15]
 ds_read_b64_tr_b16 v[16:17], v6 offset:8192
 ds_read_b64_tr_b16 v[18:19], v6 offset:9216
 s_waitcnt lgkmcnt(2)
 v_mfma_f32_32x32x16_bf16 a[16:31], v[28:31], v[76:79], a[16:31]
 ds_read_b64_tr_b16 v[20:21], v7 offset:8192
 ds_read_b64_tr_b16 v[22:23], v7 offset:9216
 buffer_load_dwordx4 v[116:119], v15, s[4:7], s34 offen offset:1024 sc1
 s_waitcnt vmcnt(9) lgkmcnt(2)
 v_mfma_f32_32x32x16_bf16 a[0:15], v[16:19], v[80:83], a[0:15]
 ds_read_b64_tr_b16 v[24:25], v6 offset:10240
 ds_read_b64_tr_b16 v[26:27], v6 offset:11264
 s_waitcnt lgkmcnt(2)
 v_mfma_f32_32x32x16_bf16 a[16:31], v[20:23], v[80:83], a[16:31]
 ds_read_b64_tr_b16 v[28:29], v7 offset:10240
 ds_read_b64_tr_b16 v[30:31], v7 offset:11264
 buffer_load_dwordx4 v[120:123], v15, s[4:7], s34 offen offset:2048 sc1
 s_waitcnt vmcnt(9) lgkmcnt(2)
 v_mfma_f32_32x32x16_bf16 a[0:15], v[24:27], v[84:87], a[0:15]
 ds_read_b64_tr_b16 v[16:17], v6 offset:12288
 ds_read_b64_tr_b16 v[18:19], v6 offset:13312
 s_waitcnt lgkmcnt(2)
 v_mfma_f32_32x32x16_bf16 a[16:31], v[28:31], v[84:87], a[16:31]
 ds_read_b64_tr_b16 v[20:21], v7 offset:12288
 ds_read_b64_tr_b16 v[22:23], v7 offset:13312
 buffer_load_dwordx4 v[124:127], v15, s[4:7], s34 offen offset:3072 sc1
 s_add_u32 s34, s34, 4096
 s_waitcnt vmcnt(9) lgkmcnt(2)
 v_mfma_f32_32x32x16_bf16 a[0:15], v[16:19], v[88:91], a[0:15]
 ds_read_b64_tr_b16 v[24:25], v6 offset:14336
 ds_read_b64_tr_b16 v[26:27], v6 offset:15360
 s_waitcnt lgkmcnt(2)
 v_mfma_f32_32x32x16_bf16 a[16:31], v[20:23], v[88:91], a[16:31]
 ds_read_b64_tr_b16 v[28:29], v7 offset:14336
 ds_read_b64_tr_b16 v[30:31], v7 offset:15360
 buffer_load_dwordx4 v[32:35], v15, s[4:7], s34 offen offset:0 sc1
 s_waitcnt vmcnt(9) lgkmcnt(2)
 v_mfma_f32_32x32x16_bf16 a[0:15], v[24:27], v[92:95], a[0:15]
 ds_read_b64_tr_b16 v[16:17], v6 offset:16384
 ds_read_b64_tr_b16 v[18:19], v6 offset:17408
 s_waitcnt lgkmcnt(2)
 v_mfma_f32_32x32x16_bf16 a[16:31], v[28:31], v[92:95], a[16:31]
 ds_read_b64_tr_b16 v[20:21], v7 offset:16384
 ds_read_b64_tr_b16 v[22:23], v7 offset:17408
 buffer_load_dwordx4 v[36:39], v15, s[4:7], s34 offen offset:1024 sc1
 s_waitcnt vmcnt(9) lgkmcnt(2)
 v_mfma_f32_32x32x16_bf16 a[0:15], v[16:19], v[96:99], a[0:15]
 ds_read_b64_tr_b16 v[24:25], v6 offset:18432
 ds_read_b64_tr_b16 v[26:27], v6 offset:19456
 s_waitcnt lgkmcnt(2)
 v_mfma_f32_32x32x16_bf16 a[16:31], v[20:23], v[96:99], a[16:31]
 ds_read_b64_tr_b16 v[28:29], v7 offset:18432
 ds_read_b64_tr_b16 v[30:31], v7 offset:19456
 buffer_load_dwordx4 v[40:43], v15, s[4:7], s34 offen offset:2048 sc1
 s_waitcnt vmcnt(9) lgkmcnt(2)
 v_mfma_f32_32x32x16_bf16 a[0:15], v[24:27], v[100:103], a[0:15]
 ds_read_b64_tr_b16 v[16:17], v6 offset:20480
 ds_read_b64_tr_b16 v[18:19], v6 offset:21504
 s_waitcnt lgkmcnt(2)
 v_mfma_f32_32x32x16_bf16 a[16:31], v[28:31], v[100:103], a[16:31]
 ds_read_b64_tr_b16 v[20:21], v7 offset:20480
 ds_read_b64_tr_b16 v[22:23], v7 offset:21504
 buffer_load_dwordx4 v[44:47], v15, s[4:7], s34 offen offset:3072 sc1
 s_add_u32 s34, s34, 4096
 s_waitcnt vmcnt(9) lgkmcnt(2)
 v_mfma_f32_32x32x16_bf16 a[0:15], v[16:19], v[104:107], a[0:15]
 ds_read_b64_tr_b16 v[24:25], v6 offset:22528
 ds_read_b64_tr_b16 v[26:27], v6 offset:23552
 s_waitcnt lgkmcnt(2)
 v_mfma_f32_32x32x16_bf16 a[16:31], v[20:23], v[104:107], a[16:31]
 ds_read_b64_tr_b16 v[28:29], v7 offset:22528
 ds_read_b64_tr_b16 v[30:31], v7 offset:23552
 buffer_load_dwordx4 v[48:51], v15, s[4:7], s34 offen offset:0 sc1
 s_waitcnt vmcnt(9) lgkmcnt(2)
 v_mfma_f32_32x32x16_bf16 a[0:15], v[24:27], v[108:111], a[0:15]
 ds_read_b64_tr_b16 v[16:17], v6 offset:24576
 ds_read_b64_tr_b16 v[18:19], v6 offset:25600
 s_waitcnt lgkmcnt(2)
 v_mfma_f32_32x32x16_bf16 a[16:31], v[28:31], v[108:111], a[16:31]
 ds_read_b64_tr_b16 v[20:21], v7 offset:24576
 ds_read_b64_tr_b16 v[22:23], v7 offset:25600
 buffer_load_dwordx4 v[52:55], v15, s[4:7], s34 offen offset:1024 sc1
 s_waitcnt vmcnt(9) lgkmcnt(2)
 v_mfma_f32_32x32x16_bf16 a[0:15], v[16:19], v[112:115], a[0:15]
 ds_read_b64_tr_b16 v[24:25], v6 offset:26624
 ds_read_b64_tr_b16 v[26:27], v6 offset:27648
 s_waitcnt lgkmcnt(2)
 v_mfma_f32_32x32x16_bf16 a[16:31], v[20:23], v[112:115], a[16:31]
 ds_read_b64_tr_b16 v[28:29], v7 offset:26624
 ds_read_b64_tr_b16 v[30:31], v7 offset:27648
 buffer_load_dwordx4 v[56:59], v15, s[4:7], s34 offen offset:2048 sc1
 s_waitcnt vmcnt(9) lgkmcnt(2)
 v_mfma_f32_32x32x16_bf16 a[0:15], v[24:27], v[116:119], a[0:15]
 ds_read_b64_tr_b16 v[16:17], v6 offset:28672
 ds_read_b64_tr_b16 v[18:19], v6 offset:29696
 s_waitcnt lgkmcnt(2)
 v_mfma_f32_32x32x16_bf16 a[16:31], v[28:31], v[116:119], a[16:31]
 ds_read_b64_tr_b16 v[20:21], v7 offset:28672
 ds_read_b64_tr_b16 v[22:23], v7 offset:29696
 buffer_load_dwordx4 v[60:63], v15, s[4:7], s34 offen offset:3072 sc1
 s_add_u32 s34, s34, 4096
 s_waitcnt vmcnt(9) lgkmcnt(2)
 v_mfma_f32_32x32x16_bf16 a[0:15], v[16:19], v[120:123], a[0:15]
 ds_read_b64_tr_b16 v[24:25], v6 offset:30720
 ds_read_b64_tr_b16 v[26:27], v6 offset:31744
 s_waitcnt lgkmcnt(2)
 v_mfma_f32_32x32x16_bf16 a[16:31], v[20:23], v[120:123], a[16:31]
 ds_read_b64_tr_b16 v[28:29], v7 offset:30720
 ds_read_b64_tr_b16 v[30:31], v7 offset:31744
 buffer_load_dwordx4 v[64:67], v15, s[4:7], s34 offen offset:0 sc1
 s_waitcnt vmcnt(9) lgkmcnt(2)
 v_mfma_f32_32x32x16_bf16 a[0:15], v[24:27], v[124:127], a[0:15]
 ds_read_b64_tr_b16 v[16:17], v6 offset:32768
 ds_read_b64_tr_b16 v[18:19], v6 offset:33792
 s_waitcnt lgkmcnt(2)
 v_mfma_f32_32x32x16_bf16 a[16:31], v[28:31], v[124:127], a[16:31]
 ds_read_b64_tr_b16 v[20:21], v7 offset:32768
 ds_read_b64_tr_b16 v[22:23], v7 offset:33792
 buffer_load_dwordx4 v[68:71], v15, s[4:7], s34 offen offset:1024 sc1
 s_waitcnt vmcnt(9) lgkmcnt(2)
 v_mfma_f32_32x32x16_bf16 a[0:15], v[16:19], v[32:35], a[0:15]
 ds_read_b64_tr_b16 v[24:25], v6 offset:34816
 ds_read_b64_tr_b16 v[26:27], v6 offset:35840
 s_waitcnt lgkmcnt(2)
 v_mfma_f32_32x32x16_bf16 a[16:31], v[20:23], v[32:35], a[16:31]
 ds_read_b64_tr_b16 v[28:29], v7 offset:34816
 ds_read_b64_tr_b16 v[30:31], v7 offset:35840
 buffer_load_dwordx4 v[72:75], v15, s[4:7], s34 offen offset:2048 sc1
 s_waitcnt vmcnt(9) lgkmcnt(2)
 v_mfma_f32_32x32x16_bf16 a[0:15], v[24:27], v[36:39], a[0:15]
 ds_read_b64_tr_b16 v[16:17], v6 offset:36864
 ds_read_b64_tr_b16 v[18:19], v6 offset:37888
 s_waitcnt lgkmcnt(2)
 v_mfma_f32_32x32x16_bf16 a[16:31], v[28:31], v[36:39], a[16:31]
 ds_read_b64_tr_b16 v[20:21], v7 offset:36864
 ds_read_b64_tr_b16 v[22:23], v7 offset:37888
 buffer_load_dwordx4 v[76:79], v15, s[4:7], s34 offen offset:3072 sc1
 s_add_u32 s34, s34, 4096
 s_waitcnt vmcnt(9) lgkmcnt(2)
 v_mfma_f32_32x32x16_bf16 a[0:15], v[16:19], v[40:43], a[0:15]
 ds_read_b64_tr_b16 v[24:25], v6 offset:38912
 ds_read_b64_tr_b16 v[26:27], v6 offset:39936
 s_waitcnt lgkmcnt(2)
 v_mfma_f32_32x32x16_bf16 a[16:31], v[20:23], v[40:43], a[16:31]
 ds_read_b64_tr_b16 v[28:29], v7 offset:38912
 ds_read_b64_tr_b16 v[30:31], v7 offset:39936
 buffer_load_dwordx4 v[80:83], v15, s[4:7], s34 offen offset:0 sc1
 s_add_u32 s33, s25, 2260992
 v_lshl_add_u32 v3, v0, 11, s33
 s_mov_b64 exec, 0xff
 buffer_load_dword v10, v3, s[4:7], 0 offen sc1
 s_mov_b64 exec, -1
 s_waitcnt vmcnt(9) lgkmcnt(2)
 v_mfma_f32_32x32x16_bf16 a[0:15], v[24:27], v[44:47], a[0:15]
 ds_read_b64_tr_b16 v[16:17], v6 offset:40960
 ds_read_b64_tr_b16 v[18:19], v6 offset:41984
 s_waitcnt lgkmcnt(2)
 v_mfma_f32_32x32x16_bf16 a[16:31], v[28:31], v[44:47], a[16:31]
 ds_read_b64_tr_b16 v[20:21], v7 offset:40960
 ds_read_b64_tr_b16 v[22:23], v7 offset:41984
 buffer_load_dwordx4 v[84:87], v15, s[4:7], s34 offen offset:1024 sc1
 s_waitcnt vmcnt(9) lgkmcnt(2)
 v_mfma_f32_32x32x16_bf16 a[0:15], v[16:19], v[48:51], a[0:15]
 ds_read_b64_tr_b16 v[24:25], v6 offset:43008
 ds_read_b64_tr_b16 v[26:27], v6 offset:44032
 s_waitcnt lgkmcnt(2)
 v_mfma_f32_32x32x16_bf16 a[16:31], v[20:23], v[48:51], a[16:31]
 ds_read_b64_tr_b16 v[28:29], v7 offset:43008
 ds_read_b64_tr_b16 v[30:31], v7 offset:44032
 buffer_load_dwordx4 v[88:91], v15, s[4:7], s34 offen offset:2048 sc1
 s_waitcnt vmcnt(9) lgkmcnt(2)
 v_mfma_f32_32x32x16_bf16 a[0:15], v[24:27], v[52:55], a[0:15]
 ds_read_b64_tr_b16 v[16:17], v6 offset:45056
 ds_read_b64_tr_b16 v[18:19], v6 offset:46080
 s_waitcnt lgkmcnt(2)
 v_mfma_f32_32x32x16_bf16 a[16:31], v[28:31], v[52:55], a[16:31]
 ds_read_b64_tr_b16 v[20:21], v7 offset:45056
 ds_read_b64_tr_b16 v[22:23], v7 offset:46080
 buffer_load_dwordx4 v[92:95], v15, s[4:7], s34 offen offset:3072 sc1
 s_add_u32 s34, s34, 4096
 s_waitcnt vmcnt(9) lgkmcnt(2)
 v_mfma_f32_32x32x16_bf16 a[0:15], v[16:19], v[56:59], a[0:15]
 ds_read_b64_tr_b16 v[24:25], v6 offset:47104
 ds_read_b64_tr_b16 v[26:27], v6 offset:48128
 s_waitcnt lgkmcnt(2)
 v_mfma_f32_32x32x16_bf16 a[16:31], v[20:23], v[56:59], a[16:31]
 ds_read_b64_tr_b16 v[28:29], v7 offset:47104
 ds_read_b64_tr_b16 v[30:31], v7 offset:48128
 s_waitcnt vmcnt(8) lgkmcnt(2)
 v_mfma_f32_32x32x16_bf16 a[0:15], v[24:27], v[60:63], a[0:15]
 ds_read_b64_tr_b16 v[16:17], v6 offset:49152
 ds_read_b64_tr_b16 v[18:19], v6 offset:50176
 s_waitcnt lgkmcnt(2)
 v_mfma_f32_32x32x16_bf16 a[16:31], v[28:31], v[60:63], a[16:31]
 ds_read_b64_tr_b16 v[20:21], v7 offset:49152
 ds_read_b64_tr_b16 v[22:23], v7 offset:50176
 s_waitcnt vmcnt(7) lgkmcnt(2)
 v_mfma_f32_32x32x16_bf16 a[0:15], v[16:19], v[64:67], a[0:15]
 ds_read_b64_tr_b16 v[24:25], v6 offset:51200
 ds_read_b64_tr_b16 v[26:27], v6 offset:52224
 s_waitcnt lgkmcnt(2)
 v_mfma_f32_32x32x16_bf16 a[16:31], v[20:23], v[64:67], a[16:31]
 ds_read_b64_tr_b16 v[28:29], v7 offset:51200
 ds_read_b64_tr_b16 v[30:31], v7 offset:52224
 s_waitcnt vmcnt(6) lgkmcnt(2)
 v_mfma_f32_32x32x16_bf16 a[0:15], v[24:27], v[68:71], a[0:15]
 ds_read_b64_tr_b16 v[16:17], v6 offset:53248
 ds_read_b64_tr_b16 v[18:19], v6 offset:54272
 s_waitcnt lgkmcnt(2)
 v_mfma_f32_32x32x16_bf16 a[16:31], v[28:31], v[68:71], a[16:31]
 ds_read_b64_tr_b16 v[20:21], v7 offset:53248
 ds_read_b64_tr_b16 v[22:23], v7 offset:54272
 s_waitcnt vmcnt(5) lgkmcnt(2)
 v_mfma_f32_32x32x16_bf16 a[0:15], v[16:19], v[72:75], a[0:15]
 ds_read_b64_tr_b16 v[24:25], v6 offset:55296
 ds_read_b64_tr_b16 v[26:27], v6 offset:56320
 s_waitcnt lgkmcnt(2)
 v_mfma_f32_32x32x16_bf16 a[16:31], v[20:23], v[72:75], a[16:31]
 ds_read_b64_tr_b16 v[28:29], v7 offset:55296
 ds_read_b64_tr_b16 v[30:31], v7 offset:56320
 s_waitcnt vmcnt(4) lgkmcnt(2)
 v_mfma_f32_32x32x16_bf16 a[0:15], v[24:27], v[76:79], a[0:15]
 ds_read_b64_tr_b16 v[16:17], v6 offset:57344
 ds_read_b64_tr_b16 v[18:19], v6 offset:58368
 s_waitcnt lgkmcnt(2)
 v_mfma_f32_32x32x16_bf16 a[16:31], v[28:31], v[76:79], a[16:31]
 ds_read_b64_tr_b16 v[20:21], v7 offset:57344
 ds_read_b64_tr_b16 v[22:23], v7 offset:58368
 s_waitcnt vmcnt(3) lgkmcnt(2)
 v_mfma_f32_32x32x16_bf16 a[0:15], v[16:19], v[80:83], a[0:15]
 ds_read_b64_tr_b16 v[24:25], v6 offset:59392
 ds_read_b64_tr_b16 v[26:27], v6 offset:60416
 s_waitcnt lgkmcnt(2)
 v_mfma_f32_32x32x16_bf16 a[16:31], v[20:23], v[80:83], a[16:31]
 ds_read_b64_tr_b16 v[28:29], v7 offset:59392
 ds_read_b64_tr_b16 v[30:31], v7 offset:60416
 s_waitcnt vmcnt(2) lgkmcnt(2)
 v_mfma_f32_32x32x16_bf16 a[0:15], v[24:27], v[84:87], a[0:15]
 ds_read_b64_tr_b16 v[16:17], v6 offset:61440
 ds_read_b64_tr_b16 v[18:19], v6 offset:62464
 s_waitcnt lgkmcnt(2)
 v_mfma_f32_32x32x16_bf16 a[16:31], v[28:31], v[84:87], a[16:31]
 ds_read_b64_tr_b16 v[20:21], v7 offset:61440
 ds_read_b64_tr_b16 v[22:23], v7 offset:62464
 s_waitcnt vmcnt(1) lgkmcnt(2)
 v_mfma_f32_32x32x16_bf16 a[0:15], v[16:19], v[88:91], a[0:15]
 ds_read_b64_tr_b16 v[24:25], v6 offset:63488
 ds_read_b64_tr_b16 v[26:27], v6 offset:64512
 s_waitcnt lgkmcnt(2)
 v_mfma_f32_32x32x16_bf16 a[16:31], v[20:23], v[88:91], a[16:31]
 ds_read_b64_tr_b16 v[28:29], v7 offset:63488
 ds_read_b64_tr_b16 v[30:31], v7 offset:64512
 s_waitcnt vmcnt(0) lgkmcnt(2)
 v_mfma_f32_32x32x16_bf16 a[0:15], v[24:27], v[92:95], a[0:15]
 s_waitcnt lgkmcnt(0)
 v_mfma_f32_32x32x16_bf16 a[16:31], v[28:31], v[92:95], a[16:31]
 s_and_b32 s34, s14, 3
 s_lshr_b32 s26, s14, 2
 s_lshl_b32 s30, s26, 3
 s_add_u32 s30, s30, s12
 s_add_u32 s35, s30, 51
 s_min_u32 s35, s35, 64
 s_lshl_b32 s24, s30, 19
 s_lshl_b32 s33, s34, 10
 s_add_u32 s24, s24, s33
 s_lshl_b32 s33, s25, 5
 s_add_u32 s24, s24, s33
 s_add_u32 s24, s24, 134217728
 s_mov_b32 s38, 0
 v_cmp_gt_u32 vcc, s35, v10
 s_and_b32 vcc_lo, vcc_lo, 0xff
 s_cbranch_scc1 L_oa
 s_mov_b32 s38, 1
 s_add_u32 s33, s24, 25165824
 buffer_load_dwordx4 v[16:19], v15, s[4:7], s33 offen sc1
 s_add_u32 s33, s24, 25231360
 buffer_load_dwordx4 v[20:23], v15, s[4:7], s33 offen sc1
 s_add_u32 s33, s24, 25296896
 buffer_load_dwordx4 v[24:27], v15, s[4:7], s33 offen sc1
 s_add_u32 s33, s24, 25362432
 buffer_load_dwordx4 v[28:31], v15, s[4:7], s33 offen sc1
 s_add_u32 s33, s24, 25427968
 buffer_load_dwordx4 v[32:35], v15, s[4:7], s33 offen sc1
 s_add_u32 s33, s24, 25493504
 buffer_load_dwordx4 v[36:39], v15, s[4:7], s33 offen sc1
 s_add_u32 s33, s24, 25559040
 buffer_load_dwordx4 v[40:43], v15, s[4:7], s33 offen sc1
 s_add_u32 s33, s24, 25624576
 buffer_load_dwordx4 v[44:47], v15, s[4:7], s33 offen sc1
L_oa:
 s_mul_i32 s33, s14, 8448
 v_add_u32 v1, s33, v15
 v_and_b32 v4, 7, v0
 v_mul_u32_u24 v2, 1056, v4
 v_lshrrev_b32 v5, 3, v0
 s_lshl_b32 s33, s34, 3
 v_add_u32 v5, s33, v5
 v_lshl_add_u32 v2, v5, 4, v2
 s_mul_i32 s33, s26, 8448
 v_add_u32 v2, s33, v2
 v_lshlrev_b32 v6, 3, v5
 s_lshl_b32 s33, s30, 8
 s_add_u32 s33, s33, 105381888
 buffer_load_dword v80, v6, s[4:7], s33 offen offset:4 sc1
 s_add_u32 s33, s33, 4096
 buffer_load_dword v82, v6, s[4:7], s33 offen offset:4 sc1
 s_add_u32 s33, s33, 4096
 buffer_load_dword v84, v6, s[4:7], s33 offen offset:4 sc1
 s_add_u32 s33, s33, 4096
 buffer_load_dword v86, v6, s[4:7], s33 offen offset:4 sc1
 s_add_u32 s33, s33, 4096
 s_add_u32 s33, s24, 0
 buffer_load_dwordx4 v[64:67], v15, s[4:7], s33 offen sc1
 s_add_u32 s33, s24, 8388608
 buffer_load_dwordx4 v[68:71], v15, s[4:7], s33 offen sc1
 s_add_u32 s33, s24, 16777216
 buffer_load_dwordx4 v[72:75], v15, s[4:7], s33 offen sc1
 v_lshlrev_b32 v5, 11, v5
 v_lshl_add_u32 v5, v4, 4, v5
 s_lshl_b32 s27, s30, 16
 s_add_u32 s27, s27, s25
 s_barrier
 ds_write_b128 v1, a[0:3] offset:0
 ds_write_b128 v1, a[4:7] offset:1056
 ds_write_b128 v1, a[8:11] offset:2112
 ds_write_b128 v1, a[12:15] offset:3168
 ds_write_b128 v1, a[16:19] offset:4224
 ds_write_b128 v1, a[20:23] offset:5280
 ds_write_b128 v1, a[24:27] offset:6336
 ds_write_b128 v1, a[28:31] offset:7392
 s_waitcnt lgkmcnt(0)
 s_barrier
 ds_read_b128 v[96:99], v2 offset:0
 ds_read_b128 v[100:103], v2 offset:512
 ds_read_b128 v[104:107], v2 offset:16896
 ds_read_b128 v[108:111], v2 offset:17408
 ds_read_b128 v[112:115], v2 offset:33792
 ds_read_b128 v[116:119], v2 offset:34304
 ds_read_b128 v[120:123], v2 offset:50688
 ds_read_b128 v[124:127], v2 offset:51200
 s_waitcnt vmcnt(0)
 v_lshrrev_b32 v81, 16, v80
 v_lshrrev_b32 v83, 16, v82
 v_lshrrev_b32 v85, 16, v84
 v_lshrrev_b32 v87, 16, v86
 s_waitcnt lgkmcnt(0)
 s_cmp_lg_u32 s38, 0
 s_cbranch_scc1 L_oc
L_ob:
 v_dot2c_f32_bf16 v96, v64, v81
 v_dot2c_f32_bf16 v97, v64, v80
 v_dot2c_f32_bf16 v98, v65, v81
 v_dot2c_f32_bf16 v99, v65, v80
 v_dot2c_f32_bf16 v100, v66, v81
 v_dot2c_f32_bf16 v101, v66, v80
 v_dot2c_f32_bf16 v102, v67, v81
 v_dot2c_f32_bf16 v103, v67, v80
 v_cvt_pk_bf16_f32 v48, v96, v97
 v_cvt_pk_bf16_f32 v49, v98, v99
 v_cvt_pk_bf16_f32 v50, v100, v101
 v_cvt_pk_bf16_f32 v51, v102, v103
 s_add_u32 s33, s27, 0
 buffer_store_dwordx4 v[48:51], v5, s[44:47], s33 offen
 v_dot2c_f32_bf16 v104, v68, v83
 v_dot2c_f32_bf16 v105, v68, v82
 v_dot2c_f32_bf16 v106, v69, v83
 v_dot2c_f32_bf16 v107, v69, v82
 v_dot2c_f32_bf16 v108, v70, v83
 v_dot2c_f32_bf16 v109, v70, v82
 v_dot2c_f32_bf16 v110, v71, v83
 v_dot2c_f32_bf16 v111, v71, v82
 v_cvt_pk_bf16_f32 v52, v104, v105
 v_cvt_pk_bf16_f32 v53, v106, v107
 v_cvt_pk_bf16_f32 v54, v108, v109
 v_cvt_pk_bf16_f32 v55, v110, v111
 s_add_u32 s33, s27, 1048576
 buffer_store_dwordx4 v[52:55], v5, s[44:47], s33 offen
 v_dot2c_f32_bf16 v112, v72, v85
 v_dot2c_f32_bf16 v113, v72, v84
 v_dot2c_f32_bf16 v114, v73, v85
 v_dot2c_f32_bf16 v115, v73, v84
 v_dot2c_f32_bf16 v116, v74, v85
 v_dot2c_f32_bf16 v117, v74, v84
 v_dot2c_f32_bf16 v118, v75, v85
 v_dot2c_f32_bf16 v119, v75, v84
 v_cvt_pk_bf16_f32 v56, v112, v113
 v_cvt_pk_bf16_f32 v57, v114, v115
 v_cvt_pk_bf16_f32 v58, v116, v117
 v_cvt_pk_bf16_f32 v59, v118, v119
 s_add_u32 s33, s27, 2097152
 buffer_store_dwordx4 v[56:59], v5, s[44:47], s33 offen
 s_cmp_lg_u32 s38, 0
 s_cbranch_scc1 L_oe
 s_mov_b64 exec, 0xff
L_of:
 buffer_load_dword v10, v3, s[4:7], 0 offen sc1
 s_waitcnt vmcnt(0)
 v_cmp_gt_u32 vcc, s35, v10
 s_cbranch_vccz L_og
 s_add_u32 s61, s61, 1
 s_cmp_gt_u32 s61, 2000000
 s_cbranch_scc1 L_og
 v_add_u32 v4, 4, v10
 v_cmp_gt_u32 vcc, s35, v4
 s_sleep 4
 s_cbranch_vccz L_of
 s_sleep 80
 s_branch L_of
L_og:
 s_mov_b64 exec, -1
 s_add_u32 s33, s24, 25165824
 buffer_load_dwordx4 v[16:19], v15, s[4:7], s33 offen sc1
 s_add_u32 s33, s24, 25231360
 buffer_load_dwordx4 v[20:23], v15, s[4:7], s33 offen sc1
 s_add_u32 s33, s24, 25296896
 buffer_load_dwordx4 v[24:27], v15, s[4:7], s33 offen sc1
 s_add_u32 s33, s24, 25362432
 buffer_load_dwordx4 v[28:31], v15, s[4:7], s33 offen sc1
 s_add_u32 s33, s24, 25427968
 buffer_load_dwordx4 v[32:35], v15, s[4:7], s33 offen sc1
 s_add_u32 s33, s24, 25493504
 buffer_load_dwordx4 v[36:39], v15, s[4:7], s33 offen sc1
 s_add_u32 s33, s24, 25559040
 buffer_load_dwordx4 v[40:43], v15, s[4:7], s33 offen sc1
 s_add_u32 s33, s24, 25624576
 buffer_load_dwordx4 v[44:47], v15, s[4:7], s33 offen sc1
L_oc:
 s_waitcnt vmcnt(7)
 v_mov_b32 v4, v16
 v_mov_b32 v88, v120
 v_mov_b32 v89, v121
 v_mov_b32 v90, v122
 v_mov_b32 v91, v123
 v_mov_b32 v92, v124
 v_mov_b32 v93, v125
 v_mov_b32 v94, v126
 v_mov_b32 v95, v127
 v_dot2c_f32_bf16 v88, v16, v87
 v_dot2c_f32_bf16 v89, v16, v86
 v_dot2c_f32_bf16 v90, v17, v87
 v_dot2c_f32_bf16 v91, v17, v86
 v_dot2c_f32_bf16 v92, v18, v87
 v_dot2c_f32_bf16 v93, v18, v86
 v_dot2c_f32_bf16 v94, v19, v87
 v_dot2c_f32_bf16 v95, v19, v86
 s_waitcnt vmcnt(6)
 v_max_u32 v4, v4, v20
 v_dot2c_f32_bf16 v88, v20, v87
 v_dot2c_f32_bf16 v89, v20, v86
 v_dot2c_f32_bf16 v90, v21, v87
 v_dot2c_f32_bf16 v91, v21, v86
 v_dot2c_f32_bf16 v92, v22, v87
 v_dot2c_f32_bf16 v93, v22, v86
 v_dot2c_f32_bf16 v94, v23, v87
 v_dot2c_f32_bf16 v95, v23, v86
 s_waitcnt vmcnt(5)
 v_max_u32 v4, v4, v24
 v_dot2c_f32_bf16 v88, v24, v87
 v_dot2c_f32_bf16 v89, v24, v86
 v_dot2c_f32_bf16 v90, v25, v87
 v_dot2c_f32_bf16 v91, v25, v86
 v_dot2c_f32_bf16 v92, v26, v87
 v_dot2c_f32_bf16 v93, v26, v86
 v_dot2c_f32_bf16 v94, v27, v87
 v_dot2c_f32_bf16 v95, v27, v86
 s_waitcnt vmcnt(4)
 v_max_u32 v4, v4, v28
 v_dot2c_f32_bf16 v88, v28, v87
 v_dot2c_f32_bf16 v89, v28, v86
 v_dot2c_f32_bf16 v90, v29, v87
 v_dot2c_f32_bf16 v91, v29, v86
 v_dot2c_f32_bf16 v92, v30, v87
 v_dot2c_f32_bf16 v93, v30, v86
 v_dot2c_f32_bf16 v94, v31, v87
 v_dot2c_f32_bf16 v95, v31, v86
 s_waitcnt vmcnt(3)
 v_max_u32 v4, v4, v32
 v_dot2c_f32_bf16 v88, v32, v87
 v_dot2c_f32_bf16 v89, v32, v86
 v_dot2c_f32_bf16 v90, v33, v87
 v_dot2c_f32_bf16 v91, v33, v86
 v_dot2c_f32_bf16 v92, v34, v87
 v_dot2c_f32_bf16 v93, v34, v86
 v_dot2c_f32_bf16 v94, v35, v87
 v_dot2c_f32_bf16 v95, v35, v86
 s_waitcnt vmcnt(2)
 v_max_u32 v4, v4, v36
 v_dot2c_f32_bf16 v88, v36, v87
 v_dot2c_f32_bf16 v89, v36, v86
 v_dot2c_f32_bf16 v90, v37, v87
 v_dot2c_f32_bf16 v91, v37, v86
 v_dot2c_f32_bf16 v92, v38, v87
 v_dot2c_f32_bf16 v93, v38, v86
 v_dot2c_f32_bf16 v94, v39, v87
 v_dot2c_f32_bf16 v95, v39, v86
 s_waitcnt vmcnt(1)
 v_max_u32 v4, v4, v40
 v_dot2c_f32_bf16 v88, v40, v87
 v_dot2c_f32_bf16 v89, v40, v86
 v_dot2c_f32_bf16 v90, v41, v87
 v_dot2c_f32_bf16 v91, v41, v86
 v_dot2c_f32_bf16 v92, v42, v87
 v_dot2c_f32_bf16 v93, v42, v86
 v_dot2c_f32_bf16 v94, v43, v87
 v_dot2c_f32_bf16 v95, v43, v86
 s_waitcnt vmcnt(0)
 v_max_u32 v4, v4, v44
 v_cmp_eq_u32 vcc, -1, v4
 v_dot2c_f32_bf16 v88, v44, v87
 v_dot2c_f32_bf16 v89, v44, v86
 v_dot2c_f32_bf16 v90, v45, v87
 v_dot2c_f32_bf16 v91, v45, v86
 v_dot2c_f32_bf16 v92, v46, v87
 v_dot2c_f32_bf16 v93, v46, v86
 v_dot2c_f32_bf16 v94, v47, v87
 v_dot2c_f32_bf16 v95, v47, v86
 s_cbranch_vccz L_oz
 s_add_u32 s61, s61, 1
 s_cmp_gt_u32 s61, 2000000
 s_cbranch_scc1 L_oz
 s_sleep 1
 s_branch L_og
L_oz:
 v_cvt_pk_bf16_f32 v60, v88, v89
 v_cvt_pk_bf16_f32 v61, v90, v91
 v_cvt_pk_bf16_f32 v62, v92, v93
 v_cvt_pk_bf16_f32 v63, v94, v95
 s_add_u32 s33, s27, 3145728
 buffer_store_dwordx4 v[60:63], v5, s[44:47], s33 offen
 s_cmp_lg_u32 s38, 0
 s_cbranch_scc1 L_ob
L_oe:
L_end:
s_endpgm
.section .rodata,"a"
.p2align 6
.amdhsa_kernel gated_mix__grouped_kv_mqa__memory_aug_recurrent_mem_tr__prompt_kernel
  .amdhsa_next_free_vgpr 256
  .amdhsa_next_free_sgpr 102
  .amdhsa_accum_offset 128
  .amdhsa_group_segment_fixed_size 0
  .amdhsa_kernarg_size 128
  .amdhsa_user_sgpr_count 2
  .amdhsa_user_sgpr_kernarg_segment_ptr 1
  .amdhsa_system_sgpr_workgroup_id_x 1
.end_amdhsa_kernel
```
